```python
import torch

def _softmax(x, axis=-1):
    return torch.softmax(x, dim=axis)
def _gelu(x):
    return torch.nn.functional.gelu(x, approximate="tanh")
def _silu(x):
    return torch.nn.functional.silu(x)
def _sigmoid(x):
    return torch.sigmoid(x)
def _layernorm(x, axis=-1, eps=1e-5):
    m = x.mean(dim=axis, keepdim=True)
    v = x.var(dim=axis, keepdim=True, unbiased=False)
    return (x - m) / torch.sqrt(v + eps)
def _scatter_add(tgt, idx, src, axis=0):
    return tgt.clone().index_add_(axis, idx, src)
def _segment_sum(src, seg, n):
    out = torch.zeros((n,) + src.shape[1:], dtype=src.dtype)
    return out.index_add_(0, seg, src)
def _pad(x, pw):
    flat = tuple(v for pair in reversed(pw) for v in pair)
    return torch.nn.functional.pad(x, flat)

kernel_name = 'concat_heads__sliding_local_dilated__linear_attn_block__prompt'

def setup_inputs():

    _w = (lambda a: (lambda t: t.to(torch.bfloat16) if t.is_floating_point() else t)(torch.as_tensor(a)))
    def _A_setup():
        B, S, D = 1, 2048, 512
        return {
            "x": _w((lambda *s: torch.randn(*s, dtype=torch.bfloat16) * 0.2)(B, S, D)),
            "wqkv": _w((lambda *s: torch.randn(*s, dtype=torch.bfloat16) * 0.2)(D, 3 * D)),
            "wo": _w((lambda *s: torch.randn(*s, dtype=torch.bfloat16) * 0.05)(D, D)),
        }
    _A_in = _A_setup()

    def _B_setup():
        B, S, D = 1, 2048, 512
        return {
            "x": _w((lambda *s: torch.randn(*s, dtype=torch.bfloat16) * 0.05)(B, S, D)),
            "wqkv": _w((lambda *s: torch.randn(*s, dtype=torch.bfloat16) * 1.6)(D, 3 * D)),
            "wo": _w((lambda *s: torch.randn(*s, dtype=torch.bfloat16) * 0.8)(D, D)),
        }
    _B_in = _B_setup()

    return {
        "A_x": _A_in["x"],
        "A_wqkv": _A_in["wqkv"],
        "A_wo": _A_in["wo"],
        "B_x": _B_in["x"],
        "B_wqkv": _B_in["wqkv"],
        "B_wo": _B_in["wo"],
    }

def reference(A_x, A_wqkv, A_wo, B_x, B_wqkv, B_wo):
    def _A_ref(x, wqkv, wo):
        B, S, D = x.shape
        H = 32; Dh = D // H
        W, dil = 8, 2
        qkv = (lambda x, *d: x.permute(*d))((x @ wqkv).reshape(B, S, 3, H, Dh), 2, 0, 3, 1, 4)
        q, k, v = qkv[0], qkv[1], qkv[2]
        scale = Dh ** -0.5
        pos = torch.arange(S)
        off = torch.arange(W) * dil
        idx = pos[:, None] - off[None, :]
        mask = idx >= 0
        idx_c = torch.where(mask, idx, 0).reshape(-1)
        kg = k[:, :, idx_c, :].reshape(B, H, S, W, Dh)
        vg = v[:, :, idx_c, :].reshape(B, H, S, W, Dh)
        logits = torch.einsum("bhsd,bhswd->bhsw", q, kg) * scale
        logits = torch.where(mask[None, None, :, :], logits, -1e9)
        attn = _softmax(logits, axis=-1)
        o = torch.einsum("bhsw,bhswd->bhsd", attn, vg)
        return (lambda x, *d: x.permute(*d))(o, 0, 2, 1, 3).reshape(B, S, D) @ wo

    def _B_ref(x, wqkv, wo):
        B, S, D = x.shape
        H = 32; Dh = D // H
        qkv = (lambda x, *d: x.permute(*d))((x @ wqkv).reshape(B, S, 3, H, Dh), 2, 0, 3, 1, 4)
        q, k, v = qkv[0], qkv[1], qkv[2]
        phi = lambda t: torch.where(t > 0, t + 1, torch.exp(t)) + 1e-6
        pq, pk = phi(q), phi(k)
        kv = torch.einsum("bhsd,bhse->bhde", pk, v)
        z = torch.einsum("bhsd->bhd", pk)
        num = torch.einsum("bhqd,bhde->bhqe", pq, kv)
        den = torch.einsum("bhqd,bhd->bhq", pq, z)[..., None] + 1e-6
        o = num / den
        return (lambda x, *d: x.permute(*d))(o, 0, 2, 1, 3).reshape(B, S, D) @ wo

    a = _A_ref(A_x, A_wqkv, A_wo)
    b = _B_ref(B_x, B_wqkv, B_wo)
    return torch.concatenate([a, b], axis=-1)
```

```asm
; @launch grid=(256,1,1) block=(256,1,1) lds=163840
.amdgcn_target "amdgcn-amd-amdhsa--gfx950"
.text
.globl concat_heads__sliding_local_dilated__linear_attn_block__prompt_kernel
.p2align 8
.type concat_heads__sliding_local_dilated__linear_attn_block__prompt_kernel,@function
concat_heads__sliding_local_dilated__linear_attn_block__prompt_kernel:
    s_cmp_ge_u32 s2, 256
    s_cbranch_scc1 L_end
    s_load_dwordx16 s[4:19], s[0:1], 0
    s_load_dwordx2 s[20:21], s[0:1], 64
    v_lshrrev_b32 v2, 6, v0
    v_and_b32 v1, 63, v0
    v_readfirstlane_b32 s51, v2
    s_and_b32 s22, s2, 7
    s_lshr_b32 s23, s2, 3
    s_lshr_b32 s48, s22, 2
    s_xor_b32 s48, s48, 1
    s_bfe_u32 s49, s22, 0x10001
    s_lshl_b32 s49, s49, 3
    s_and_b32 s58, s23, 7
    s_add_u32 s49, s49, s58
    s_and_b32 s50, s22, 1
    s_lshl_b32 s50, s50, 2
    s_lshr_b32 s58, s23, 3
    s_add_u32 s58, s58, s23
    s_and_b32 s58, s58, 3
    s_add_u32 s50, s50, s58
    s_lshr_b32 s52, s51, 1
    s_and_b32 s53, s51, 1
    v_lshrrev_b32 v2, 3, v1
    v_and_b32 v3, 7, v1
    v_lshrrev_b32 v4, 4, v1
    v_xor_b32 v5, v3, v4
    v_lshlrev_b32 v6, 11, v2
    v_lshl_add_u32 v10, v5, 4, v6
    v_xor_b32 v7, 64, v10
    v_add_u32 v11, 14336, v7
    v_and_b32 v5, 1, v4
    v_lshlrev_b32 v5, 1, v5
    v_xor_b32 v5, v3, v5
    v_mul_u32_u24 v7, 3072, v2
    v_lshl_add_u32 v14, v5, 4, v7
    v_xor_b32 v7, 64, v14
    v_add_u32 v15, 22528, v7
    s_lshl_b32 s58, s51, 1
    v_add_u32 v5, s58, v4
    v_xor_b32 v5, v3, v5
    v_lshl_add_u32 v18, v5, 4, v6
    s_lshl_b32 s54, s49, 17
    s_lshl_b32 s58, s51, 15
    s_add_u32 s54, s54, s58
    s_lshl_b32 s55, s49, 7
    s_sub_i32 s55, s55, 16
    s_max_i32 s55, s55, 0
    s_lshl_b32 s58, s53, 3
    s_add_u32 s55, s55, s58
    s_add_u32 s55, s55, s52
    s_lshl_b32 s55, s55, 10
    s_mul_i32 s56, s51, 49152
    s_lshl_b32 s58, s50, 7
    s_add_u32 s56, s56, s58
    s_add_u32 s66, s56, 1024
    s_lshl_b32 s57, s51, 12
    s_lshl_b32 s67, s51, 9
    s_lshl_b32 s65, s51, 15
    s_and_b32 s58, s50, 3
    s_lshl_b32 s58, s58, 8
    s_add_u32 s65, s65, s58
    s_waitcnt lgkmcnt(0)
    s_cmp_eq_u32 s48, 0
    s_cselect_b32 s24, s4, s10
    s_cselect_b32 s25, s5, s11
    s_mov_b32 s26, 0x200000
    s_mov_b32 s27, 0x20000
    s_cselect_b32 s28, s6, s12
    s_cselect_b32 s29, s7, s13
    s_mov_b32 s30, 0x180000
    s_mov_b32 s31, 0x20000
    s_cselect_b32 s40, s8, s14
    s_cselect_b32 s41, s9, s15
    s_mov_b32 s42, 0x80000
    s_mov_b32 s43, 0x20000
    s_mov_b32 s32, s20
    s_mov_b32 s33, s21
    s_mov_b32 s34, 0x10000000
    s_mov_b32 s35, 0x20000
    s_mov_b32 s44, s16
    s_mov_b32 s45, s17
    s_mov_b32 s46, 0x400000
    s_mov_b32 s47, 0x20000
    s_lshl_b32 s16, s50, 2
    s_add_u32 s16, s16, s49
    s_add_u32 s17, s16, 0
    s_and_b32 s17, s17, 7
    s_add_u32 m0, s57, 0
    s_lshl_b32 s60, s17, 7
    s_add_u32 s60, s60, s54
    buffer_load_dwordx4 v10, s[24:27], s60 offen offset:0 lds
    buffer_load_dwordx4 v10, s[24:27], s60 offen offset:1024 lds
    buffer_load_dwordx4 v11, s[24:27], s60 offen offset:2048 lds
    buffer_load_dwordx4 v11, s[24:27], s60 offen offset:3072 lds
    s_add_u32 m0, s57, 18432
    s_mul_i32 s60, s17, 196608
    s_add_u32 s60, s60, s66
    buffer_load_dwordx4 v14, s[28:31], s60 offen offset:0 lds
    buffer_load_dwordx4 v14, s[28:31], s60 offen offset:1024 lds
    buffer_load_dwordx4 v15, s[28:31], s60 offen offset:2048 lds
    buffer_load_dwordx4 v15, s[28:31], s60 offen offset:3072 lds
    s_cmp_lg_u32 s48, 0
    s_cbranch_scc1 L_nohalo0
    s_add_u32 m0, s67, 16384
    s_lshl_b32 s60, s17, 7
    s_add_u32 s60, s60, s55
    s_mov_b32 exec_hi, 0
    buffer_load_dwordx4 v18, s[24:27], s60 offen lds
    s_mov_b32 exec_hi, -1
L_nohalo0:
    s_add_u32 s17, s16, 1
    s_and_b32 s17, s17, 7
    s_add_u32 m0, s57, 34816
    s_lshl_b32 s60, s17, 7
    s_add_u32 s60, s60, s54
    buffer_load_dwordx4 v10, s[24:27], s60 offen offset:0 lds
    buffer_load_dwordx4 v10, s[24:27], s60 offen offset:1024 lds
    buffer_load_dwordx4 v11, s[24:27], s60 offen offset:2048 lds
    buffer_load_dwordx4 v11, s[24:27], s60 offen offset:3072 lds
    s_add_u32 m0, s57, 53248
    s_mul_i32 s60, s17, 196608
    s_add_u32 s60, s60, s66
    buffer_load_dwordx4 v14, s[28:31], s60 offen offset:0 lds
    buffer_load_dwordx4 v14, s[28:31], s60 offen offset:1024 lds
    buffer_load_dwordx4 v15, s[28:31], s60 offen offset:2048 lds
    buffer_load_dwordx4 v15, s[28:31], s60 offen offset:3072 lds
    s_cmp_lg_u32 s48, 0
    s_cbranch_scc1 L_nohalo1
    s_add_u32 m0, s67, 51200
    s_lshl_b32 s60, s17, 7
    s_add_u32 s60, s60, s55
    s_mov_b32 exec_hi, 0
    buffer_load_dwordx4 v18, s[24:27], s60 offen lds
    s_mov_b32 exec_hi, -1
L_nohalo1:
    s_getpc_b64 s[68:69]
L_wc:
    s_lshl_b32 s58, s48, 1
    s_add_u32 s58, s58, s52
    s_mov_b32 s59, L_path0-L_wc
    s_cmp_eq_u32 s58, 1
    s_cselect_b32 s59, L_path1-L_wc, s59
    s_cmp_eq_u32 s58, 2
    s_cselect_b32 s59, L_path2-L_wc, s59
    s_cmp_eq_u32 s58, 3
    s_cselect_b32 s59, L_path3-L_wc, s59
    s_lshl_b32 s58, s53, 13
    s_add_u32 s59, s59, s58
    v_lshlrev_b32 v2, 7, v1
    v_add_u32 v3, s59, v2
    v_min_u32 v3, L_end-L_wc, v3
    global_load_dword v70, v3, s[68:69]
    v_add_u32 v3, L_phase2-L_wc, v2
    v_min_u32 v3, L_end-L_wc, v3
    global_load_dword v71, v3, s[68:69]
    s_lshl_b32 s58, s48, 1
    s_add_u32 s58, s58, s52
    s_cmp_eq_u32 s58, 1
    s_cbranch_scc1 L_path1
    s_cmp_eq_u32 s58, 2
    s_cbranch_scc1 L_path2
    s_cmp_eq_u32 s58, 3
    s_cbranch_scc1 L_path3
L_path0:
    s_lshl_b32 s58, s48, 4
    s_add_u32 s58, s58, s49
    s_lshl_b32 s13, s58, 7
    s_add_u32 s13, s13, 5242880
    s_lshl_b32 s11, s58, 8
    s_add_u32 s11, s11, 5251072
    s_lshl_b32 s14, s50, 7
    s_add_u32 s14, s14, 5246976
    s_load_dwordx2 s[36:37], s[20:21], s13
    s_lshl_b32 s59, s50, 1
    s_add_u32 s59, s59, s53
    s_lshl_b32 s12, s59, 3
    s_add_u32 s12, s12, s11
    s_add_u32 s12, s12, 0
    s_lshr_b32 s60, s50, 2
    s_lshl_b32 s60, s60, 7
    s_add_u32 s11, s11, s60
    v_lshrrev_b32 v2, 4, v1
    v_and_b32 v3, 15, v1
    v_lshlrev_b32 v5, 1, v2
    v_xor_b32 v5, v3, v5
    v_lshlrev_b32 v6, 10, v2
    v_lshl_add_u32 v12, v5, 4, v6
    v_xor_b32 v6, 128, v12
    v_add_u32 v13, 3072, v6
    v_add_u32 v16, 6144, v12
    v_add_u32 v17, 9216, v6
    v_and_b32 v2, 15, v1
    v_lshrrev_b32 v3, 4, v1
    v_lshrrev_b32 v4, 1, v2
    v_xor_b32 v5, v3, v4
    v_lshlrev_b32 v6, 7, v2
    v_lshl_add_u32 v6, v5, 4, v6
    v_lshrrev_b32 v7, 3, v2
    v_lshl_add_u32 v7, v7, 10, v6
    v_add_u32 v20, 0, v7
    v_xor_b32 v23, 64, v20
    v_add_u32 v21, 65536, v20
    v_add_u32 v22, 131072, v20
    v_add_u32 v24, 65536, v23
    v_add_u32 v25, 131072, v23
    v_add_u32 v26, 16384, v6
    v_xor_b32 v29, 64, v26
    v_add_u32 v27, 65536, v26
    v_add_u32 v28, 131072, v26
    v_add_u32 v30, 65536, v29
    v_add_u32 v31, 131072, v29
    v_lshrrev_b32 v4, 2, v2
    v_and_b32 v5, 3, v2
    v_lshrrev_b32 v8, 3, v2
    v_and_b32 v7, 1, v3
    v_lshl_or_b32 v8, v7, 1, v8
    v_lshrrev_b32 v6, 1, v3
    v_lshlrev_b32 v6, 12, v6
    v_lshl_add_u32 v6, v7, 11, v6
    v_lshl_add_u32 v6, v4, 7, v6
    v_lshl_add_u32 v6, v5, 3, v6
    s_lshl_b32 s58, s53, 1
    v_xor_b32 v7, s58, v8
    v_lshl_add_u32 v32, v7, 5, v6
    v_xor_b32 v35, 32, v32
    v_add_u32 v33, 65536, v32
    v_add_u32 v34, 131072, v32
    v_add_u32 v36, 65536, v35
    v_add_u32 v37, 131072, v35
    v_lshlrev_b32 v46, 4, v1
    v_lshlrev_b32 v47, 3, v1
    s_mov_b32 s61, 0x3eb8aa3b
    s_mov_b32 s62, 0xbeb8aa3b
    s_mov_b32 s63, 0x3fb8aa3b
    s_mov_b32 s64, 0x358637bd
    s_mov_b32 s71, 300000
    s_mov_b32 s18, 0x3fb8aa3b
    s_mov_b32 s19, 0x3fb8aa3b
    s_mov_b32 s96, 0x3eb8aa3b
    s_mov_b32 s97, 0x3eb8aa3b
    v_mov_b32 v66, 0x3f803f80
    v_mov_b32 v67, 0x3f803f80
    v_mov_b32 v68, 0x3f803f80
    v_mov_b32 v69, 0x3f803f80
    s_lshl_b32 s58, s49, 3
    s_add_u32 s8, s58, 0
    s_add_u32 s4, s8, 0
    s_lshl_b32 s4, s4, 4
    s_add_u32 s4, s4, s59
    s_lshl_b32 s4, s4, 10
    s_lshr_b32 s59, s50, 2
    s_lshl_b32 s59, s59, 2
    s_add_u32 s8, s8, s59
    s_add_u32 s8, s8, s51
    s_lshl_b32 s8, s8, 14
    s_lshl_b32 s7, s51, 13
    s_lshl_b32 s58, s53, 13
    v_add_u32 v9, s58, v47
    v_add_u32 v9, 139264, v9
    v_and_b32 v2, 15, v1
    v_lshrrev_b32 v3, 4, v1
    v_lshlrev_b32 v3, 2, v3
    v_mov_b32 v8, 0xf149f2ca
    v_add_u32 v4, 0, v3
    v_sub_u32 v5, v2, v4
    v_cmp_gt_u32 vcc, 8, v5
    v_mov_b32 v7, 0xffff
    s_nop 0
    v_cndmask_b32 v48, v8, 0, vcc
    v_cndmask_b32 v6, 0, v7, vcc
    v_mov_b32 v64, v6
    v_add_u32 v5, 9, v2
    v_cmp_ge_u32 vcc, v4, v5
    s_nop 1
    v_cndmask_b32 v52, v8, 0, vcc
    v_subrev_u32 v5, 0, v4
    v_cmp_gt_u32 vcc, 8, v5
    v_cmp_gt_u32 s[68:69], v5, v2
    s_nop 0
    s_and_b64 vcc, vcc, s[68:69]
    s_cmp_eq_u32 s49, 0
    s_cselect_b64 vcc, 0, vcc
    v_cndmask_b32 v56, v8, 0, vcc
    v_subrev_u32 v5, 8, v4
    v_cmp_gt_u32 vcc, 8, v5
    v_cmp_gt_u32 s[68:69], v5, v2
    s_nop 0
    s_and_b64 vcc, vcc, s[68:69]
    s_cmp_eq_u32 s49, 0
    s_cselect_b64 vcc, 0, vcc
    v_cndmask_b32 v60, v8, 0, vcc
    v_add_u32 v4, 1, v3
    v_sub_u32 v5, v2, v4
    v_cmp_gt_u32 vcc, 8, v5
    v_mov_b32 v7, 0xffff0000
    s_nop 0
    v_cndmask_b32 v49, v8, 0, vcc
    v_cndmask_b32 v6, 0, v7, vcc
    v_or_b32 v64, v64, v6
    v_add_u32 v5, 9, v2
    v_cmp_ge_u32 vcc, v4, v5
    s_nop 1
    v_cndmask_b32 v53, v8, 0, vcc
    v_subrev_u32 v5, 0, v4
    v_cmp_gt_u32 vcc, 8, v5
    v_cmp_gt_u32 s[68:69], v5, v2
    s_nop 0
    s_and_b64 vcc, vcc, s[68:69]
    s_cmp_eq_u32 s49, 0
    s_cselect_b64 vcc, 0, vcc
    v_cndmask_b32 v57, v8, 0, vcc
    v_subrev_u32 v5, 8, v4
    v_cmp_gt_u32 vcc, 8, v5
    v_cmp_gt_u32 s[68:69], v5, v2
    s_nop 0
    s_and_b64 vcc, vcc, s[68:69]
    s_cmp_eq_u32 s49, 0
    s_cselect_b64 vcc, 0, vcc
    v_cndmask_b32 v61, v8, 0, vcc
    v_add_u32 v4, 2, v3
    v_sub_u32 v5, v2, v4
    v_cmp_gt_u32 vcc, 8, v5
    v_mov_b32 v7, 0xffff
    s_nop 0
    v_cndmask_b32 v50, v8, 0, vcc
    v_cndmask_b32 v6, 0, v7, vcc
    v_mov_b32 v65, v6
    v_add_u32 v5, 9, v2
    v_cmp_ge_u32 vcc, v4, v5
    s_nop 1
    v_cndmask_b32 v54, v8, 0, vcc
    v_subrev_u32 v5, 0, v4
    v_cmp_gt_u32 vcc, 8, v5
    v_cmp_gt_u32 s[68:69], v5, v2
    s_nop 0
    s_and_b64 vcc, vcc, s[68:69]
    s_cmp_eq_u32 s49, 0
    s_cselect_b64 vcc, 0, vcc
    v_cndmask_b32 v58, v8, 0, vcc
    v_subrev_u32 v5, 8, v4
    v_cmp_gt_u32 vcc, 8, v5
    v_cmp_gt_u32 s[68:69], v5, v2
    s_nop 0
    s_and_b64 vcc, vcc, s[68:69]
    s_cmp_eq_u32 s49, 0
    s_cselect_b64 vcc, 0, vcc
    v_cndmask_b32 v62, v8, 0, vcc
    v_add_u32 v4, 3, v3
    v_sub_u32 v5, v2, v4
    v_cmp_gt_u32 vcc, 8, v5
    v_mov_b32 v7, 0xffff0000
    s_nop 0
    v_cndmask_b32 v51, v8, 0, vcc
    v_cndmask_b32 v6, 0, v7, vcc
    v_or_b32 v65, v65, v6
    v_add_u32 v5, 9, v2
    v_cmp_ge_u32 vcc, v4, v5
    s_nop 1
    v_cndmask_b32 v55, v8, 0, vcc
    v_subrev_u32 v5, 0, v4
    v_cmp_gt_u32 vcc, 8, v5
    v_cmp_gt_u32 s[68:69], v5, v2
    s_nop 0
    s_and_b64 vcc, vcc, s[68:69]
    s_cmp_eq_u32 s49, 0
    s_cselect_b64 vcc, 0, vcc
    v_cndmask_b32 v59, v8, 0, vcc
    v_subrev_u32 v5, 8, v4
    v_cmp_gt_u32 vcc, 8, v5
    v_cmp_gt_u32 s[68:69], v5, v2
    s_nop 0
    s_and_b64 vcc, vcc, s[68:69]
    s_cmp_eq_u32 s49, 0
    s_cselect_b64 vcc, 0, vcc
    v_cndmask_b32 v63, v8, 0, vcc
    s_add_u32 s17, s16, 2
    s_and_b32 s17, s17, 7
    s_add_u32 m0, s57, 69632
    s_lshl_b32 s60, s17, 7
    s_add_u32 s60, s60, s54
    buffer_load_dwordx4 v10, s[24:27], s60 offen offset:0 lds
    buffer_load_dwordx4 v10, s[24:27], s60 offen offset:1024 lds
    buffer_load_dwordx4 v11, s[24:27], s60 offen offset:2048 lds
    buffer_load_dwordx4 v11, s[24:27], s60 offen offset:3072 lds
    s_add_u32 m0, s57, 88064
    s_mul_i32 s60, s17, 196608
    s_add_u32 s60, s60, s66
    buffer_load_dwordx4 v14, s[28:31], s60 offen offset:0 lds
    buffer_load_dwordx4 v14, s[28:31], s60 offen offset:1024 lds
    buffer_load_dwordx4 v15, s[28:31], s60 offen offset:2048 lds
    buffer_load_dwordx4 v15, s[28:31], s60 offen offset:3072 lds
    s_add_u32 m0, s67, 86016
    s_lshl_b32 s60, s17, 7
    s_add_u32 s60, s60, s55
    s_mov_b32 exec_hi, 0
    buffer_load_dwordx4 v18, s[24:27], s60 offen lds
    s_mov_b32 exec_hi, -1
    s_waitcnt vmcnt(20)
    s_barrier
    ds_read_b128 a[0:3], v20 offset:0
    ds_read_b64_tr_b16 v[144:145], v32 offset:18432
    ds_read_b64_tr_b16 v[146:147], v32 offset:18944
    ds_read_b64_tr_b16 v[148:149], v32 offset:19456
    ds_read_b64_tr_b16 v[150:151], v32 offset:19968
    ds_read_b64_tr_b16 v[152:153], v35 offset:18432
    ds_read_b64_tr_b16 v[154:155], v35 offset:18944
    ds_read_b64_tr_b16 v[156:157], v35 offset:19456
    ds_read_b64_tr_b16 v[158:159], v35 offset:19968
    ds_read_b128 a[64:67], v20 offset:1024
    ds_read_b128 a[128:131], v20 offset:4096
    ds_read_b128 a[192:195], v20 offset:5120
    ds_read_b128 v[176:179], v26 offset:0
    s_waitcnt lgkmcnt(12)
    s_waitcnt lgkmcnt(10)
    v_mfma_f32_16x16x32_bf16 v[72:75], v[144:147], a[0:3], 0
    ds_read_b128 a[4:7], v23 offset:0
    s_waitcnt lgkmcnt(9)
    v_mfma_f32_16x16x32_bf16 v[76:79], a[0:3], v[148:151], 0
    ds_read_b64_tr_b16 v[160:161], v32 offset:26624
    s_waitcnt lgkmcnt(8)
    v_mfma_f32_16x16x32_bf16 v[80:83], v[152:155], a[0:3], 0
    ds_read_b64_tr_b16 v[162:163], v32 offset:27136
    s_waitcnt lgkmcnt(7)
    v_mfma_f32_16x16x32_bf16 v[84:87], a[0:3], v[156:159], 0
    s_add_u32 s17, s16, 3
    s_and_b32 s17, s17, 7
    s_add_u32 m0, s57, 104448
    s_lshl_b32 s60, s17, 7
    s_add_u32 s60, s60, s54
    buffer_load_dwordx4 v10, s[24:27], s60 offen offset:0 lds
    s_waitcnt lgkmcnt(6)
    v_mfma_f32_16x16x32_bf16 v[88:91], v[144:147], a[64:67], 0
    ds_read_b64_tr_b16 v[164:165], v32 offset:27648
    v_mfma_f32_16x16x32_bf16 v[92:95], a[64:67], v[148:151], 0
    ds_read_b64_tr_b16 v[166:167], v32 offset:28160
    v_mfma_f32_16x16x32_bf16 v[96:99], v[152:155], a[64:67], 0
    ds_read_b64_tr_b16 v[168:169], v35 offset:26624
    v_mfma_f32_16x16x32_bf16 v[100:103], a[64:67], v[156:159], 0
    buffer_load_dwordx4 v10, s[24:27], s60 offen offset:1024 lds
    s_waitcnt lgkmcnt(8)
    v_mfma_f32_16x16x32_bf16 v[104:107], v[144:147], a[128:131], 0
    ds_read_b64_tr_b16 v[170:171], v35 offset:27136
    v_mfma_f32_16x16x32_bf16 v[108:111], a[128:131], v[148:151], 0
    ds_read_b64_tr_b16 v[172:173], v35 offset:27648
    v_mfma_f32_16x16x32_bf16 v[112:115], v[152:155], a[128:131], 0
    ds_read_b64_tr_b16 v[174:175], v35 offset:28160
    v_mfma_f32_16x16x32_bf16 v[116:119], a[128:131], v[156:159], 0
    buffer_load_dwordx4 v11, s[24:27], s60 offen offset:2048 lds
    s_waitcnt lgkmcnt(10)
    v_mfma_f32_16x16x32_bf16 v[120:123], v[144:147], a[192:195], 0
    ds_read_b128 a[68:71], v23 offset:1024
    v_mfma_f32_16x16x32_bf16 v[124:127], a[192:195], v[148:151], 0
    ds_read_b128 a[132:135], v23 offset:4096
    v_mfma_f32_16x16x32_bf16 v[128:131], v[152:155], a[192:195], 0
    ds_read_b128 a[196:199], v23 offset:5120
    v_mfma_f32_16x16x32_bf16 v[132:135], a[192:195], v[156:159], 0
    buffer_load_dwordx4 v11, s[24:27], s60 offen offset:3072 lds
    s_waitcnt lgkmcnt(12)
    v_mfma_f32_16x16x32_bf16 v[136:139], v[144:147], v[176:179], 0
    ds_read_b128 v[180:183], v29 offset:0
    v_mfma_f32_16x16x32_bf16 v[140:143], v[152:155], v[176:179], 0
    s_waitcnt lgkmcnt(12)
    s_waitcnt lgkmcnt(10)
    v_mfma_f32_16x16x32_bf16 v[72:75], v[160:163], a[4:7], v[72:75]
    s_waitcnt lgkmcnt(8)
    v_mfma_f32_16x16x32_bf16 v[76:79], a[4:7], v[164:167], v[76:79]
    s_add_u32 m0, s57, 122880
    s_mul_i32 s60, s17, 196608
    s_add_u32 s60, s60, s66
    buffer_load_dwordx4 v14, s[28:31], s60 offen offset:0 lds
    s_waitcnt lgkmcnt(6)
    v_mfma_f32_16x16x32_bf16 v[80:83], v[168:171], a[4:7], v[80:83]
    s_waitcnt lgkmcnt(4)
    v_mfma_f32_16x16x32_bf16 v[84:87], a[4:7], v[172:175], v[84:87]
    s_waitcnt lgkmcnt(0)
    s_waitcnt vmcnt(16)
    s_barrier
    v_mfma_f32_16x16x32_bf16 v[88:91], v[160:163], a[68:71], v[88:91]
    ds_read_b128 a[8:11], v20 offset:34816
    ds_read_b64_tr_b16 v[144:145], v32 offset:53248
    v_mfma_f32_16x16x32_bf16 v[92:95], a[68:71], v[164:167], v[92:95]
    ds_read_b64_tr_b16 v[146:147], v32 offset:53760
    ds_read_b64_tr_b16 v[148:149], v32 offset:54272
    v_mfma_f32_16x16x32_bf16 v[96:99], v[168:171], a[68:71], v[96:99]
    ds_read_b64_tr_b16 v[150:151], v32 offset:54784
    ds_read_b64_tr_b16 v[152:153], v35 offset:53248
    v_mfma_f32_16x16x32_bf16 v[100:103], a[68:71], v[172:175], v[100:103]
    buffer_load_dwordx4 v14, s[28:31], s60 offen offset:1024 lds
    ds_read_b64_tr_b16 v[154:155], v35 offset:53760
    v_mfma_f32_16x16x32_bf16 v[104:107], v[160:163], a[132:135], v[104:107]
    ds_read_b64_tr_b16 v[156:157], v35 offset:54272
    ds_read_b64_tr_b16 v[158:159], v35 offset:54784
    v_mfma_f32_16x16x32_bf16 v[108:111], a[132:135], v[164:167], v[108:111]
    ds_read_b128 a[72:75], v20 offset:35840
    ds_read_b128 a[136:139], v20 offset:38912
    v_mfma_f32_16x16x32_bf16 v[112:115], v[168:171], a[132:135], v[112:115]
    ds_read_b128 a[200:203], v20 offset:39936
    ds_read_b128 v[176:179], v26 offset:34816
    v_mfma_f32_16x16x32_bf16 v[116:119], a[132:135], v[172:175], v[116:119]
    buffer_load_dwordx4 v15, s[28:31], s60 offen offset:2048 lds
    v_mfma_f32_16x16x32_bf16 v[120:123], v[160:163], a[196:199], v[120:123]
    v_mfma_f32_16x16x32_bf16 v[124:127], a[196:199], v[164:167], v[124:127]
    v_mfma_f32_16x16x32_bf16 v[128:131], v[168:171], a[196:199], v[128:131]
    v_mfma_f32_16x16x32_bf16 v[132:135], a[196:199], v[172:175], v[132:135]
    buffer_load_dwordx4 v15, s[28:31], s60 offen offset:3072 lds
    v_mfma_f32_16x16x32_bf16 v[136:139], v[160:163], v[180:183], v[136:139]
    v_mfma_f32_16x16x32_bf16 v[140:143], v[168:171], v[180:183], v[140:143]
    s_waitcnt lgkmcnt(12)
    s_waitcnt lgkmcnt(10)
    v_mfma_f32_16x16x32_bf16 v[72:75], v[144:147], a[8:11], v[72:75]
    ds_read_b128 a[12:15], v23 offset:34816
    s_waitcnt lgkmcnt(9)
    v_mfma_f32_16x16x32_bf16 v[76:79], a[8:11], v[148:151], v[76:79]
    ds_read_b64_tr_b16 v[160:161], v32 offset:61440
    s_waitcnt lgkmcnt(8)
    v_mfma_f32_16x16x32_bf16 v[80:83], v[152:155], a[8:11], v[80:83]
    ds_read_b64_tr_b16 v[162:163], v32 offset:61952
    s_waitcnt lgkmcnt(7)
    v_mfma_f32_16x16x32_bf16 v[84:87], a[8:11], v[156:159], v[84:87]
    s_add_u32 m0, s67, 120832
    s_lshl_b32 s60, s17, 7
    s_add_u32 s60, s60, s55
    s_mov_b32 exec_hi, 0
    buffer_load_dwordx4 v18, s[24:27], s60 offen lds
    s_mov_b32 exec_hi, -1
    s_waitcnt lgkmcnt(6)
    v_mfma_f32_16x16x32_bf16 v[88:91], v[144:147], a[72:75], v[88:91]
    ds_read_b64_tr_b16 v[164:165], v32 offset:62464
    v_mfma_f32_16x16x32_bf16 v[92:95], a[72:75], v[148:151], v[92:95]
    ds_read_b64_tr_b16 v[166:167], v32 offset:62976
    v_mfma_f32_16x16x32_bf16 v[96:99], v[152:155], a[72:75], v[96:99]
    ds_read_b64_tr_b16 v[168:169], v35 offset:61440
    v_mfma_f32_16x16x32_bf16 v[100:103], a[72:75], v[156:159], v[100:103]
    s_add_u32 s17, s16, 4
    s_and_b32 s17, s17, 7
    s_add_u32 m0, s57, 0
    s_lshl_b32 s60, s17, 7
    s_add_u32 s60, s60, s54
    buffer_load_dwordx4 v10, s[24:27], s60 offen offset:0 lds
    s_waitcnt lgkmcnt(8)
    v_mfma_f32_16x16x32_bf16 v[104:107], v[144:147], a[136:139], v[104:107]
    ds_read_b64_tr_b16 v[170:171], v35 offset:61952
    v_mfma_f32_16x16x32_bf16 v[108:111], a[136:139], v[148:151], v[108:111]
    ds_read_b64_tr_b16 v[172:173], v35 offset:62464
    v_mfma_f32_16x16x32_bf16 v[112:115], v[152:155], a[136:139], v[112:115]
    ds_read_b64_tr_b16 v[174:175], v35 offset:62976
    v_mfma_f32_16x16x32_bf16 v[116:119], a[136:139], v[156:159], v[116:119]
    buffer_load_dwordx4 v10, s[24:27], s60 offen offset:1024 lds
    s_waitcnt lgkmcnt(10)
    v_mfma_f32_16x16x32_bf16 v[120:123], v[144:147], a[200:203], v[120:123]
    ds_read_b128 a[76:79], v23 offset:35840
    v_mfma_f32_16x16x32_bf16 v[124:127], a[200:203], v[148:151], v[124:127]
    ds_read_b128 a[140:143], v23 offset:38912
    v_mfma_f32_16x16x32_bf16 v[128:131], v[152:155], a[200:203], v[128:131]
    ds_read_b128 a[204:207], v23 offset:39936
    v_mfma_f32_16x16x32_bf16 v[132:135], a[200:203], v[156:159], v[132:135]
    buffer_load_dwordx4 v11, s[24:27], s60 offen offset:2048 lds
    s_waitcnt lgkmcnt(12)
    v_mfma_f32_16x16x32_bf16 v[136:139], v[144:147], v[176:179], v[136:139]
    ds_read_b128 v[180:183], v29 offset:34816
    v_mfma_f32_16x16x32_bf16 v[140:143], v[152:155], v[176:179], v[140:143]
    s_waitcnt lgkmcnt(12)
    s_waitcnt lgkmcnt(10)
    v_mfma_f32_16x16x32_bf16 v[72:75], v[160:163], a[12:15], v[72:75]
    s_waitcnt lgkmcnt(8)
    v_mfma_f32_16x16x32_bf16 v[76:79], a[12:15], v[164:167], v[76:79]
    buffer_load_dwordx4 v11, s[24:27], s60 offen offset:3072 lds
    s_waitcnt lgkmcnt(6)
    v_mfma_f32_16x16x32_bf16 v[80:83], v[168:171], a[12:15], v[80:83]
    s_waitcnt lgkmcnt(4)
    v_mfma_f32_16x16x32_bf16 v[84:87], a[12:15], v[172:175], v[84:87]
    s_waitcnt lgkmcnt(0)
    s_waitcnt vmcnt(13)
    s_barrier
    v_mfma_f32_16x16x32_bf16 v[88:91], v[160:163], a[76:79], v[88:91]
    ds_read_b128 a[16:19], v21 offset:4096
    ds_read_b64_tr_b16 v[144:145], v33 offset:22528
    v_mfma_f32_16x16x32_bf16 v[92:95], a[76:79], v[164:167], v[92:95]
    ds_read_b64_tr_b16 v[146:147], v33 offset:23040
    ds_read_b64_tr_b16 v[148:149], v33 offset:23552
    v_mfma_f32_16x16x32_bf16 v[96:99], v[168:171], a[76:79], v[96:99]
    ds_read_b64_tr_b16 v[150:151], v33 offset:24064
    ds_read_b64_tr_b16 v[152:153], v36 offset:22528
    v_mfma_f32_16x16x32_bf16 v[100:103], a[76:79], v[172:175], v[100:103]
    s_add_u32 m0, s57, 18432
    s_mul_i32 s60, s17, 196608
    s_add_u32 s60, s60, s66
    buffer_load_dwordx4 v14, s[28:31], s60 offen offset:0 lds
    v_mfma_f32_16x16x32_bf16 v[104:107], v[160:163], a[140:143], v[104:107]
    ds_read_b64_tr_b16 v[154:155], v36 offset:23040
    ds_read_b64_tr_b16 v[156:157], v36 offset:23552
    v_mfma_f32_16x16x32_bf16 v[108:111], a[140:143], v[164:167], v[108:111]
    ds_read_b64_tr_b16 v[158:159], v36 offset:24064
    ds_read_b128 a[80:83], v21 offset:5120
    v_mfma_f32_16x16x32_bf16 v[112:115], v[168:171], a[140:143], v[112:115]
    ds_read_b128 a[144:147], v21 offset:8192
    ds_read_b128 a[208:211], v21 offset:9216
    v_mfma_f32_16x16x32_bf16 v[116:119], a[140:143], v[172:175], v[116:119]
    buffer_load_dwordx4 v14, s[28:31], s60 offen offset:1024 lds
    ds_read_b128 v[176:179], v27 offset:4096
    v_mfma_f32_16x16x32_bf16 v[120:123], v[160:163], a[204:207], v[120:123]
    v_mfma_f32_16x16x32_bf16 v[124:127], a[204:207], v[164:167], v[124:127]
    v_mfma_f32_16x16x32_bf16 v[128:131], v[168:171], a[204:207], v[128:131]
    v_mfma_f32_16x16x32_bf16 v[132:135], a[204:207], v[172:175], v[132:135]
    buffer_load_dwordx4 v15, s[28:31], s60 offen offset:2048 lds
    v_mfma_f32_16x16x32_bf16 v[136:139], v[160:163], v[180:183], v[136:139]
    v_mfma_f32_16x16x32_bf16 v[140:143], v[168:171], v[180:183], v[140:143]
    s_waitcnt lgkmcnt(12)
    s_waitcnt lgkmcnt(10)
    v_mfma_f32_16x16x32_bf16 v[72:75], v[144:147], a[16:19], v[72:75]
    ds_read_b128 a[20:23], v24 offset:4096
    s_waitcnt lgkmcnt(9)
    v_mfma_f32_16x16x32_bf16 v[76:79], a[16:19], v[148:151], v[76:79]
    buffer_load_dwordx4 v15, s[28:31], s60 offen offset:3072 lds
    s_waitcnt lgkmcnt(7)
    v_mfma_f32_16x16x32_bf16 v[80:83], v[152:155], a[16:19], v[80:83]
    ds_read_b64_tr_b16 v[160:161], v33 offset:30720
    s_waitcnt lgkmcnt(6)
    v_mfma_f32_16x16x32_bf16 v[84:87], a[16:19], v[156:159], v[84:87]
    s_add_u32 m0, s67, 16384
    s_lshl_b32 s60, s17, 7
    s_add_u32 s60, s60, s55
    s_mov_b32 exec_hi, 0
    buffer_load_dwordx4 v18, s[24:27], s60 offen lds
    s_mov_b32 exec_hi, -1
    s_waitcnt lgkmcnt(5)
    v_mfma_f32_16x16x32_bf16 v[88:91], v[144:147], a[80:83], v[88:91]
    ds_read_b64_tr_b16 v[162:163], v33 offset:31232
    v_mfma_f32_16x16x32_bf16 v[92:95], a[80:83], v[148:151], v[92:95]
    s_add_u32 s17, s16, 5
    s_and_b32 s17, s17, 7
    s_add_u32 m0, s57, 34816
    s_lshl_b32 s60, s17, 7
    s_add_u32 s60, s60, s54
    buffer_load_dwordx4 v10, s[24:27], s60 offen offset:0 lds
    v_mfma_f32_16x16x32_bf16 v[96:99], v[152:155], a[80:83], v[96:99]
    ds_read_b64_tr_b16 v[164:165], v33 offset:31744
    v_mfma_f32_16x16x32_bf16 v[100:103], a[80:83], v[156:159], v[100:103]
    buffer_load_dwordx4 v10, s[24:27], s60 offen offset:1024 lds
    s_waitcnt lgkmcnt(6)
    v_mfma_f32_16x16x32_bf16 v[104:107], v[144:147], a[144:147], v[104:107]
    ds_read_b64_tr_b16 v[166:167], v33 offset:32256
    v_mfma_f32_16x16x32_bf16 v[108:111], a[144:147], v[148:151], v[108:111]
    buffer_load_dwordx4 v11, s[24:27], s60 offen offset:2048 lds
    v_mfma_f32_16x16x32_bf16 v[112:115], v[152:155], a[144:147], v[112:115]
    ds_read_b64_tr_b16 v[168:169], v36 offset:30720
    v_mfma_f32_16x16x32_bf16 v[116:119], a[144:147], v[156:159], v[116:119]
    buffer_load_dwordx4 v11, s[24:27], s60 offen offset:3072 lds
    s_waitcnt lgkmcnt(7)
    v_mfma_f32_16x16x32_bf16 v[120:123], v[144:147], a[208:211], v[120:123]
    ds_read_b64_tr_b16 v[170:171], v36 offset:31232
    v_mfma_f32_16x16x32_bf16 v[124:127], a[208:211], v[148:151], v[124:127]
    s_add_u32 m0, s57, 53248
    s_mul_i32 s60, s17, 196608
    s_add_u32 s60, s60, s66
    buffer_load_dwordx4 v14, s[28:31], s60 offen offset:0 lds
    v_mfma_f32_16x16x32_bf16 v[128:131], v[152:155], a[208:211], v[128:131]
    ds_read_b64_tr_b16 v[172:173], v36 offset:31744
    v_mfma_f32_16x16x32_bf16 v[132:135], a[208:211], v[156:159], v[132:135]
    buffer_load_dwordx4 v14, s[28:31], s60 offen offset:1024 lds
    s_waitcnt lgkmcnt(8)
    v_mfma_f32_16x16x32_bf16 v[136:139], v[144:147], v[176:179], v[136:139]
    ds_read_b64_tr_b16 v[174:175], v36 offset:32256
    v_mfma_f32_16x16x32_bf16 v[140:143], v[152:155], v[176:179], v[140:143]
    buffer_load_dwordx4 v15, s[28:31], s60 offen offset:2048 lds
    ds_read_b128 a[84:87], v24 offset:5120
    ds_read_b128 a[148:151], v24 offset:8192
    ds_read_b128 a[212:215], v24 offset:9216
    ds_read_b128 v[180:183], v30 offset:4096
    s_waitcnt lgkmcnt(12)
    s_waitcnt lgkmcnt(10)
    v_mfma_f32_16x16x32_bf16 v[72:75], v[160:163], a[20:23], v[72:75]
    s_waitcnt lgkmcnt(8)
    v_mfma_f32_16x16x32_bf16 v[76:79], a[20:23], v[164:167], v[76:79]
    buffer_load_dwordx4 v15, s[28:31], s60 offen offset:3072 lds
    s_waitcnt lgkmcnt(6)
    v_mfma_f32_16x16x32_bf16 v[80:83], v[168:171], a[20:23], v[80:83]
    s_waitcnt lgkmcnt(4)
    v_mfma_f32_16x16x32_bf16 v[84:87], a[20:23], v[172:175], v[84:87]
    s_waitcnt lgkmcnt(0)
    s_waitcnt vmcnt(17)
    s_barrier
    v_mfma_f32_16x16x32_bf16 v[88:91], v[160:163], a[84:87], v[88:91]
    ds_read_b128 a[24:27], v21 offset:38912
    ds_read_b64_tr_b16 v[144:145], v33 offset:57344
    v_mfma_f32_16x16x32_bf16 v[92:95], a[84:87], v[164:167], v[92:95]
    ds_read_b64_tr_b16 v[146:147], v33 offset:57856
    ds_read_b64_tr_b16 v[148:149], v33 offset:58368
    v_mfma_f32_16x16x32_bf16 v[96:99], v[168:171], a[84:87], v[96:99]
    ds_read_b64_tr_b16 v[150:151], v33 offset:58880
    ds_read_b64_tr_b16 v[152:153], v36 offset:57344
    v_mfma_f32_16x16x32_bf16 v[100:103], a[84:87], v[172:175], v[100:103]
    s_add_u32 m0, s67, 51200
    s_lshl_b32 s60, s17, 7
    s_add_u32 s60, s60, s55
    s_mov_b32 exec_hi, 0
    buffer_load_dwordx4 v18, s[24:27], s60 offen lds
    s_mov_b32 exec_hi, -1
    v_mfma_f32_16x16x32_bf16 v[104:107], v[160:163], a[148:151], v[104:107]
    ds_read_b64_tr_b16 v[154:155], v36 offset:57856
    ds_read_b64_tr_b16 v[156:157], v36 offset:58368
    v_mfma_f32_16x16x32_bf16 v[108:111], a[148:151], v[164:167], v[108:111]
    ds_read_b64_tr_b16 v[158:159], v36 offset:58880
    ds_read_b128 a[88:91], v21 offset:39936
    v_mfma_f32_16x16x32_bf16 v[112:115], v[168:171], a[148:151], v[112:115]
    ds_read_b128 a[152:155], v21 offset:43008
    ds_read_b128 a[216:219], v21 offset:44032
    v_mfma_f32_16x16x32_bf16 v[116:119], a[148:151], v[172:175], v[116:119]
    s_add_u32 s17, s16, 6
    s_and_b32 s17, s17, 7
    s_add_u32 m0, s57, 69632
    s_lshl_b32 s60, s17, 7
    s_add_u32 s60, s60, s54
    buffer_load_dwordx4 v10, s[24:27], s60 offen offset:0 lds
    v_mfma_f32_16x16x32_bf16 v[120:123], v[160:163], a[212:215], v[120:123]
    ds_read_b128 v[176:179], v27 offset:38912
    v_mfma_f32_16x16x32_bf16 v[124:127], a[212:215], v[164:167], v[124:127]
    v_mfma_f32_16x16x32_bf16 v[128:131], v[168:171], a[212:215], v[128:131]
    v_mfma_f32_16x16x32_bf16 v[132:135], a[212:215], v[172:175], v[132:135]
    buffer_load_dwordx4 v10, s[24:27], s60 offen offset:1024 lds
    v_mfma_f32_16x16x32_bf16 v[136:139], v[160:163], v[180:183], v[136:139]
    v_mfma_f32_16x16x32_bf16 v[140:143], v[168:171], v[180:183], v[140:143]
    s_waitcnt lgkmcnt(12)
    s_waitcnt lgkmcnt(10)
    v_mfma_f32_16x16x32_bf16 v[72:75], v[144:147], a[24:27], v[72:75]
    ds_read_b128 a[28:31], v24 offset:38912
    s_waitcnt lgkmcnt(9)
    v_mfma_f32_16x16x32_bf16 v[76:79], a[24:27], v[148:151], v[76:79]
    ds_read_b64_tr_b16 v[160:161], v34 offset:0
    s_waitcnt lgkmcnt(8)
    v_mfma_f32_16x16x32_bf16 v[80:83], v[152:155], a[24:27], v[80:83]
    ds_read_b64_tr_b16 v[162:163], v34 offset:512
    s_waitcnt lgkmcnt(7)
    v_mfma_f32_16x16x32_bf16 v[84:87], a[24:27], v[156:159], v[84:87]
    buffer_load_dwordx4 v11, s[24:27], s60 offen offset:2048 lds
    s_waitcnt lgkmcnt(6)
    v_mfma_f32_16x16x32_bf16 v[88:91], v[144:147], a[88:91], v[88:91]
    ds_read_b64_tr_b16 v[164:165], v34 offset:1024
    v_mfma_f32_16x16x32_bf16 v[92:95], a[88:91], v[148:151], v[92:95]
    ds_read_b64_tr_b16 v[166:167], v34 offset:1536
    v_mfma_f32_16x16x32_bf16 v[96:99], v[152:155], a[88:91], v[96:99]
    ds_read_b64_tr_b16 v[168:169], v37 offset:0
    v_mfma_f32_16x16x32_bf16 v[100:103], a[88:91], v[156:159], v[100:103]
    buffer_load_dwordx4 v11, s[24:27], s60 offen offset:3072 lds
    s_waitcnt lgkmcnt(8)
    v_mfma_f32_16x16x32_bf16 v[104:107], v[144:147], a[152:155], v[104:107]
    ds_read_b64_tr_b16 v[170:171], v37 offset:512
    v_mfma_f32_16x16x32_bf16 v[108:111], a[152:155], v[148:151], v[108:111]
    ds_read_b64_tr_b16 v[172:173], v37 offset:1024
    v_mfma_f32_16x16x32_bf16 v[112:115], v[152:155], a[152:155], v[112:115]
    ds_read_b64_tr_b16 v[174:175], v37 offset:1536
    v_mfma_f32_16x16x32_bf16 v[116:119], a[152:155], v[156:159], v[116:119]
    s_add_u32 m0, s57, 88064
    s_mul_i32 s60, s17, 196608
    s_add_u32 s60, s60, s66
    buffer_load_dwordx4 v14, s[28:31], s60 offen offset:0 lds
    s_waitcnt lgkmcnt(10)
    v_mfma_f32_16x16x32_bf16 v[120:123], v[144:147], a[216:219], v[120:123]
    ds_read_b128 a[92:95], v24 offset:39936
    v_mfma_f32_16x16x32_bf16 v[124:127], a[216:219], v[148:151], v[124:127]
    ds_read_b128 a[156:159], v24 offset:43008
    v_mfma_f32_16x16x32_bf16 v[128:131], v[152:155], a[216:219], v[128:131]
    ds_read_b128 a[220:223], v24 offset:44032
    v_mfma_f32_16x16x32_bf16 v[132:135], a[216:219], v[156:159], v[132:135]
    buffer_load_dwordx4 v14, s[28:31], s60 offen offset:1024 lds
    s_waitcnt lgkmcnt(12)
    v_mfma_f32_16x16x32_bf16 v[136:139], v[144:147], v[176:179], v[136:139]
    ds_read_b128 v[180:183], v30 offset:38912
    v_mfma_f32_16x16x32_bf16 v[140:143], v[152:155], v[176:179], v[140:143]
    s_waitcnt lgkmcnt(12)
    s_waitcnt lgkmcnt(10)
    v_mfma_f32_16x16x32_bf16 v[72:75], v[160:163], a[28:31], v[72:75]
    s_waitcnt lgkmcnt(8)
    v_mfma_f32_16x16x32_bf16 v[76:79], a[28:31], v[164:167], v[76:79]
    buffer_load_dwordx4 v15, s[28:31], s60 offen offset:2048 lds
    s_waitcnt lgkmcnt(6)
    v_mfma_f32_16x16x32_bf16 v[80:83], v[168:171], a[28:31], v[80:83]
    s_waitcnt lgkmcnt(4)
    v_mfma_f32_16x16x32_bf16 v[84:87], a[28:31], v[172:175], v[84:87]
    s_waitcnt lgkmcnt(0)
    s_waitcnt vmcnt(16)
    s_barrier
    v_mfma_f32_16x16x32_bf16 v[88:91], v[160:163], a[92:95], v[88:91]
    ds_read_b128 a[32:35], v20 offset:0
    ds_read_b64_tr_b16 v[144:145], v32 offset:18432
    v_mfma_f32_16x16x32_bf16 v[92:95], a[92:95], v[164:167], v[92:95]
    ds_read_b64_tr_b16 v[146:147], v32 offset:18944
    ds_read_b64_tr_b16 v[148:149], v32 offset:19456
    v_mfma_f32_16x16x32_bf16 v[96:99], v[168:171], a[92:95], v[96:99]
    ds_read_b64_tr_b16 v[150:151], v32 offset:19968
    ds_read_b64_tr_b16 v[152:153], v35 offset:18432
    v_mfma_f32_16x16x32_bf16 v[100:103], a[92:95], v[172:175], v[100:103]
    buffer_load_dwordx4 v15, s[28:31], s60 offen offset:3072 lds
    ds_read_b64_tr_b16 v[154:155], v35 offset:18944
    v_mfma_f32_16x16x32_bf16 v[104:107], v[160:163], a[156:159], v[104:107]
    ds_read_b64_tr_b16 v[156:157], v35 offset:19456
    ds_read_b64_tr_b16 v[158:159], v35 offset:19968
    v_mfma_f32_16x16x32_bf16 v[108:111], a[156:159], v[164:167], v[108:111]
    ds_read_b128 a[96:99], v20 offset:1024
    ds_read_b128 a[160:163], v20 offset:4096
    v_mfma_f32_16x16x32_bf16 v[112:115], v[168:171], a[156:159], v[112:115]
    ds_read_b128 a[224:227], v20 offset:5120
    ds_read_b128 v[176:179], v26 offset:0
    v_mfma_f32_16x16x32_bf16 v[116:119], a[156:159], v[172:175], v[116:119]
    s_add_u32 m0, s67, 86016
    s_lshl_b32 s60, s17, 7
    s_add_u32 s60, s60, s55
    s_mov_b32 exec_hi, 0
    buffer_load_dwordx4 v18, s[24:27], s60 offen lds
    s_mov_b32 exec_hi, -1
    v_mfma_f32_16x16x32_bf16 v[120:123], v[160:163], a[220:223], v[120:123]
    v_mfma_f32_16x16x32_bf16 v[124:127], a[220:223], v[164:167], v[124:127]
    v_mfma_f32_16x16x32_bf16 v[128:131], v[168:171], a[220:223], v[128:131]
    v_mfma_f32_16x16x32_bf16 v[132:135], a[220:223], v[172:175], v[132:135]
    s_add_u32 s17, s16, 7
    s_and_b32 s17, s17, 7
    s_add_u32 m0, s57, 104448
    s_lshl_b32 s60, s17, 7
    s_add_u32 s60, s60, s54
    buffer_load_dwordx4 v10, s[24:27], s60 offen offset:0 lds
    v_mfma_f32_16x16x32_bf16 v[136:139], v[160:163], v[180:183], v[136:139]
    v_mfma_f32_16x16x32_bf16 v[140:143], v[168:171], v[180:183], v[140:143]
    s_waitcnt lgkmcnt(12)
    s_waitcnt lgkmcnt(10)
    v_mfma_f32_16x16x32_bf16 v[72:75], v[144:147], a[32:35], v[72:75]
    ds_read_b128 a[36:39], v23 offset:0
    s_waitcnt lgkmcnt(9)
    v_mfma_f32_16x16x32_bf16 v[76:79], a[32:35], v[148:151], v[76:79]
    ds_read_b64_tr_b16 v[160:161], v32 offset:26624
    s_waitcnt lgkmcnt(8)
    v_mfma_f32_16x16x32_bf16 v[80:83], v[152:155], a[32:35], v[80:83]
    ds_read_b64_tr_b16 v[162:163], v32 offset:27136
    s_waitcnt lgkmcnt(7)
    v_mfma_f32_16x16x32_bf16 v[84:87], a[32:35], v[156:159], v[84:87]
    buffer_load_dwordx4 v10, s[24:27], s60 offen offset:1024 lds
    s_waitcnt lgkmcnt(6)
    v_mfma_f32_16x16x32_bf16 v[88:91], v[144:147], a[96:99], v[88:91]
    ds_read_b64_tr_b16 v[164:165], v32 offset:27648
    v_mfma_f32_16x16x32_bf16 v[92:95], a[96:99], v[148:151], v[92:95]
    ds_read_b64_tr_b16 v[166:167], v32 offset:28160
    v_mfma_f32_16x16x32_bf16 v[96:99], v[152:155], a[96:99], v[96:99]
    ds_read_b64_tr_b16 v[168:169], v35 offset:26624
    v_mfma_f32_16x16x32_bf16 v[100:103], a[96:99], v[156:159], v[100:103]
    buffer_load_dwordx4 v11, s[24:27], s60 offen offset:2048 lds
    s_waitcnt lgkmcnt(8)
    v_mfma_f32_16x16x32_bf16 v[104:107], v[144:147], a[160:163], v[104:107]
    ds_read_b64_tr_b16 v[170:171], v35 offset:27136
    v_mfma_f32_16x16x32_bf16 v[108:111], a[160:163], v[148:151], v[108:111]
    ds_read_b64_tr_b16 v[172:173], v35 offset:27648
    v_mfma_f32_16x16x32_bf16 v[112:115], v[152:155], a[160:163], v[112:115]
    ds_read_b64_tr_b16 v[174:175], v35 offset:28160
    v_mfma_f32_16x16x32_bf16 v[116:119], a[160:163], v[156:159], v[116:119]
    buffer_load_dwordx4 v11, s[24:27], s60 offen offset:3072 lds
    s_waitcnt lgkmcnt(10)
    v_mfma_f32_16x16x32_bf16 v[120:123], v[144:147], a[224:227], v[120:123]
    ds_read_b128 a[100:103], v23 offset:1024
    v_mfma_f32_16x16x32_bf16 v[124:127], a[224:227], v[148:151], v[124:127]
    ds_read_b128 a[164:167], v23 offset:4096
    v_mfma_f32_16x16x32_bf16 v[128:131], v[152:155], a[224:227], v[128:131]
    ds_read_b128 a[228:231], v23 offset:5120
    v_mfma_f32_16x16x32_bf16 v[132:135], a[224:227], v[156:159], v[132:135]
    s_add_u32 m0, s57, 122880
    s_mul_i32 s60, s17, 196608
    s_add_u32 s60, s60, s66
    buffer_load_dwordx4 v14, s[28:31], s60 offen offset:0 lds
    s_waitcnt lgkmcnt(12)
    v_mfma_f32_16x16x32_bf16 v[136:139], v[144:147], v[176:179], v[136:139]
    ds_read_b128 v[180:183], v29 offset:0
    v_mfma_f32_16x16x32_bf16 v[140:143], v[152:155], v[176:179], v[140:143]
    s_waitcnt lgkmcnt(12)
    s_waitcnt lgkmcnt(10)
    v_mfma_f32_16x16x32_bf16 v[72:75], v[160:163], a[36:39], v[72:75]
    s_waitcnt lgkmcnt(8)
    v_mfma_f32_16x16x32_bf16 v[76:79], a[36:39], v[164:167], v[76:79]
    buffer_load_dwordx4 v14, s[28:31], s60 offen offset:1024 lds
    s_waitcnt lgkmcnt(6)
    v_mfma_f32_16x16x32_bf16 v[80:83], v[168:171], a[36:39], v[80:83]
    s_waitcnt lgkmcnt(4)
    v_mfma_f32_16x16x32_bf16 v[84:87], a[36:39], v[172:175], v[84:87]
    s_waitcnt lgkmcnt(0)
    s_waitcnt vmcnt(15)
    s_barrier
    v_mfma_f32_16x16x32_bf16 v[88:91], v[160:163], a[100:103], v[88:91]
    ds_read_b128 a[40:43], v20 offset:34816
    ds_read_b64_tr_b16 v[144:145], v32 offset:53248
    v_mfma_f32_16x16x32_bf16 v[92:95], a[100:103], v[164:167], v[92:95]
    ds_read_b64_tr_b16 v[146:147], v32 offset:53760
    ds_read_b64_tr_b16 v[148:149], v32 offset:54272
    v_mfma_f32_16x16x32_bf16 v[96:99], v[168:171], a[100:103], v[96:99]
    ds_read_b64_tr_b16 v[150:151], v32 offset:54784
    ds_read_b64_tr_b16 v[152:153], v35 offset:53248
    v_mfma_f32_16x16x32_bf16 v[100:103], a[100:103], v[172:175], v[100:103]
    buffer_load_dwordx4 v15, s[28:31], s60 offen offset:2048 lds
    ds_read_b64_tr_b16 v[154:155], v35 offset:53760
    v_mfma_f32_16x16x32_bf16 v[104:107], v[160:163], a[164:167], v[104:107]
    ds_read_b64_tr_b16 v[156:157], v35 offset:54272
    ds_read_b64_tr_b16 v[158:159], v35 offset:54784
    v_mfma_f32_16x16x32_bf16 v[108:111], a[164:167], v[164:167], v[108:111]
    ds_read_b128 a[104:107], v20 offset:35840
    ds_read_b128 a[168:171], v20 offset:38912
    v_mfma_f32_16x16x32_bf16 v[112:115], v[168:171], a[164:167], v[112:115]
    ds_read_b128 a[232:235], v20 offset:39936
    ds_read_b128 v[176:179], v26 offset:34816
    v_mfma_f32_16x16x32_bf16 v[116:119], a[164:167], v[172:175], v[116:119]
    buffer_load_dwordx4 v15, s[28:31], s60 offen offset:3072 lds
    v_mfma_f32_16x16x32_bf16 v[120:123], v[160:163], a[228:231], v[120:123]
    v_mfma_f32_16x16x32_bf16 v[124:127], a[228:231], v[164:167], v[124:127]
    v_mfma_f32_16x16x32_bf16 v[128:131], v[168:171], a[228:231], v[128:131]
    v_mfma_f32_16x16x32_bf16 v[132:135], a[228:231], v[172:175], v[132:135]
    s_add_u32 m0, s67, 120832
    s_lshl_b32 s60, s17, 7
    s_add_u32 s60, s60, s55
    s_mov_b32 exec_hi, 0
    buffer_load_dwordx4 v18, s[24:27], s60 offen lds
    s_mov_b32 exec_hi, -1
    v_mfma_f32_16x16x32_bf16 v[136:139], v[160:163], v[180:183], v[136:139]
    v_mfma_f32_16x16x32_bf16 v[140:143], v[168:171], v[180:183], v[140:143]
    s_waitcnt lgkmcnt(12)
    s_waitcnt lgkmcnt(10)
    v_mfma_f32_16x16x32_bf16 v[72:75], v[144:147], a[40:43], v[72:75]
    ds_read_b128 a[44:47], v23 offset:34816
    s_waitcnt lgkmcnt(9)
    v_mfma_f32_16x16x32_bf16 v[76:79], a[40:43], v[148:151], v[76:79]
    ds_read_b64_tr_b16 v[160:161], v32 offset:61440
    s_waitcnt lgkmcnt(8)
    v_mfma_f32_16x16x32_bf16 v[80:83], v[152:155], a[40:43], v[80:83]
    ds_read_b64_tr_b16 v[162:163], v32 offset:61952
    s_waitcnt lgkmcnt(7)
    v_mfma_f32_16x16x32_bf16 v[84:87], a[40:43], v[156:159], v[84:87]
    s_add_u32 s17, s16, 0
    s_and_b32 s17, s17, 7
    s_add_u32 m0, s57, 0
    s_mul_i32 s60, s17, 196608
    s_add_u32 s60, s60, s56
    buffer_load_dwordx4 v14, s[28:31], s60 offen offset:0 lds
    s_waitcnt lgkmcnt(6)
    v_mfma_f32_16x16x32_bf16 v[88:91], v[144:147], a[104:107], v[88:91]
    ds_read_b64_tr_b16 v[164:165], v32 offset:62464
    v_mfma_f32_16x16x32_bf16 v[92:95], a[104:107], v[148:151], v[92:95]
    ds_read_b64_tr_b16 v[166:167], v32 offset:62976
    v_mfma_f32_16x16x32_bf16 v[96:99], v[152:155], a[104:107], v[96:99]
    ds_read_b64_tr_b16 v[168:169], v35 offset:61440
    v_mfma_f32_16x16x32_bf16 v[100:103], a[104:107], v[156:159], v[100:103]
    buffer_load_dwordx4 v15, s[28:31], s60 offen offset:2048 lds
    s_waitcnt lgkmcnt(8)
    v_mfma_f32_16x16x32_bf16 v[104:107], v[144:147], a[168:171], v[104:107]
    ds_read_b64_tr_b16 v[170:171], v35 offset:61952
    v_mfma_f32_16x16x32_bf16 v[108:111], a[168:171], v[148:151], v[108:111]
    ds_read_b64_tr_b16 v[172:173], v35 offset:62464
    v_mfma_f32_16x16x32_bf16 v[112:115], v[152:155], a[168:171], v[112:115]
    ds_read_b64_tr_b16 v[174:175], v35 offset:62976
    v_mfma_f32_16x16x32_bf16 v[116:119], a[168:171], v[156:159], v[116:119]
    s_add_u32 s17, s16, 1
    s_and_b32 s17, s17, 7
    s_add_u32 m0, s57, 1024
    s_mul_i32 s60, s17, 196608
    s_add_u32 s60, s60, s56
    buffer_load_dwordx4 v14, s[28:31], s60 offen offset:0 lds
    s_waitcnt lgkmcnt(10)
    v_mfma_f32_16x16x32_bf16 v[120:123], v[144:147], a[232:235], v[120:123]
    ds_read_b128 a[108:111], v23 offset:35840
    v_mfma_f32_16x16x32_bf16 v[124:127], a[232:235], v[148:151], v[124:127]
    ds_read_b128 a[172:175], v23 offset:38912
    v_mfma_f32_16x16x32_bf16 v[128:131], v[152:155], a[232:235], v[128:131]
    ds_read_b128 a[236:239], v23 offset:39936
    v_mfma_f32_16x16x32_bf16 v[132:135], a[232:235], v[156:159], v[132:135]
    buffer_load_dwordx4 v15, s[28:31], s60 offen offset:2048 lds
    s_waitcnt lgkmcnt(12)
    v_mfma_f32_16x16x32_bf16 v[136:139], v[144:147], v[176:179], v[136:139]
    ds_read_b128 v[180:183], v29 offset:34816
    v_mfma_f32_16x16x32_bf16 v[140:143], v[152:155], v[176:179], v[140:143]
    s_waitcnt lgkmcnt(12)
    s_waitcnt lgkmcnt(10)
    v_mfma_f32_16x16x32_bf16 v[72:75], v[160:163], a[44:47], v[72:75]
    s_waitcnt lgkmcnt(8)
    v_mfma_f32_16x16x32_bf16 v[76:79], a[44:47], v[164:167], v[76:79]
    s_add_u32 s17, s16, 2
    s_and_b32 s17, s17, 7
    s_add_u32 m0, s57, 16384
    s_mul_i32 s60, s17, 196608
    s_add_u32 s60, s60, s56
    buffer_load_dwordx4 v14, s[28:31], s60 offen offset:0 lds
    s_waitcnt lgkmcnt(6)
    v_mfma_f32_16x16x32_bf16 v[80:83], v[168:171], a[44:47], v[80:83]
    s_waitcnt lgkmcnt(4)
    v_mfma_f32_16x16x32_bf16 v[84:87], a[44:47], v[172:175], v[84:87]
    s_waitcnt lgkmcnt(0)
    s_waitcnt vmcnt(14)
    s_barrier
    v_mfma_f32_16x16x32_bf16 v[88:91], v[160:163], a[108:111], v[88:91]
    ds_read_b128 a[48:51], v21 offset:4096
    ds_read_b64_tr_b16 v[144:145], v33 offset:22528
    v_mfma_f32_16x16x32_bf16 v[92:95], a[108:111], v[164:167], v[92:95]
    ds_read_b64_tr_b16 v[146:147], v33 offset:23040
    ds_read_b64_tr_b16 v[148:149], v33 offset:23552
    v_mfma_f32_16x16x32_bf16 v[96:99], v[168:171], a[108:111], v[96:99]
    ds_read_b64_tr_b16 v[150:151], v33 offset:24064
    ds_read_b64_tr_b16 v[152:153], v36 offset:22528
    v_mfma_f32_16x16x32_bf16 v[100:103], a[108:111], v[172:175], v[100:103]
    buffer_load_dwordx4 v15, s[28:31], s60 offen offset:2048 lds
    ds_read_b64_tr_b16 v[154:155], v36 offset:23040
    v_mfma_f32_16x16x32_bf16 v[104:107], v[160:163], a[172:175], v[104:107]
    ds_read_b64_tr_b16 v[156:157], v36 offset:23552
    ds_read_b64_tr_b16 v[158:159], v36 offset:24064
    v_mfma_f32_16x16x32_bf16 v[108:111], a[172:175], v[164:167], v[108:111]
    ds_read_b128 a[112:115], v21 offset:5120
    ds_read_b128 a[176:179], v21 offset:8192
    v_mfma_f32_16x16x32_bf16 v[112:115], v[168:171], a[172:175], v[112:115]
    ds_read_b128 a[240:243], v21 offset:9216
    ds_read_b128 v[176:179], v27 offset:4096
    v_mfma_f32_16x16x32_bf16 v[116:119], a[172:175], v[172:175], v[116:119]
    s_add_u32 s17, s16, 3
    s_and_b32 s17, s17, 7
    s_add_u32 m0, s57, 17408
    s_mul_i32 s60, s17, 196608
    s_add_u32 s60, s60, s56
    buffer_load_dwordx4 v14, s[28:31], s60 offen offset:0 lds
    v_mfma_f32_16x16x32_bf16 v[120:123], v[160:163], a[236:239], v[120:123]
    v_mfma_f32_16x16x32_bf16 v[124:127], a[236:239], v[164:167], v[124:127]
    v_mfma_f32_16x16x32_bf16 v[128:131], v[168:171], a[236:239], v[128:131]
    v_mfma_f32_16x16x32_bf16 v[132:135], a[236:239], v[172:175], v[132:135]
    buffer_load_dwordx4 v15, s[28:31], s60 offen offset:2048 lds
    v_mfma_f32_16x16x32_bf16 v[136:139], v[160:163], v[180:183], v[136:139]
    v_mfma_f32_16x16x32_bf16 v[140:143], v[168:171], v[180:183], v[140:143]
    s_waitcnt lgkmcnt(12)
    s_waitcnt lgkmcnt(10)
    v_mfma_f32_16x16x32_bf16 v[72:75], v[144:147], a[48:51], v[72:75]
    ds_read_b128 a[52:55], v24 offset:4096
    s_waitcnt lgkmcnt(9)
    v_mfma_f32_16x16x32_bf16 v[76:79], a[48:51], v[148:151], v[76:79]
    ds_read_b64_tr_b16 v[160:161], v33 offset:30720
    s_waitcnt lgkmcnt(8)
    v_mfma_f32_16x16x32_bf16 v[80:83], v[152:155], a[48:51], v[80:83]
    ds_read_b64_tr_b16 v[162:163], v33 offset:31232
    s_waitcnt lgkmcnt(7)
    v_mfma_f32_16x16x32_bf16 v[84:87], a[48:51], v[156:159], v[84:87]
    s_add_u32 s17, s16, 4
    s_and_b32 s17, s17, 7
    s_add_u32 m0, s57, 34816
    s_mul_i32 s60, s17, 196608
    s_add_u32 s60, s60, s56
    buffer_load_dwordx4 v14, s[28:31], s60 offen offset:0 lds
    s_waitcnt lgkmcnt(6)
    v_mfma_f32_16x16x32_bf16 v[88:91], v[144:147], a[112:115], v[88:91]
    ds_read_b64_tr_b16 v[164:165], v33 offset:31744
    v_mfma_f32_16x16x32_bf16 v[92:95], a[112:115], v[148:151], v[92:95]
    ds_read_b64_tr_b16 v[166:167], v33 offset:32256
    v_mfma_f32_16x16x32_bf16 v[96:99], v[152:155], a[112:115], v[96:99]
    ds_read_b64_tr_b16 v[168:169], v36 offset:30720
    v_mfma_f32_16x16x32_bf16 v[100:103], a[112:115], v[156:159], v[100:103]
    buffer_load_dwordx4 v15, s[28:31], s60 offen offset:2048 lds
    s_waitcnt lgkmcnt(8)
    v_mfma_f32_16x16x32_bf16 v[104:107], v[144:147], a[176:179], v[104:107]
    ds_read_b64_tr_b16 v[170:171], v36 offset:31232
    v_mfma_f32_16x16x32_bf16 v[108:111], a[176:179], v[148:151], v[108:111]
    ds_read_b64_tr_b16 v[172:173], v36 offset:31744
    v_mfma_f32_16x16x32_bf16 v[112:115], v[152:155], a[176:179], v[112:115]
    ds_read_b64_tr_b16 v[174:175], v36 offset:32256
    v_mfma_f32_16x16x32_bf16 v[116:119], a[176:179], v[156:159], v[116:119]
    s_add_u32 s17, s16, 5
    s_and_b32 s17, s17, 7
    s_add_u32 m0, s57, 35840
    s_mul_i32 s60, s17, 196608
    s_add_u32 s60, s60, s56
    buffer_load_dwordx4 v14, s[28:31], s60 offen offset:0 lds
    s_waitcnt lgkmcnt(10)
    v_mfma_f32_16x16x32_bf16 v[120:123], v[144:147], a[240:243], v[120:123]
    ds_read_b128 a[116:119], v24 offset:5120
    v_mfma_f32_16x16x32_bf16 v[124:127], a[240:243], v[148:151], v[124:127]
    ds_read_b128 a[180:183], v24 offset:8192
    v_mfma_f32_16x16x32_bf16 v[128:131], v[152:155], a[240:243], v[128:131]
    ds_read_b128 a[244:247], v24 offset:9216
    v_mfma_f32_16x16x32_bf16 v[132:135], a[240:243], v[156:159], v[132:135]
    buffer_load_dwordx4 v15, s[28:31], s60 offen offset:2048 lds
    s_waitcnt lgkmcnt(12)
    v_mfma_f32_16x16x32_bf16 v[136:139], v[144:147], v[176:179], v[136:139]
    ds_read_b128 v[180:183], v30 offset:4096
    v_mfma_f32_16x16x32_bf16 v[140:143], v[152:155], v[176:179], v[140:143]
    s_waitcnt lgkmcnt(12)
    s_waitcnt lgkmcnt(10)
    v_mfma_f32_16x16x32_bf16 v[72:75], v[160:163], a[52:55], v[72:75]
    s_waitcnt lgkmcnt(8)
    v_mfma_f32_16x16x32_bf16 v[76:79], a[52:55], v[164:167], v[76:79]
    s_add_u32 s17, s16, 6
    s_and_b32 s17, s17, 7
    s_add_u32 m0, s57, 51200
    s_mul_i32 s60, s17, 196608
    s_add_u32 s60, s60, s56
    buffer_load_dwordx4 v14, s[28:31], s60 offen offset:0 lds
    s_waitcnt lgkmcnt(6)
    v_mfma_f32_16x16x32_bf16 v[80:83], v[168:171], a[52:55], v[80:83]
    s_waitcnt lgkmcnt(4)
    v_mfma_f32_16x16x32_bf16 v[84:87], a[52:55], v[172:175], v[84:87]
    s_waitcnt lgkmcnt(0)
    s_waitcnt vmcnt(13)
    s_barrier
    v_mfma_f32_16x16x32_bf16 v[88:91], v[160:163], a[116:119], v[88:91]
    ds_read_b128 a[56:59], v21 offset:38912
    ds_read_b64_tr_b16 v[144:145], v33 offset:57344
    v_mfma_f32_16x16x32_bf16 v[92:95], a[116:119], v[164:167], v[92:95]
    ds_read_b64_tr_b16 v[146:147], v33 offset:57856
    ds_read_b64_tr_b16 v[148:149], v33 offset:58368
    v_mfma_f32_16x16x32_bf16 v[96:99], v[168:171], a[116:119], v[96:99]
    ds_read_b64_tr_b16 v[150:151], v33 offset:58880
    ds_read_b64_tr_b16 v[152:153], v36 offset:57344
    v_mfma_f32_16x16x32_bf16 v[100:103], a[116:119], v[172:175], v[100:103]
    buffer_load_dwordx4 v15, s[28:31], s60 offen offset:2048 lds
    ds_read_b64_tr_b16 v[154:155], v36 offset:57856
    v_mfma_f32_16x16x32_bf16 v[104:107], v[160:163], a[180:183], v[104:107]
    ds_read_b64_tr_b16 v[156:157], v36 offset:58368
    ds_read_b64_tr_b16 v[158:159], v36 offset:58880
    v_mfma_f32_16x16x32_bf16 v[108:111], a[180:183], v[164:167], v[108:111]
    ds_read_b128 a[120:123], v21 offset:39936
    ds_read_b128 a[184:187], v21 offset:43008
    v_mfma_f32_16x16x32_bf16 v[112:115], v[168:171], a[180:183], v[112:115]
    ds_read_b128 a[248:251], v21 offset:44032
    ds_read_b128 v[176:179], v27 offset:38912
    v_mfma_f32_16x16x32_bf16 v[116:119], a[180:183], v[172:175], v[116:119]
    s_add_u32 s17, s16, 7
    s_and_b32 s17, s17, 7
    s_add_u32 m0, s57, 52224
    s_mul_i32 s60, s17, 196608
    s_add_u32 s60, s60, s56
    buffer_load_dwordx4 v14, s[28:31], s60 offen offset:0 lds
    v_mfma_f32_16x16x32_bf16 v[120:123], v[160:163], a[244:247], v[120:123]
    v_mfma_f32_16x16x32_bf16 v[124:127], a[244:247], v[164:167], v[124:127]
    v_mfma_f32_16x16x32_bf16 v[128:131], v[168:171], a[244:247], v[128:131]
    v_mfma_f32_16x16x32_bf16 v[132:135], a[244:247], v[172:175], v[132:135]
    buffer_load_dwordx4 v15, s[28:31], s60 offen offset:2048 lds
    v_mfma_f32_16x16x32_bf16 v[136:139], v[160:163], v[180:183], v[136:139]
    v_mfma_f32_16x16x32_bf16 v[140:143], v[168:171], v[180:183], v[140:143]
    s_waitcnt lgkmcnt(12)
    s_waitcnt lgkmcnt(10)
    v_mfma_f32_16x16x32_bf16 v[72:75], v[144:147], a[56:59], v[72:75]
    ds_read_b128 a[60:63], v24 offset:38912
    s_waitcnt lgkmcnt(9)
    v_mfma_f32_16x16x32_bf16 v[76:79], a[56:59], v[148:151], v[76:79]
    ds_read_b64_tr_b16 v[160:161], v34 offset:0
    s_waitcnt lgkmcnt(8)
    v_mfma_f32_16x16x32_bf16 v[80:83], v[152:155], a[56:59], v[80:83]
    ds_read_b64_tr_b16 v[162:163], v34 offset:512
    s_waitcnt lgkmcnt(7)
    v_mfma_f32_16x16x32_bf16 v[84:87], a[56:59], v[156:159], v[84:87]
    s_add_u32 m0, s7, 67584
    s_add_u32 s60, s65, 0
    buffer_load_dwordx4 v12, s[40:43], s60 offen offset:0 lds
    s_waitcnt lgkmcnt(6)
    v_mfma_f32_16x16x32_bf16 v[88:91], v[144:147], a[120:123], v[88:91]
    ds_read_b64_tr_b16 v[164:165], v34 offset:1024
    v_mfma_f32_16x16x32_bf16 v[92:95], a[120:123], v[148:151], v[92:95]
    ds_read_b64_tr_b16 v[166:167], v34 offset:1536
    v_mfma_f32_16x16x32_bf16 v[96:99], v[152:155], a[120:123], v[96:99]
    ds_read_b64_tr_b16 v[168:169], v37 offset:0
    v_mfma_f32_16x16x32_bf16 v[100:103], a[120:123], v[156:159], v[100:103]
    buffer_load_dwordx4 v13, s[40:43], s60 offen offset:1024 lds
    s_waitcnt lgkmcnt(8)
    v_mfma_f32_16x16x32_bf16 v[104:107], v[144:147], a[184:187], v[104:107]
    ds_read_b64_tr_b16 v[170:171], v37 offset:512
    v_mfma_f32_16x16x32_bf16 v[108:111], a[184:187], v[148:151], v[108:111]
    ds_read_b64_tr_b16 v[172:173], v37 offset:1024
    v_mfma_f32_16x16x32_bf16 v[112:115], v[152:155], a[184:187], v[112:115]
    ds_read_b64_tr_b16 v[174:175], v37 offset:1536
    v_mfma_f32_16x16x32_bf16 v[116:119], a[184:187], v[156:159], v[116:119]
    buffer_load_dwordx4 v16, s[40:43], s60 offen offset:2048 lds
    s_waitcnt lgkmcnt(10)
    v_mfma_f32_16x16x32_bf16 v[120:123], v[144:147], a[248:251], v[120:123]
    ds_read_b128 a[124:127], v24 offset:39936
    v_mfma_f32_16x16x32_bf16 v[124:127], a[248:251], v[148:151], v[124:127]
    ds_read_b128 a[188:191], v24 offset:43008
    v_mfma_f32_16x16x32_bf16 v[128:131], v[152:155], a[248:251], v[128:131]
    ds_read_b128 a[252:255], v24 offset:44032
    v_mfma_f32_16x16x32_bf16 v[132:135], a[248:251], v[156:159], v[132:135]
    buffer_load_dwordx4 v17, s[40:43], s60 offen offset:3072 lds
    s_waitcnt lgkmcnt(12)
    v_mfma_f32_16x16x32_bf16 v[136:139], v[144:147], v[176:179], v[136:139]
    ds_read_b128 v[180:183], v30 offset:38912
    v_mfma_f32_16x16x32_bf16 v[140:143], v[152:155], v[176:179], v[140:143]
    s_waitcnt lgkmcnt(12)
    s_waitcnt lgkmcnt(10)
    v_mfma_f32_16x16x32_bf16 v[72:75], v[160:163], a[60:63], v[72:75]
    s_waitcnt lgkmcnt(8)
    v_mfma_f32_16x16x32_bf16 v[76:79], a[60:63], v[164:167], v[76:79]
    s_add_u32 m0, s7, 71680
    s_add_u32 s60, s65, 16384
    buffer_load_dwordx4 v12, s[40:43], s60 offen offset:0 lds
    s_waitcnt lgkmcnt(6)
    v_mfma_f32_16x16x32_bf16 v[80:83], v[168:171], a[60:63], v[80:83]
    s_waitcnt lgkmcnt(4)
    v_mfma_f32_16x16x32_bf16 v[84:87], a[60:63], v[172:175], v[84:87]
    s_waitcnt lgkmcnt(0)
    s_waitcnt vmcnt(13)
    s_barrier
    v_mfma_f32_16x16x32_bf16 v[88:91], v[160:163], a[124:127], v[88:91]
    ds_read_b64_tr_b16 v[144:145], v32 offset:0
    ds_read_b64_tr_b16 v[146:147], v32 offset:512
    v_mfma_f32_16x16x32_bf16 v[92:95], a[124:127], v[164:167], v[92:95]
    ds_read_b64_tr_b16 v[148:149], v32 offset:8192
    ds_read_b64_tr_b16 v[150:151], v32 offset:8704
    v_mfma_f32_16x16x32_bf16 v[96:99], v[168:171], a[124:127], v[96:99]
    ds_read_b64_tr_b16 v[152:153], v32 offset:1024
    ds_read_b64_tr_b16 v[154:155], v32 offset:1536
    v_mfma_f32_16x16x32_bf16 v[100:103], a[124:127], v[172:175], v[100:103]
    buffer_load_dwordx4 v13, s[40:43], s60 offen offset:1024 lds
    v_mfma_f32_16x16x32_bf16 v[104:107], v[160:163], a[188:191], v[104:107]
    v_mfma_f32_16x16x32_bf16 v[108:111], a[188:191], v[164:167], v[108:111]
    v_mfma_f32_16x16x32_bf16 v[112:115], v[168:171], a[188:191], v[112:115]
    v_mfma_f32_16x16x32_bf16 v[116:119], a[188:191], v[172:175], v[116:119]
    buffer_load_dwordx4 v16, s[40:43], s60 offen offset:2048 lds
    v_mfma_f32_16x16x32_bf16 v[120:123], v[160:163], a[252:255], v[120:123]
    v_mfma_f32_16x16x32_bf16 v[124:127], a[252:255], v[164:167], v[124:127]
    v_mfma_f32_16x16x32_bf16 v[128:131], v[168:171], a[252:255], v[128:131]
    v_mfma_f32_16x16x32_bf16 v[132:135], a[252:255], v[172:175], v[132:135]
    buffer_load_dwordx4 v17, s[40:43], s60 offen offset:3072 lds
    v_mfma_f32_16x16x32_bf16 v[136:139], v[160:163], v[180:183], v[136:139]
    v_mfma_f32_16x16x32_bf16 v[140:143], v[168:171], v[180:183], v[140:143]
L_q_00:
    s_waitcnt lgkmcnt(4)
    v_mfma_f32_16x16x32_bf16 v[184:187], v[144:147], a[0:3], 0
    ds_read_b64_tr_b16 v[156:157], v32 offset:9216
    ds_read_b64_tr_b16 v[158:159], v32 offset:9728
    v_cvt_pk_bf16_f32 v248, v104, v105
    v_cvt_pk_bf16_f32 v249, v106, v107
    v_mfma_f32_16x16x32_bf16 v[188:191], v[144:147], a[64:67], 0
    v_cvt_pk_bf16_f32 v220, v108, v109
    v_cvt_pk_bf16_f32 v221, v110, v111
    ds_write_b64 v9, v[248:249] offset:0
    ds_write_b64 v9, v[220:221] offset:512
    v_mfma_f32_16x16x32_bf16 v[192:195], v[144:147], a[128:131], 0
    v_cvt_pk_bf16_f32 v250, v112, v113
    v_cvt_pk_bf16_f32 v251, v114, v115
    v_cvt_pk_bf16_f32 v226, v116, v117
    v_cvt_pk_bf16_f32 v227, v118, v119
    v_mfma_f32_16x16x32_bf16 v[196:199], v[144:147], a[192:195], 0
    s_add_u32 m0, s7, 100352
    s_add_u32 s60, s65, 131072
    buffer_load_dwordx4 v12, s[40:43], s60 offen offset:0 lds
    ds_write_b64 v9, v[250:251] offset:1024
    ds_write_b64 v9, v[226:227] offset:1536
    s_waitcnt lgkmcnt(8)
    v_mfma_f32_16x16x32_bf16 v[184:187], v[148:151], a[4:7], v[184:187]
    ds_read_b64_tr_b16 v[160:161], v32 offset:16384
    ds_read_b64_tr_b16 v[162:163], v32 offset:16896
    v_cvt_pk_bf16_f32 v252, v120, v121
    v_cvt_pk_bf16_f32 v253, v122, v123
    v_mfma_f32_16x16x32_bf16 v[188:191], v[148:151], a[68:71], v[188:191]
    v_cvt_pk_bf16_f32 v232, v124, v125
    v_cvt_pk_bf16_f32 v233, v126, v127
    ds_write_b64 v9, v[252:253] offset:2048
    ds_write_b64 v9, v[232:233] offset:2560
    v_mfma_f32_16x16x32_bf16 v[192:195], v[148:151], a[132:135], v[192:195]
    v_cvt_pk_bf16_f32 v254, v128, v129
    v_cvt_pk_bf16_f32 v255, v130, v131
    v_cvt_pk_bf16_f32 v238, v132, v133
    v_cvt_pk_bf16_f32 v239, v134, v135
    v_mfma_f32_16x16x32_bf16 v[196:199], v[148:151], a[196:199], v[196:199]
    buffer_load_dwordx4 v13, s[40:43], s60 offen offset:1024 lds
    ds_write_b64 v9, v[254:255] offset:3072
    ds_write_b64 v9, v[238:239] offset:3584
    v_cvt_pk_bf16_f32 v240, v72, v73
    s_waitcnt lgkmcnt(12)
    v_mfma_f32_16x16x32_bf16 v[184:187], v[152:155], a[8:11], v[184:187]
    ds_read_b64_tr_b16 v[164:165], v32 offset:24576
    ds_read_b64_tr_b16 v[166:167], v32 offset:25088
    v_cvt_pk_bf16_f32 v241, v74, v75
    v_cvt_pk_bf16_f32 v218, v76, v77
    v_mfma_f32_16x16x32_bf16 v[188:191], v[152:155], a[72:75], v[188:191]
    v_cvt_pk_bf16_f32 v219, v78, v79
    v_cvt_pk_bf16_f32 v242, v80, v81
    v_cvt_pk_bf16_f32 v243, v82, v83
    v_cvt_pk_bf16_f32 v224, v84, v85
    v_mfma_f32_16x16x32_bf16 v[192:195], v[152:155], a[136:139], v[192:195]
    v_cvt_pk_bf16_f32 v225, v86, v87
    v_cvt_pk_bf16_f32 v244, v88, v89
    v_cvt_pk_bf16_f32 v245, v90, v91
    v_cvt_pk_bf16_f32 v230, v92, v93
    v_mfma_f32_16x16x32_bf16 v[196:199], v[152:155], a[200:203], v[196:199]
    buffer_load_dwordx4 v16, s[40:43], s60 offen offset:2048 lds
    v_cvt_pk_bf16_f32 v231, v94, v95
    v_cvt_pk_bf16_f32 v246, v96, v97
    v_cvt_pk_bf16_f32 v247, v98, v99
    s_waitcnt lgkmcnt(12)
    v_mfma_f32_16x16x32_bf16 v[184:187], v[156:159], a[12:15], v[184:187]
    ds_read_b64_tr_b16 v[168:169], v32 offset:17408
    ds_read_b64_tr_b16 v[170:171], v32 offset:17920
    v_cvt_pk_bf16_f32 v236, v100, v101
    v_cvt_pk_bf16_f32 v237, v102, v103
    v_mfma_f32_16x16x32_bf16 v[188:191], v[156:159], a[76:79], v[188:191]
    v_cvt_pk_bf16_f32 v176, v136, v137
    v_cvt_pk_bf16_f32 v177, v138, v139
    v_cvt_pk_bf16_f32 v178, v140, v141
    v_cvt_pk_bf16_f32 v179, v142, v143
    v_mfma_f32_16x16x32_bf16 v[192:195], v[156:159], a[140:143], v[192:195]
    v_mfma_f32_16x16x32_bf16 v[196:199], v[156:159], a[204:207], v[196:199]
    buffer_load_dwordx4 v17, s[40:43], s60 offen offset:3072 lds
    s_waitcnt lgkmcnt(8)
    v_mfma_f32_16x16x32_bf16 v[184:187], v[160:163], a[16:19], v[184:187]
    ds_read_b64_tr_b16 v[172:173], v32 offset:25600
    ds_read_b64_tr_b16 v[174:175], v32 offset:26112
    v_mfma_f32_16x16x32_bf16 v[188:191], v[160:163], a[80:83], v[188:191]
    v_mfma_f32_16x16x32_bf16 v[192:195], v[160:163], a[144:147], v[192:195]
    v_mfma_f32_16x16x32_bf16 v[196:199], v[160:163], a[208:211], v[196:199]
    s_add_u32 m0, s7, 104448
    s_add_u32 s60, s65, 147456
    buffer_load_dwordx4 v12, s[40:43], s60 offen offset:0 lds
    s_waitcnt lgkmcnt(0)
    s_waitcnt vmcnt(13)
    s_barrier
    v_mfma_f32_16x16x32_bf16 v[184:187], v[164:167], a[20:23], v[184:187]
    ds_read_b64_tr_b16 v[144:145], v32 offset:34816
    ds_read_b64_tr_b16 v[146:147], v32 offset:35328
    ds_read_b64 v[216:217], v9 offset:4096
    ds_read_b64 v[222:223], v9 offset:4608
    v_mfma_f32_16x16x32_bf16 v[188:191], v[164:167], a[84:87], v[188:191]
    ds_read_b64 v[228:229], v9 offset:4096
    ds_read_b64 v[234:235], v9 offset:4608
    v_mfma_f32_16x16x32_bf16 v[192:195], v[164:167], a[148:151], v[192:195]
    v_mfma_f32_16x16x32_bf16 v[196:199], v[164:167], a[212:215], v[196:199]
    buffer_load_dwordx4 v13, s[40:43], s60 offen offset:1024 lds
    v_mfma_f32_16x16x32_bf16 v[184:187], v[168:171], a[24:27], v[184:187]
    ds_read_b64_tr_b16 v[148:149], v32 offset:43008
    ds_read_b64_tr_b16 v[150:151], v32 offset:43520
    v_mfma_f32_16x16x32_bf16 v[188:191], v[168:171], a[88:91], v[188:191]
    v_mfma_f32_16x16x32_bf16 v[192:195], v[168:171], a[152:155], v[192:195]
    v_mfma_f32_16x16x32_bf16 v[196:199], v[168:171], a[216:219], v[196:199]
    buffer_load_dwordx4 v16, s[40:43], s60 offen offset:2048 lds
    v_mfma_f32_16x16x32_bf16 v[184:187], v[172:175], a[28:31], v[184:187]
    ds_read_b64_tr_b16 v[152:153], v32 offset:35840
    ds_read_b64_tr_b16 v[154:155], v32 offset:36352
    v_mfma_f32_16x16x32_bf16 v[188:191], v[172:175], a[92:95], v[188:191]
    v_mfma_f32_16x16x32_bf16 v[192:195], v[172:175], a[156:159], v[192:195]
    v_mfma_f32_16x16x32_bf16 v[196:199], v[172:175], a[220:223], v[196:199]
    buffer_load_dwordx4 v17, s[40:43], s60 offen offset:3072 lds
    s_waitcnt lgkmcnt(8)
    v_mfma_f32_16x16x32_bf16 v[184:187], v[144:147], a[32:35], v[184:187]
    ds_read_b64_tr_b16 v[156:157], v32 offset:44032
    ds_read_b64_tr_b16 v[158:159], v32 offset:44544
    v_mfma_f32_16x16x32_bf16 v[188:191], v[144:147], a[96:99], v[188:191]
    v_mfma_f32_16x16x32_bf16 v[192:195], v[144:147], a[160:163], v[192:195]
    v_mfma_f32_16x16x32_bf16 v[196:199], v[144:147], a[224:227], v[196:199]
    s_waitcnt lgkmcnt(4)
    v_mfma_f32_16x16x32_bf16 v[184:187], v[148:151], a[36:39], v[184:187]
    ds_read_b64_tr_b16 v[160:161], v32 offset:51200
    ds_read_b64_tr_b16 v[162:163], v32 offset:51712
    v_mfma_f32_16x16x32_bf16 v[188:191], v[148:151], a[100:103], v[188:191]
    v_mfma_f32_16x16x32_bf16 v[192:195], v[148:151], a[164:167], v[192:195]
    v_mfma_f32_16x16x32_bf16 v[196:199], v[148:151], a[228:231], v[196:199]
    s_waitcnt lgkmcnt(4)
    v_mfma_f32_16x16x32_bf16 v[184:187], v[152:155], a[40:43], v[184:187]
    ds_read_b64_tr_b16 v[164:165], v32 offset:59392
    ds_read_b64_tr_b16 v[166:167], v32 offset:59904
    v_mfma_f32_16x16x32_bf16 v[188:191], v[152:155], a[104:107], v[188:191]
    v_mfma_f32_16x16x32_bf16 v[192:195], v[152:155], a[168:171], v[192:195]
    v_mfma_f32_16x16x32_bf16 v[196:199], v[152:155], a[232:235], v[196:199]
    s_waitcnt lgkmcnt(4)
    v_mfma_f32_16x16x32_bf16 v[184:187], v[156:159], a[44:47], v[184:187]
    ds_read_b64_tr_b16 v[168:169], v32 offset:52224
    ds_read_b64_tr_b16 v[170:171], v32 offset:52736
    v_mfma_f32_16x16x32_bf16 v[188:191], v[156:159], a[108:111], v[188:191]
    v_mfma_f32_16x16x32_bf16 v[192:195], v[156:159], a[172:175], v[192:195]
    v_mfma_f32_16x16x32_bf16 v[196:199], v[156:159], a[236:239], v[196:199]
    s_waitcnt lgkmcnt(4)
    v_mfma_f32_16x16x32_bf16 v[184:187], v[160:163], a[48:51], v[184:187]
    ds_read_b64_tr_b16 v[172:173], v32 offset:60416
    ds_read_b64_tr_b16 v[174:175], v32 offset:60928
    v_mfma_f32_16x16x32_bf16 v[188:191], v[160:163], a[112:115], v[188:191]
    v_mfma_f32_16x16x32_bf16 v[192:195], v[160:163], a[176:179], v[192:195]
    v_mfma_f32_16x16x32_bf16 v[196:199], v[160:163], a[240:243], v[196:199]
    s_waitcnt lgkmcnt(4)
    v_mfma_f32_16x16x32_bf16 v[184:187], v[164:167], a[52:55], v[184:187]
    ds_read_b64_tr_b16 v[144:145], v35 offset:0
    ds_read_b64_tr_b16 v[146:147], v35 offset:512
    v_mfma_f32_16x16x32_bf16 v[188:191], v[164:167], a[116:119], v[188:191]
    v_mfma_f32_16x16x32_bf16 v[192:195], v[164:167], a[180:183], v[192:195]
    v_mfma_f32_16x16x32_bf16 v[196:199], v[164:167], a[244:247], v[196:199]
    s_waitcnt lgkmcnt(4)
    v_mfma_f32_16x16x32_bf16 v[184:187], v[168:171], a[56:59], v[184:187]
    ds_read_b64_tr_b16 v[148:149], v35 offset:8192
    ds_read_b64_tr_b16 v[150:151], v35 offset:8704
    v_mfma_f32_16x16x32_bf16 v[188:191], v[168:171], a[120:123], v[188:191]
    v_mfma_f32_16x16x32_bf16 v[192:195], v[168:171], a[184:187], v[192:195]
    v_mfma_f32_16x16x32_bf16 v[196:199], v[168:171], a[248:251], v[196:199]
    s_waitcnt lgkmcnt(4)
    v_mfma_f32_16x16x32_bf16 v[184:187], v[172:175], a[60:63], v[184:187]
    ds_read_b64_tr_b16 v[152:153], v35 offset:1024
    ds_read_b64_tr_b16 v[154:155], v35 offset:1536
    v_mfma_f32_16x16x32_bf16 v[188:191], v[172:175], a[124:127], v[188:191]
    v_mfma_f32_16x16x32_bf16 v[192:195], v[172:175], a[188:191], v[192:195]
    v_mfma_f32_16x16x32_bf16 v[196:199], v[172:175], a[252:255], v[196:199]
    s_waitcnt lgkmcnt(4)
    v_mfma_f32_16x16x32_bf16 v[200:203], v[144:147], a[0:3], 0
    ds_read_b64_tr_b16 v[156:157], v35 offset:9216
    ds_read_b64_tr_b16 v[158:159], v35 offset:9728
    v_mfma_f32_16x16x32_bf16 v[204:207], v[144:147], a[64:67], 0
    v_cvt_pk_bf16_f32 v136, v184, v185
    v_cvt_pk_bf16_f32 v137, v186, v187
    v_mfma_f32_16x16x32_bf16 v[208:211], v[144:147], a[128:131], 0
    v_cvt_pk_bf16_f32 v138, v188, v189
    v_cvt_pk_bf16_f32 v139, v190, v191
    v_mfma_f32_16x16x32_bf16 v[212:215], v[144:147], a[192:195], 0
    v_cvt_pk_bf16_f32 v140, v192, v193
    v_cvt_pk_bf16_f32 v141, v194, v195
    s_waitcnt lgkmcnt(4)
    v_mfma_f32_16x16x32_bf16 v[200:203], v[148:151], a[4:7], v[200:203]
    ds_read_b64_tr_b16 v[160:161], v35 offset:16384
    ds_read_b64_tr_b16 v[162:163], v35 offset:16896
    v_mfma_f32_16x16x32_bf16 v[204:207], v[148:151], a[68:71], v[204:207]
    v_cvt_pk_bf16_f32 v142, v196, v197
    v_cvt_pk_bf16_f32 v143, v198, v199
    v_mfma_f32_16x16x32_bf16 v[208:211], v[148:151], a[132:135], v[208:211]
    v_mfma_f32_16x16x16_bf16 v[72:75], v[240:241], v[136:137], v[48:51]
    v_mfma_f32_16x16x32_bf16 v[212:215], v[148:151], a[196:199], v[212:215]
    v_mfma_f32_16x16x16_bf16 v[76:79], v[176:177], v[136:137], v[56:59]
    v_mfma_f32_16x16x16_bf16 v[84:87], v[244:245], v[138:139], v[48:51]
    s_waitcnt lgkmcnt(4)
    v_mfma_f32_16x16x32_bf16 v[200:203], v[152:155], a[8:11], v[200:203]
    ds_read_b64_tr_b16 v[164:165], v35 offset:24576
    ds_read_b64_tr_b16 v[166:167], v35 offset:25088
    v_mfma_f32_16x16x32_bf16 v[204:207], v[152:155], a[72:75], v[204:207]
    v_mfma_f32_16x16x16_bf16 v[88:91], v[176:177], v[138:139], v[60:63]
    v_mfma_f32_16x16x16_bf16 v[96:99], v[248:249], v[140:141], v[48:51]
    v_mfma_f32_16x16x32_bf16 v[208:211], v[152:155], a[136:139], v[208:211]
    v_mfma_f32_16x16x16_bf16 v[100:103], v[240:241], v[140:141], v[52:55]
    v_mfma_f32_16x16x16_bf16 v[108:111], v[252:253], v[142:143], v[48:51]
    v_mfma_f32_16x16x32_bf16 v[212:215], v[152:155], a[200:203], v[212:215]
    v_mfma_f32_16x16x16_bf16 v[112:115], v[244:245], v[142:143], v[52:55]
    v_max_f32 v72, v72, v76
    s_waitcnt lgkmcnt(4)
    v_mfma_f32_16x16x32_bf16 v[200:203], v[156:159], a[12:15], v[200:203]
    ds_read_b64_tr_b16 v[168:169], v35 offset:17408
    ds_read_b64_tr_b16 v[170:171], v35 offset:17920
    v_mfma_f32_16x16x32_bf16 v[204:207], v[156:159], a[76:79], v[204:207]
    v_max_f32 v73, v73, v77
    v_max_f32 v74, v74, v78
    v_mfma_f32_16x16x32_bf16 v[208:211], v[156:159], a[140:143], v[208:211]
    v_max_f32 v75, v75, v79
    v_max_f32 v84, v84, v88
    v_mfma_f32_16x16x32_bf16 v[212:215], v[156:159], a[204:207], v[212:215]
    v_max_f32 v85, v85, v89
    v_max_f32 v86, v86, v90
    s_waitcnt lgkmcnt(4)
    v_mfma_f32_16x16x32_bf16 v[200:203], v[160:163], a[16:19], v[200:203]
    ds_read_b64_tr_b16 v[172:173], v35 offset:25600
    ds_read_b64_tr_b16 v[174:175], v35 offset:26112
    v_mfma_f32_16x16x32_bf16 v[204:207], v[160:163], a[80:83], v[204:207]
    v_max_f32 v87, v87, v91
    v_max_f32 v96, v96, v100
    v_mfma_f32_16x16x32_bf16 v[208:211], v[160:163], a[144:147], v[208:211]
    v_max_f32 v97, v97, v101
    v_max_f32 v98, v98, v102
    v_mfma_f32_16x16x32_bf16 v[212:215], v[160:163], a[208:211], v[212:215]
    v_max_f32 v99, v99, v103
    v_max_f32 v108, v108, v112
    s_waitcnt lgkmcnt(4)
    v_mfma_f32_16x16x32_bf16 v[200:203], v[164:167], a[20:23], v[200:203]
    ds_read_b64_tr_b16 v[144:145], v35 offset:34816
    ds_read_b64_tr_b16 v[146:147], v35 offset:35328
    v_mfma_f32_16x16x32_bf16 v[204:207], v[164:167], a[84:87], v[204:207]
    v_max_f32 v109, v109, v113
    v_max_f32 v110, v110, v114
    v_mfma_f32_16x16x32_bf16 v[208:211], v[164:167], a[148:151], v[208:211]
    v_max_f32 v111, v111, v115
    v_max3_f32 v76, v72, v73, v74
    v_mfma_f32_16x16x32_bf16 v[212:215], v[164:167], a[212:215], v[212:215]
    v_max3_f32 v88, v84, v85, v86
    v_max3_f32 v100, v96, v97, v98
    s_waitcnt lgkmcnt(4)
    v_mfma_f32_16x16x32_bf16 v[200:203], v[168:171], a[24:27], v[200:203]
    ds_read_b64_tr_b16 v[148:149], v35 offset:43008
    ds_read_b64_tr_b16 v[150:151], v35 offset:43520
    v_mfma_f32_16x16x32_bf16 v[204:207], v[168:171], a[88:91], v[204:207]
    v_max3_f32 v112, v108, v109, v110
    v_max_f32 v76, v76, v75
    v_mfma_f32_16x16x32_bf16 v[208:211], v[168:171], a[152:155], v[208:211]
    v_max_f32 v88, v88, v87
    v_max_f32 v100, v100, v99
    v_mfma_f32_16x16x32_bf16 v[212:215], v[168:171], a[216:219], v[212:215]
    v_max_f32 v112, v112, v111
    v_mov_b32 v77, v76
    s_waitcnt lgkmcnt(4)
    v_mfma_f32_16x16x32_bf16 v[200:203], v[172:175], a[28:31], v[200:203]
    ds_read_b64_tr_b16 v[152:153], v35 offset:35840
    ds_read_b64_tr_b16 v[154:155], v35 offset:36352
    v_mfma_f32_16x16x32_bf16 v[204:207], v[172:175], a[92:95], v[204:207]
    v_mov_b32 v89, v88
    v_mov_b32 v101, v100
    v_mfma_f32_16x16x32_bf16 v[208:211], v[172:175], a[156:159], v[208:211]
    v_mov_b32 v113, v112
    v_permlane32_swap_b32 v76, v77
    v_mfma_f32_16x16x32_bf16 v[212:215], v[172:175], a[220:223], v[212:215]
    v_permlane32_swap_b32 v88, v89
    v_permlane32_swap_b32 v100, v101
    s_waitcnt lgkmcnt(4)
    v_mfma_f32_16x16x32_bf16 v[200:203], v[144:147], a[32:35], v[200:203]
    ds_read_b64_tr_b16 v[156:157], v35 offset:44032
    ds_read_b64_tr_b16 v[158:159], v35 offset:44544
    v_mfma_f32_16x16x32_bf16 v[204:207], v[144:147], a[96:99], v[204:207]
    v_permlane32_swap_b32 v112, v113
    v_max_f32 v76, v76, v77
    v_mfma_f32_16x16x32_bf16 v[208:211], v[144:147], a[160:163], v[208:211]
    v_max_f32 v88, v88, v89
    v_max_f32 v100, v100, v101
    v_mfma_f32_16x16x32_bf16 v[212:215], v[144:147], a[224:227], v[212:215]
    v_max_f32 v112, v112, v113
    v_mov_b32 v77, v76
    s_waitcnt lgkmcnt(4)
    v_mfma_f32_16x16x32_bf16 v[200:203], v[148:151], a[36:39], v[200:203]
    ds_read_b64_tr_b16 v[160:161], v35 offset:51200
    ds_read_b64_tr_b16 v[162:163], v35 offset:51712
    v_mfma_f32_16x16x32_bf16 v[204:207], v[148:151], a[100:103], v[204:207]
    v_mov_b32 v89, v88
    v_mov_b32 v101, v100
    v_mfma_f32_16x16x32_bf16 v[208:211], v[148:151], a[164:167], v[208:211]
    v_mov_b32 v113, v112
    v_permlane16_swap_b32 v76, v77
    v_mfma_f32_16x16x32_bf16 v[212:215], v[148:151], a[228:231], v[212:215]
    v_permlane16_swap_b32 v88, v89
    v_permlane16_swap_b32 v100, v101
    s_waitcnt lgkmcnt(4)
    v_mfma_f32_16x16x32_bf16 v[200:203], v[152:155], a[40:43], v[200:203]
    ds_read_b64_tr_b16 v[164:165], v35 offset:59392
    ds_read_b64_tr_b16 v[166:167], v35 offset:59904
    v_mfma_f32_16x16x32_bf16 v[204:207], v[152:155], a[104:107], v[204:207]
    v_permlane16_swap_b32 v112, v113
    v_max_f32 v76, v76, v77
    v_mfma_f32_16x16x32_bf16 v[208:211], v[152:155], a[168:171], v[208:211]
    v_max_f32 v88, v88, v89
    v_max_f32 v100, v100, v101
    v_mfma_f32_16x16x32_bf16 v[212:215], v[152:155], a[232:235], v[212:215]
    v_max_f32 v112, v112, v113
    v_mul_f32 v76, s62, v76
    s_waitcnt lgkmcnt(4)
    v_mfma_f32_16x16x32_bf16 v[200:203], v[156:159], a[44:47], v[200:203]
    ds_read_b64_tr_b16 v[168:169], v35 offset:52224
    ds_read_b64_tr_b16 v[170:171], v35 offset:52736
    v_mfma_f32_16x16x32_bf16 v[204:207], v[156:159], a[108:111], v[204:207]
    v_mul_f32 v88, s62, v88
    v_mul_f32 v100, s62, v100
    v_mfma_f32_16x16x32_bf16 v[208:211], v[156:159], a[172:175], v[208:211]
    v_mul_f32 v112, s62, v112
    v_pk_fma_f32 v[72:73], v[72:73], s[96:97], v[76:77] op_sel_hi:[1,1,0]
    v_mfma_f32_16x16x32_bf16 v[212:215], v[156:159], a[236:239], v[212:215]
    v_pk_fma_f32 v[74:75], v[74:75], s[96:97], v[76:77] op_sel_hi:[1,1,0]
    v_pk_fma_f32 v[84:85], v[84:85], s[96:97], v[88:89] op_sel_hi:[1,1,0]
    s_waitcnt lgkmcnt(4)
    v_mfma_f32_16x16x32_bf16 v[200:203], v[160:163], a[48:51], v[200:203]
    ds_read_b64_tr_b16 v[172:173], v35 offset:60416
    ds_read_b64_tr_b16 v[174:175], v35 offset:60928
    v_mfma_f32_16x16x32_bf16 v[204:207], v[160:163], a[112:115], v[204:207]
    v_pk_fma_f32 v[86:87], v[86:87], s[96:97], v[88:89] op_sel_hi:[1,1,0]
    v_pk_fma_f32 v[96:97], v[96:97], s[96:97], v[100:101] op_sel_hi:[1,1,0]
    v_mfma_f32_16x16x32_bf16 v[208:211], v[160:163], a[176:179], v[208:211]
    v_pk_fma_f32 v[98:99], v[98:99], s[96:97], v[100:101] op_sel_hi:[1,1,0]
    v_pk_fma_f32 v[108:109], v[108:109], s[96:97], v[112:113] op_sel_hi:[1,1,0]
    v_mfma_f32_16x16x32_bf16 v[212:215], v[160:163], a[240:243], v[212:215]
    v_pk_fma_f32 v[110:111], v[110:111], s[96:97], v[112:113] op_sel_hi:[1,1,0]
    v_exp_f32 v72, v72
    s_waitcnt lgkmcnt(4)
    v_mfma_f32_16x16x32_bf16 v[200:203], v[164:167], a[52:55], v[200:203]
    v_exp_f32 v73, v73
    v_exp_f32 v74, v74
    v_mfma_f32_16x16x32_bf16 v[204:207], v[164:167], a[116:119], v[204:207]
    v_exp_f32 v75, v75
    v_exp_f32 v84, v84
    v_mfma_f32_16x16x32_bf16 v[208:211], v[164:167], a[180:183], v[208:211]
    v_exp_f32 v85, v85
    v_exp_f32 v86, v86
    v_mfma_f32_16x16x32_bf16 v[212:215], v[164:167], a[244:247], v[212:215]
    v_exp_f32 v87, v87
    v_exp_f32 v96, v96
    s_waitcnt lgkmcnt(2)
    v_mfma_f32_16x16x32_bf16 v[200:203], v[168:171], a[56:59], v[200:203]
    v_exp_f32 v97, v97
    v_exp_f32 v98, v98
    v_mfma_f32_16x16x32_bf16 v[204:207], v[168:171], a[120:123], v[204:207]
    v_exp_f32 v99, v99
    v_exp_f32 v108, v108
    v_mfma_f32_16x16x32_bf16 v[208:211], v[168:171], a[184:187], v[208:211]
    v_exp_f32 v109, v109
    v_exp_f32 v110, v110
    v_mfma_f32_16x16x32_bf16 v[212:215], v[168:171], a[248:251], v[212:215]
    v_exp_f32 v111, v111
    v_cvt_pk_bf16_f32 v76, v72, v73
    s_waitcnt lgkmcnt(0)
    v_mfma_f32_16x16x32_bf16 v[200:203], v[172:175], a[60:63], v[200:203]
    v_cvt_pk_bf16_f32 v77, v74, v75
    v_cvt_pk_bf16_f32 v88, v84, v85
    v_mfma_f32_16x16x32_bf16 v[204:207], v[172:175], a[124:127], v[204:207]
    v_cvt_pk_bf16_f32 v89, v86, v87
    v_cvt_pk_bf16_f32 v100, v96, v97
    v_mfma_f32_16x16x32_bf16 v[208:211], v[172:175], a[188:191], v[208:211]
    v_cvt_pk_bf16_f32 v101, v98, v99
    v_cvt_pk_bf16_f32 v112, v108, v109
    v_mfma_f32_16x16x32_bf16 v[212:215], v[172:175], a[252:255], v[212:215]
    v_cvt_pk_bf16_f32 v113, v110, v111
    v_and_b32 v82, v76, v64
    v_and_b32 v83, v77, v65
    v_xor_b32 v80, v76, v82
    v_xor_b32 v81, v77, v83
    v_and_b32 v94, v88, v64
    v_and_b32 v95, v89, v65
    v_xor_b32 v92, v88, v94
    v_xor_b32 v93, v89, v95
    v_and_b32 v106, v100, v64
    v_and_b32 v107, v101, v65
    v_xor_b32 v104, v100, v106
    v_xor_b32 v105, v101, v107
    v_and_b32 v118, v112, v64
    v_and_b32 v119, v113, v65
    v_xor_b32 v116, v112, v118
    v_xor_b32 v117, v113, v119
    v_mfma_f32_16x16x16_bf16 v[184:187], v[66:67], v[76:77], 0
    v_mfma_f32_16x16x16_bf16 v[188:191], v[66:67], v[88:89], 0
    v_mfma_f32_16x16x16_bf16 v[192:195], v[66:67], v[100:101], 0
    v_mfma_f32_16x16x16_bf16 v[196:199], v[66:67], v[112:113], 0
    v_mfma_f32_16x16x32_bf16 v[72:75], v[216:219], v[80:83], 0
    v_mfma_f32_16x16x32_bf16 v[84:87], v[228:231], v[92:95], 0
    v_mfma_f32_16x16x32_bf16 v[96:99], v[218:221], v[104:107], 0
    v_mfma_f32_16x16x32_bf16 v[108:111], v[230:233], v[116:119], 0
    s_nop 0
    v_rcp_f32 v184, v184
    v_rcp_f32 v188, v188
    v_rcp_f32 v192, v192
    v_rcp_f32 v196, v196
    v_pk_mul_f32 v[72:73], v[72:73], v[184:185] op_sel_hi:[1,0]
    v_pk_mul_f32 v[74:75], v[74:75], v[184:185] op_sel_hi:[1,0]
    v_pk_mul_f32 v[84:85], v[84:85], v[188:189] op_sel_hi:[1,0]
    v_pk_mul_f32 v[86:87], v[86:87], v[188:189] op_sel_hi:[1,0]
    v_pk_mul_f32 v[96:97], v[96:97], v[192:193] op_sel_hi:[1,0]
    v_pk_mul_f32 v[98:99], v[98:99], v[192:193] op_sel_hi:[1,0]
    v_pk_mul_f32 v[108:109], v[108:109], v[196:197] op_sel_hi:[1,0]
    v_pk_mul_f32 v[110:111], v[110:111], v[196:197] op_sel_hi:[1,0]
    v_cvt_pk_bf16_f32 v120, v72, v73
    v_cvt_pk_bf16_f32 v121, v74, v75
    v_cvt_pk_bf16_f32 v124, v84, v85
    v_cvt_pk_bf16_f32 v125, v86, v87
    v_cvt_pk_bf16_f32 v128, v96, v97
    v_cvt_pk_bf16_f32 v129, v98, v99
    v_cvt_pk_bf16_f32 v132, v108, v109
    v_cvt_pk_bf16_f32 v133, v110, v111
    s_waitcnt lgkmcnt(0)
    s_waitcnt vmcnt(0)
    s_barrier
    v_cvt_pk_bf16_f32 v136, v200, v201
    v_cvt_pk_bf16_f32 v137, v202, v203
    v_cvt_pk_bf16_f32 v138, v204, v205
    v_cvt_pk_bf16_f32 v139, v206, v207
    v_cvt_pk_bf16_f32 v140, v208, v209
    v_cvt_pk_bf16_f32 v141, v210, v211
    v_cvt_pk_bf16_f32 v142, v212, v213
    v_cvt_pk_bf16_f32 v143, v214, v215
    s_add_u32 m0, s7, 0
    s_add_u32 s60, s65, 262144
    buffer_load_dwordx4 v12, s[40:43], s60 offen offset:0 lds
    v_mfma_f32_16x16x16_bf16 v[72:75], v[242:243], v[136:137], v[48:51]
    v_mfma_f32_16x16x16_bf16 v[76:79], v[178:179], v[136:137], v[56:59]
    v_mfma_f32_16x16x16_bf16 v[84:87], v[246:247], v[138:139], v[48:51]
    v_mfma_f32_16x16x16_bf16 v[88:91], v[178:179], v[138:139], v[60:63]
    v_mfma_f32_16x16x16_bf16 v[96:99], v[250:251], v[140:141], v[48:51]
    v_mfma_f32_16x16x16_bf16 v[100:103], v[242:243], v[140:141], v[52:55]
    v_mfma_f32_16x16x16_bf16 v[108:111], v[254:255], v[142:143], v[48:51]
    v_mfma_f32_16x16x16_bf16 v[112:115], v[246:247], v[142:143], v[52:55]
    s_nop 1
    v_max_f32 v72, v72, v76
    buffer_load_dwordx4 v13, s[40:43], s60 offen offset:1024 lds
    v_max_f32 v73, v73, v77
    v_max_f32 v74, v74, v78
    v_max_f32 v75, v75, v79
    v_max_f32 v84, v84, v88
    v_max_f32 v85, v85, v89
    v_max_f32 v86, v86, v90
    v_max_f32 v87, v87, v91
    v_max_f32 v96, v96, v100
    v_max_f32 v97, v97, v101
    buffer_load_dwordx4 v16, s[40:43], s60 offen offset:2048 lds
    v_max_f32 v98, v98, v102
    v_max_f32 v99, v99, v103
    v_max_f32 v108, v108, v112
    v_max_f32 v109, v109, v113
    v_max_f32 v110, v110, v114
    v_max_f32 v111, v111, v115
    v_max3_f32 v76, v72, v73, v74
    v_max3_f32 v88, v84, v85, v86
    v_max3_f32 v100, v96, v97, v98
    buffer_load_dwordx4 v17, s[40:43], s60 offen offset:3072 lds
    v_max3_f32 v112, v108, v109, v110
    v_max_f32 v76, v76, v75
    v_max_f32 v88, v88, v87
    v_max_f32 v100, v100, v99
    v_max_f32 v112, v112, v111
    v_mov_b32 v77, v76
    v_mov_b32 v89, v88
    v_mov_b32 v101, v100
    v_mov_b32 v113, v112
    s_add_u32 m0, s7, 4096
    s_add_u32 s60, s65, 278528
    buffer_load_dwordx4 v12, s[40:43], s60 offen offset:0 lds
    v_permlane32_swap_b32 v76, v77
    v_permlane32_swap_b32 v88, v89
    v_permlane32_swap_b32 v100, v101
    v_permlane32_swap_b32 v112, v113
    v_max_f32 v76, v76, v77
    v_max_f32 v88, v88, v89
    v_max_f32 v100, v100, v101
    v_max_f32 v112, v112, v113
    v_mov_b32 v77, v76
    buffer_load_dwordx4 v13, s[40:43], s60 offen offset:1024 lds
    v_mov_b32 v89, v88
    v_mov_b32 v101, v100
    v_mov_b32 v113, v112
    v_permlane16_swap_b32 v76, v77
    v_permlane16_swap_b32 v88, v89
    v_permlane16_swap_b32 v100, v101
    v_permlane16_swap_b32 v112, v113
    v_max_f32 v76, v76, v77
    v_max_f32 v88, v88, v89
    buffer_load_dwordx4 v16, s[40:43], s60 offen offset:2048 lds
    v_max_f32 v100, v100, v101
    v_max_f32 v112, v112, v113
    v_mul_f32 v76, s62, v76
    v_mul_f32 v88, s62, v88
    v_mul_f32 v100, s62, v100
    v_mul_f32 v112, s62, v112
    v_pk_fma_f32 v[72:73], v[72:73], s[96:97], v[76:77] op_sel_hi:[1,1,0]
    v_pk_fma_f32 v[74:75], v[74:75], s[96:97], v[76:77] op_sel_hi:[1,1,0]
    v_pk_fma_f32 v[84:85], v[84:85], s[96:97], v[88:89] op_sel_hi:[1,1,0]
    buffer_load_dwordx4 v17, s[40:43], s60 offen offset:3072 lds
    v_pk_fma_f32 v[86:87], v[86:87], s[96:97], v[88:89] op_sel_hi:[1,1,0]
    v_pk_fma_f32 v[96:97], v[96:97], s[96:97], v[100:101] op_sel_hi:[1,1,0]
    v_pk_fma_f32 v[98:99], v[98:99], s[96:97], v[100:101] op_sel_hi:[1,1,0]
    v_pk_fma_f32 v[108:109], v[108:109], s[96:97], v[112:113] op_sel_hi:[1,1,0]
    v_pk_fma_f32 v[110:111], v[110:111], s[96:97], v[112:113] op_sel_hi:[1,1,0]
    v_exp_f32 v72, v72
    v_exp_f32 v73, v73
    v_exp_f32 v74, v74
    v_exp_f32 v75, v75
    s_add_u32 m0, s7, 32768
    s_add_u32 s60, s65, 393216
    buffer_load_dwordx4 v12, s[40:43], s60 offen offset:0 lds
    v_exp_f32 v84, v84
    v_exp_f32 v85, v85
    v_exp_f32 v86, v86
    v_exp_f32 v87, v87
    v_exp_f32 v96, v96
    v_exp_f32 v97, v97
    v_exp_f32 v98, v98
    v_exp_f32 v99, v99
    v_exp_f32 v108, v108
    buffer_load_dwordx4 v13, s[40:43], s60 offen offset:1024 lds
    v_exp_f32 v109, v109
    v_exp_f32 v110, v110
    v_exp_f32 v111, v111
    v_cvt_pk_bf16_f32 v76, v72, v73
    v_cvt_pk_bf16_f32 v77, v74, v75
    v_cvt_pk_bf16_f32 v88, v84, v85
    v_cvt_pk_bf16_f32 v89, v86, v87
    v_cvt_pk_bf16_f32 v100, v96, v97
    v_cvt_pk_bf16_f32 v101, v98, v99
    buffer_load_dwordx4 v16, s[40:43], s60 offen offset:2048 lds
    v_cvt_pk_bf16_f32 v112, v108, v109
    v_cvt_pk_bf16_f32 v113, v110, v111
    v_and_b32 v82, v76, v64
    v_and_b32 v83, v77, v65
    v_xor_b32 v80, v76, v82
    v_xor_b32 v81, v77, v83
    v_and_b32 v94, v88, v64
    v_and_b32 v95, v89, v65
    v_xor_b32 v92, v88, v94
    buffer_load_dwordx4 v17, s[40:43], s60 offen offset:3072 lds
    v_xor_b32 v93, v89, v95
    v_and_b32 v106, v100, v64
    v_and_b32 v107, v101, v65
    v_xor_b32 v104, v100, v106
    v_xor_b32 v105, v101, v107
    v_and_b32 v118, v112, v64
    v_and_b32 v119, v113, v65
    v_xor_b32 v116, v112, v118
    v_xor_b32 v117, v113, v119
    s_add_u32 m0, s7, 36864
    s_add_u32 s60, s65, 409600
    buffer_load_dwordx4 v12, s[40:43], s60 offen offset:0 lds
    v_mfma_f32_16x16x16_bf16 v[200:203], v[66:67], v[76:77], 0
    v_mfma_f32_16x16x16_bf16 v[204:207], v[66:67], v[88:89], 0
    v_mfma_f32_16x16x16_bf16 v[208:211], v[66:67], v[100:101], 0
    v_mfma_f32_16x16x16_bf16 v[212:215], v[66:67], v[112:113], 0
    v_mfma_f32_16x16x32_bf16 v[72:75], v[222:225], v[80:83], 0
    v_mfma_f32_16x16x32_bf16 v[84:87], v[234:237], v[92:95], 0
    v_mfma_f32_16x16x32_bf16 v[96:99], v[224:227], v[104:107], 0
    v_mfma_f32_16x16x32_bf16 v[108:111], v[236:239], v[116:119], 0
    s_nop 0
    v_rcp_f32 v200, v200
    buffer_load_dwordx4 v13, s[40:43], s60 offen offset:1024 lds
    v_rcp_f32 v204, v204
    v_rcp_f32 v208, v208
    v_rcp_f32 v212, v212
    v_pk_mul_f32 v[72:73], v[72:73], v[200:201] op_sel_hi:[1,0]
    v_pk_mul_f32 v[74:75], v[74:75], v[200:201] op_sel_hi:[1,0]
    v_pk_mul_f32 v[84:85], v[84:85], v[204:205] op_sel_hi:[1,0]
    v_pk_mul_f32 v[86:87], v[86:87], v[204:205] op_sel_hi:[1,0]
    v_pk_mul_f32 v[96:97], v[96:97], v[208:209] op_sel_hi:[1,0]
    v_pk_mul_f32 v[98:99], v[98:99], v[208:209] op_sel_hi:[1,0]
    buffer_load_dwordx4 v16, s[40:43], s60 offen offset:2048 lds
    v_pk_mul_f32 v[108:109], v[108:109], v[212:213] op_sel_hi:[1,0]
    v_pk_mul_f32 v[110:111], v[110:111], v[212:213] op_sel_hi:[1,0]
    v_cvt_pk_bf16_f32 v122, v72, v73
    v_cvt_pk_bf16_f32 v123, v74, v75
    v_cvt_pk_bf16_f32 v126, v84, v85
    v_cvt_pk_bf16_f32 v127, v86, v87
    v_cvt_pk_bf16_f32 v130, v96, v97
    v_cvt_pk_bf16_f32 v131, v98, v99
    v_cvt_pk_bf16_f32 v134, v108, v109
    buffer_load_dwordx4 v17, s[40:43], s60 offen offset:3072 lds
    v_cvt_pk_bf16_f32 v135, v110, v111
    s_add_u32 s60, s4, 0
    buffer_store_dwordx4 v[120:123], v46, s[32:35], s60 offen sc1
    s_add_u32 s60, s4, 16384
    buffer_store_dwordx4 v[124:127], v46, s[32:35], s60 offen sc1
    s_add_u32 s60, s4, 32768
    buffer_store_dwordx4 v[128:131], v46, s[32:35], s60 offen sc1
    s_add_u32 s60, s4, 49152
    buffer_store_dwordx4 v[132:135], v46, s[32:35], s60 offen sc1
    s_branch L_phase2
L_path1:
    s_lshl_b32 s58, s48, 4
    s_add_u32 s58, s58, s49
    s_lshl_b32 s13, s58, 7
    s_add_u32 s13, s13, 5242880
    s_lshl_b32 s11, s58, 8
    s_add_u32 s11, s11, 5251072
    s_lshl_b32 s14, s50, 7
    s_add_u32 s14, s14, 5246976
    s_load_dwordx2 s[36:37], s[20:21], s13
    s_lshl_b32 s59, s50, 1
    s_add_u32 s59, s59, s53
    s_lshl_b32 s12, s59, 3
    s_add_u32 s12, s12, s11
    s_add_u32 s12, s12, 128
    s_lshr_b32 s60, s50, 2
    s_lshl_b32 s60, s60, 7
    s_add_u32 s11, s11, s60
    v_lshrrev_b32 v2, 4, v1
    v_and_b32 v3, 15, v1
    v_lshlrev_b32 v5, 1, v2
    v_xor_b32 v5, v3, v5
    v_lshlrev_b32 v6, 10, v2
    v_lshl_add_u32 v12, v5, 4, v6
    v_xor_b32 v6, 128, v12
    v_add_u32 v13, 3072, v6
    v_add_u32 v16, 6144, v12
    v_add_u32 v17, 9216, v6
    v_and_b32 v2, 15, v1
    v_lshrrev_b32 v3, 4, v1
    v_lshrrev_b32 v4, 1, v2
    v_xor_b32 v5, v3, v4
    v_lshlrev_b32 v6, 7, v2
    v_lshl_add_u32 v6, v5, 4, v6
    v_lshrrev_b32 v7, 3, v2
    v_lshl_add_u32 v7, v7, 10, v6
    v_add_u32 v20, 8192, v7
    v_xor_b32 v23, 64, v20
    v_add_u32 v21, 65536, v20
    v_add_u32 v22, 131072, v20
    v_add_u32 v24, 65536, v23
    v_add_u32 v25, 131072, v23
    v_add_u32 v26, 16384, v6
    v_xor_b32 v29, 64, v26
    v_add_u32 v27, 65536, v26
    v_add_u32 v28, 131072, v26
    v_add_u32 v30, 65536, v29
    v_add_u32 v31, 131072, v29
    v_lshrrev_b32 v4, 2, v2
    v_and_b32 v5, 3, v2
    v_lshrrev_b32 v8, 3, v2
    v_and_b32 v7, 1, v3
    v_lshl_or_b32 v8, v7, 1, v8
    v_lshrrev_b32 v6, 1, v3
    v_lshlrev_b32 v6, 12, v6
    v_lshl_add_u32 v6, v7, 11, v6
    v_lshl_add_u32 v6, v4, 7, v6
    v_lshl_add_u32 v6, v5, 3, v6
    s_lshl_b32 s58, s53, 1
    v_xor_b32 v7, s58, v8
    v_lshl_add_u32 v32, v7, 5, v6
    v_xor_b32 v35, 32, v32
    v_add_u32 v33, 65536, v32
    v_add_u32 v34, 131072, v32
    v_add_u32 v36, 65536, v35
    v_add_u32 v37, 131072, v35
    v_lshlrev_b32 v46, 4, v1
    v_lshlrev_b32 v47, 3, v1
    s_mov_b32 s61, 0x3eb8aa3b
    s_mov_b32 s62, 0xbeb8aa3b
    s_mov_b32 s63, 0x3fb8aa3b
    s_mov_b32 s64, 0x358637bd
    s_mov_b32 s71, 300000
    s_mov_b32 s18, 0x3fb8aa3b
    s_mov_b32 s19, 0x3fb8aa3b
    s_mov_b32 s96, 0x3eb8aa3b
    s_mov_b32 s97, 0x3eb8aa3b
    v_mov_b32 v66, 0x3f803f80
    v_mov_b32 v67, 0x3f803f80
    v_mov_b32 v68, 0x3f803f80
    v_mov_b32 v69, 0x3f803f80
    s_lshl_b32 s58, s49, 3
    s_add_u32 s8, s58, 0
    s_add_u32 s4, s8, 4
    s_lshl_b32 s4, s4, 4
    s_add_u32 s4, s4, s59
    s_lshl_b32 s4, s4, 10
    s_lshr_b32 s59, s50, 2
    s_lshl_b32 s59, s59, 2
    s_add_u32 s8, s8, s59
    s_add_u32 s8, s8, s51
    s_lshl_b32 s8, s8, 14
    s_lshl_b32 s7, s51, 13
    s_lshl_b32 s58, s53, 13
    v_add_u32 v9, s58, v47
    v_add_u32 v9, 139264, v9
    v_and_b32 v2, 15, v1
    v_lshrrev_b32 v3, 4, v1
    v_lshlrev_b32 v3, 2, v3
    v_mov_b32 v8, 0xf149f2ca
    v_add_u32 v4, 0, v3
    v_sub_u32 v5, v2, v4
    v_cmp_gt_u32 vcc, 8, v5
    v_mov_b32 v7, 0xffff
    s_nop 0
    v_cndmask_b32 v48, v8, 0, vcc
    v_cndmask_b32 v6, 0, v7, vcc
    v_mov_b32 v64, v6
    v_add_u32 v5, 9, v2
    v_cmp_ge_u32 vcc, v4, v5
    s_nop 1
    v_cndmask_b32 v52, v8, 0, vcc
    v_add_u32 v4, 1, v3
    v_sub_u32 v5, v2, v4
    v_cmp_gt_u32 vcc, 8, v5
    v_mov_b32 v7, 0xffff0000
    s_nop 0
    v_cndmask_b32 v49, v8, 0, vcc
    v_cndmask_b32 v6, 0, v7, vcc
    v_or_b32 v64, v64, v6
    v_add_u32 v5, 9, v2
    v_cmp_ge_u32 vcc, v4, v5
    s_nop 1
    v_cndmask_b32 v53, v8, 0, vcc
    v_add_u32 v4, 2, v3
    v_sub_u32 v5, v2, v4
    v_cmp_gt_u32 vcc, 8, v5
    v_mov_b32 v7, 0xffff
    s_nop 0
    v_cndmask_b32 v50, v8, 0, vcc
    v_cndmask_b32 v6, 0, v7, vcc
    v_mov_b32 v65, v6
    v_add_u32 v5, 9, v2
    v_cmp_ge_u32 vcc, v4, v5
    s_nop 1
    v_cndmask_b32 v54, v8, 0, vcc
    v_add_u32 v4, 3, v3
    v_sub_u32 v5, v2, v4
    v_cmp_gt_u32 vcc, 8, v5
    v_mov_b32 v7, 0xffff0000
    s_nop 0
    v_cndmask_b32 v51, v8, 0, vcc
    v_cndmask_b32 v6, 0, v7, vcc
    v_or_b32 v65, v65, v6
    v_add_u32 v5, 9, v2
    v_cmp_ge_u32 vcc, v4, v5
    s_nop 1
    v_cndmask_b32 v55, v8, 0, vcc
    s_add_u32 s17, s16, 2
    s_and_b32 s17, s17, 7
    s_add_u32 m0, s57, 69632
    s_lshl_b32 s60, s17, 7
    s_add_u32 s60, s60, s54
    buffer_load_dwordx4 v10, s[24:27], s60 offen offset:0 lds
    buffer_load_dwordx4 v10, s[24:27], s60 offen offset:1024 lds
    buffer_load_dwordx4 v11, s[24:27], s60 offen offset:2048 lds
    buffer_load_dwordx4 v11, s[24:27], s60 offen offset:3072 lds
    s_add_u32 m0, s57, 88064
    s_mul_i32 s60, s17, 196608
    s_add_u32 s60, s60, s66
    buffer_load_dwordx4 v14, s[28:31], s60 offen offset:0 lds
    buffer_load_dwordx4 v14, s[28:31], s60 offen offset:1024 lds
    buffer_load_dwordx4 v15, s[28:31], s60 offen offset:2048 lds
    buffer_load_dwordx4 v15, s[28:31], s60 offen offset:3072 lds
    s_add_u32 m0, s67, 86016
    s_lshl_b32 s60, s17, 7
    s_add_u32 s60, s60, s55
    s_mov_b32 exec_hi, 0
    buffer_load_dwordx4 v18, s[24:27], s60 offen lds
    s_mov_b32 exec_hi, -1
    s_waitcnt vmcnt(20)
    s_barrier
    ds_read_b128 a[0:3], v20 offset:0
    ds_read_b64_tr_b16 v[144:145], v32 offset:18432
    ds_read_b64_tr_b16 v[146:147], v32 offset:18944
    ds_read_b64_tr_b16 v[148:149], v32 offset:19456
    ds_read_b64_tr_b16 v[150:151], v32 offset:19968
    ds_read_b64_tr_b16 v[152:153], v35 offset:18432
    ds_read_b64_tr_b16 v[154:155], v35 offset:18944
    ds_read_b64_tr_b16 v[156:157], v35 offset:19456
    ds_read_b64_tr_b16 v[158:159], v35 offset:19968
    ds_read_b128 a[64:67], v20 offset:1024
    ds_read_b128 a[128:131], v20 offset:4096
    ds_read_b128 a[192:195], v20 offset:5120
    ds_read_b128 v[176:179], v26 offset:0
    s_waitcnt lgkmcnt(12)
    s_waitcnt lgkmcnt(10)
    v_mfma_f32_16x16x32_bf16 v[72:75], v[144:147], a[0:3], 0
    ds_read_b128 a[4:7], v23 offset:0
    s_waitcnt lgkmcnt(9)
    v_mfma_f32_16x16x32_bf16 v[76:79], a[0:3], v[148:151], 0
    ds_read_b64_tr_b16 v[160:161], v32 offset:26624
    s_waitcnt lgkmcnt(8)
    v_mfma_f32_16x16x32_bf16 v[80:83], v[152:155], a[0:3], 0
    ds_read_b64_tr_b16 v[162:163], v32 offset:27136
    s_waitcnt lgkmcnt(7)
    v_mfma_f32_16x16x32_bf16 v[84:87], a[0:3], v[156:159], 0
    s_add_u32 s17, s16, 3
    s_and_b32 s17, s17, 7
    s_add_u32 m0, s57, 104448
    s_lshl_b32 s60, s17, 7
    s_add_u32 s60, s60, s54
    buffer_load_dwordx4 v10, s[24:27], s60 offen offset:0 lds
    s_waitcnt lgkmcnt(6)
    v_mfma_f32_16x16x32_bf16 v[88:91], v[144:147], a[64:67], 0
    ds_read_b64_tr_b16 v[164:165], v32 offset:27648
    v_mfma_f32_16x16x32_bf16 v[92:95], a[64:67], v[148:151], 0
    ds_read_b64_tr_b16 v[166:167], v32 offset:28160
    v_mfma_f32_16x16x32_bf16 v[96:99], v[152:155], a[64:67], 0
    ds_read_b64_tr_b16 v[168:169], v35 offset:26624
    v_mfma_f32_16x16x32_bf16 v[100:103], a[64:67], v[156:159], 0
    buffer_load_dwordx4 v10, s[24:27], s60 offen offset:1024 lds
    s_waitcnt lgkmcnt(8)
    v_mfma_f32_16x16x32_bf16 v[104:107], v[144:147], a[128:131], 0
    ds_read_b64_tr_b16 v[170:171], v35 offset:27136
    v_mfma_f32_16x16x32_bf16 v[108:111], a[128:131], v[148:151], 0
    ds_read_b64_tr_b16 v[172:173], v35 offset:27648
    v_mfma_f32_16x16x32_bf16 v[112:115], v[152:155], a[128:131], 0
    ds_read_b64_tr_b16 v[174:175], v35 offset:28160
    v_mfma_f32_16x16x32_bf16 v[116:119], a[128:131], v[156:159], 0
    buffer_load_dwordx4 v11, s[24:27], s60 offen offset:2048 lds
    s_waitcnt lgkmcnt(10)
    v_mfma_f32_16x16x32_bf16 v[120:123], v[144:147], a[192:195], 0
    ds_read_b128 a[68:71], v23 offset:1024
    v_mfma_f32_16x16x32_bf16 v[124:127], a[192:195], v[148:151], 0
    ds_read_b128 a[132:135], v23 offset:4096
    v_mfma_f32_16x16x32_bf16 v[128:131], v[152:155], a[192:195], 0
    ds_read_b128 a[196:199], v23 offset:5120
    v_mfma_f32_16x16x32_bf16 v[132:135], a[192:195], v[156:159], 0
    buffer_load_dwordx4 v11, s[24:27], s60 offen offset:3072 lds
    s_waitcnt lgkmcnt(12)
    v_mfma_f32_16x16x32_bf16 v[136:139], v[176:179], v[148:151], 0
    ds_read_b128 v[180:183], v29 offset:0
    v_mfma_f32_16x16x32_bf16 v[140:143], v[176:179], v[156:159], 0
    s_waitcnt lgkmcnt(12)
    s_waitcnt lgkmcnt(10)
    v_mfma_f32_16x16x32_bf16 v[72:75], v[160:163], a[4:7], v[72:75]
    s_waitcnt lgkmcnt(8)
    v_mfma_f32_16x16x32_bf16 v[76:79], a[4:7], v[164:167], v[76:79]
    s_add_u32 m0, s57, 122880
    s_mul_i32 s60, s17, 196608
    s_add_u32 s60, s60, s66
    buffer_load_dwordx4 v14, s[28:31], s60 offen offset:0 lds
    s_waitcnt lgkmcnt(6)
    v_mfma_f32_16x16x32_bf16 v[80:83], v[168:171], a[4:7], v[80:83]
    s_waitcnt lgkmcnt(4)
    v_mfma_f32_16x16x32_bf16 v[84:87], a[4:7], v[172:175], v[84:87]
    s_waitcnt lgkmcnt(0)
    s_waitcnt vmcnt(16)
    s_barrier
    v_mfma_f32_16x16x32_bf16 v[88:91], v[160:163], a[68:71], v[88:91]
    ds_read_b128 a[8:11], v20 offset:34816
    ds_read_b64_tr_b16 v[144:145], v32 offset:53248
    v_mfma_f32_16x16x32_bf16 v[92:95], a[68:71], v[164:167], v[92:95]
    ds_read_b64_tr_b16 v[146:147], v32 offset:53760
    ds_read_b64_tr_b16 v[148:149], v32 offset:54272
    v_mfma_f32_16x16x32_bf16 v[96:99], v[168:171], a[68:71], v[96:99]
    ds_read_b64_tr_b16 v[150:151], v32 offset:54784
    ds_read_b64_tr_b16 v[152:153], v35 offset:53248
    v_mfma_f32_16x16x32_bf16 v[100:103], a[68:71], v[172:175], v[100:103]
    buffer_load_dwordx4 v14, s[28:31], s60 offen offset:1024 lds
    ds_read_b64_tr_b16 v[154:155], v35 offset:53760
    v_mfma_f32_16x16x32_bf16 v[104:107], v[160:163], a[132:135], v[104:107]
    ds_read_b64_tr_b16 v[156:157], v35 offset:54272
    ds_read_b64_tr_b16 v[158:159], v35 offset:54784
    v_mfma_f32_16x16x32_bf16 v[108:111], a[132:135], v[164:167], v[108:111]
    ds_read_b128 a[72:75], v20 offset:35840
    ds_read_b128 a[136:139], v20 offset:38912
    v_mfma_f32_16x16x32_bf16 v[112:115], v[168:171], a[132:135], v[112:115]
    ds_read_b128 a[200:203], v20 offset:39936
    ds_read_b128 v[176:179], v26 offset:34816
    v_mfma_f32_16x16x32_bf16 v[116:119], a[132:135], v[172:175], v[116:119]
    buffer_load_dwordx4 v15, s[28:31], s60 offen offset:2048 lds
    v_mfma_f32_16x16x32_bf16 v[120:123], v[160:163], a[196:199], v[120:123]
    v_mfma_f32_16x16x32_bf16 v[124:127], a[196:199], v[164:167], v[124:127]
    v_mfma_f32_16x16x32_bf16 v[128:131], v[168:171], a[196:199], v[128:131]
    v_mfma_f32_16x16x32_bf16 v[132:135], a[196:199], v[172:175], v[132:135]
    buffer_load_dwordx4 v15, s[28:31], s60 offen offset:3072 lds
    v_mfma_f32_16x16x32_bf16 v[136:139], v[180:183], v[164:167], v[136:139]
    v_mfma_f32_16x16x32_bf16 v[140:143], v[180:183], v[172:175], v[140:143]
    s_waitcnt lgkmcnt(12)
    s_waitcnt lgkmcnt(10)
    v_mfma_f32_16x16x32_bf16 v[72:75], v[144:147], a[8:11], v[72:75]
    ds_read_b128 a[12:15], v23 offset:34816
    s_waitcnt lgkmcnt(9)
    v_mfma_f32_16x16x32_bf16 v[76:79], a[8:11], v[148:151], v[76:79]
    ds_read_b64_tr_b16 v[160:161], v32 offset:61440
    s_waitcnt lgkmcnt(8)
    v_mfma_f32_16x16x32_bf16 v[80:83], v[152:155], a[8:11], v[80:83]
    ds_read_b64_tr_b16 v[162:163], v32 offset:61952
    s_waitcnt lgkmcnt(7)
    v_mfma_f32_16x16x32_bf16 v[84:87], a[8:11], v[156:159], v[84:87]
    s_add_u32 m0, s67, 120832
    s_lshl_b32 s60, s17, 7
    s_add_u32 s60, s60, s55
    s_mov_b32 exec_hi, 0
    buffer_load_dwordx4 v18, s[24:27], s60 offen lds
    s_mov_b32 exec_hi, -1
    s_waitcnt lgkmcnt(6)
    v_mfma_f32_16x16x32_bf16 v[88:91], v[144:147], a[72:75], v[88:91]
    ds_read_b64_tr_b16 v[164:165], v32 offset:62464
    v_mfma_f32_16x16x32_bf16 v[92:95], a[72:75], v[148:151], v[92:95]
    ds_read_b64_tr_b16 v[166:167], v32 offset:62976
    v_mfma_f32_16x16x32_bf16 v[96:99], v[152:155], a[72:75], v[96:99]
    ds_read_b64_tr_b16 v[168:169], v35 offset:61440
    v_mfma_f32_16x16x32_bf16 v[100:103], a[72:75], v[156:159], v[100:103]
    s_add_u32 s17, s16, 4
    s_and_b32 s17, s17, 7
    s_add_u32 m0, s57, 0
    s_lshl_b32 s60, s17, 7
    s_add_u32 s60, s60, s54
    buffer_load_dwordx4 v10, s[24:27], s60 offen offset:0 lds
    s_waitcnt lgkmcnt(8)
    v_mfma_f32_16x16x32_bf16 v[104:107], v[144:147], a[136:139], v[104:107]
    ds_read_b64_tr_b16 v[170:171], v35 offset:61952
    v_mfma_f32_16x16x32_bf16 v[108:111], a[136:139], v[148:151], v[108:111]
    ds_read_b64_tr_b16 v[172:173], v35 offset:62464
    v_mfma_f32_16x16x32_bf16 v[112:115], v[152:155], a[136:139], v[112:115]
    ds_read_b64_tr_b16 v[174:175], v35 offset:62976
    v_mfma_f32_16x16x32_bf16 v[116:119], a[136:139], v[156:159], v[116:119]
    buffer_load_dwordx4 v10, s[24:27], s60 offen offset:1024 lds
    s_waitcnt lgkmcnt(10)
    v_mfma_f32_16x16x32_bf16 v[120:123], v[144:147], a[200:203], v[120:123]
    ds_read_b128 a[76:79], v23 offset:35840
    v_mfma_f32_16x16x32_bf16 v[124:127], a[200:203], v[148:151], v[124:127]
    ds_read_b128 a[140:143], v23 offset:38912
    v_mfma_f32_16x16x32_bf16 v[128:131], v[152:155], a[200:203], v[128:131]
    ds_read_b128 a[204:207], v23 offset:39936
    v_mfma_f32_16x16x32_bf16 v[132:135], a[200:203], v[156:159], v[132:135]
    buffer_load_dwordx4 v11, s[24:27], s60 offen offset:2048 lds
    s_waitcnt lgkmcnt(12)
    v_mfma_f32_16x16x32_bf16 v[136:139], v[176:179], v[148:151], v[136:139]
    ds_read_b128 v[180:183], v29 offset:34816
    v_mfma_f32_16x16x32_bf16 v[140:143], v[176:179], v[156:159], v[140:143]
    s_waitcnt lgkmcnt(12)
    s_waitcnt lgkmcnt(10)
    v_mfma_f32_16x16x32_bf16 v[72:75], v[160:163], a[12:15], v[72:75]
    s_waitcnt lgkmcnt(8)
    v_mfma_f32_16x16x32_bf16 v[76:79], a[12:15], v[164:167], v[76:79]
    buffer_load_dwordx4 v11, s[24:27], s60 offen offset:3072 lds
    s_waitcnt lgkmcnt(6)
    v_mfma_f32_16x16x32_bf16 v[80:83], v[168:171], a[12:15], v[80:83]
    s_waitcnt lgkmcnt(4)
    v_mfma_f32_16x16x32_bf16 v[84:87], a[12:15], v[172:175], v[84:87]
    s_waitcnt lgkmcnt(0)
    s_waitcnt vmcnt(13)
    s_barrier
    v_mfma_f32_16x16x32_bf16 v[88:91], v[160:163], a[76:79], v[88:91]
    ds_read_b128 a[16:19], v21 offset:4096
    ds_read_b64_tr_b16 v[144:145], v33 offset:22528
    v_mfma_f32_16x16x32_bf16 v[92:95], a[76:79], v[164:167], v[92:95]
    ds_read_b64_tr_b16 v[146:147], v33 offset:23040
    ds_read_b64_tr_b16 v[148:149], v33 offset:23552
    v_mfma_f32_16x16x32_bf16 v[96:99], v[168:171], a[76:79], v[96:99]
    ds_read_b64_tr_b16 v[150:151], v33 offset:24064
    ds_read_b64_tr_b16 v[152:153], v36 offset:22528
    v_mfma_f32_16x16x32_bf16 v[100:103], a[76:79], v[172:175], v[100:103]
    s_add_u32 m0, s57, 18432
    s_mul_i32 s60, s17, 196608
    s_add_u32 s60, s60, s66
    buffer_load_dwordx4 v14, s[28:31], s60 offen offset:0 lds
    v_mfma_f32_16x16x32_bf16 v[104:107], v[160:163], a[140:143], v[104:107]
    ds_read_b64_tr_b16 v[154:155], v36 offset:23040
    ds_read_b64_tr_b16 v[156:157], v36 offset:23552
    v_mfma_f32_16x16x32_bf16 v[108:111], a[140:143], v[164:167], v[108:111]
    ds_read_b64_tr_b16 v[158:159], v36 offset:24064
    ds_read_b128 a[80:83], v21 offset:5120
    v_mfma_f32_16x16x32_bf16 v[112:115], v[168:171], a[140:143], v[112:115]
    ds_read_b128 a[144:147], v21 offset:8192
    ds_read_b128 a[208:211], v21 offset:9216
    v_mfma_f32_16x16x32_bf16 v[116:119], a[140:143], v[172:175], v[116:119]
    buffer_load_dwordx4 v14, s[28:31], s60 offen offset:1024 lds
    ds_read_b128 v[176:179], v27 offset:4096
    v_mfma_f32_16x16x32_bf16 v[120:123], v[160:163], a[204:207], v[120:123]
    v_mfma_f32_16x16x32_bf16 v[124:127], a[204:207], v[164:167], v[124:127]
    v_mfma_f32_16x16x32_bf16 v[128:131], v[168:171], a[204:207], v[128:131]
    v_mfma_f32_16x16x32_bf16 v[132:135], a[204:207], v[172:175], v[132:135]
    buffer_load_dwordx4 v15, s[28:31], s60 offen offset:2048 lds
    v_mfma_f32_16x16x32_bf16 v[136:139], v[180:183], v[164:167], v[136:139]
    v_mfma_f32_16x16x32_bf16 v[140:143], v[180:183], v[172:175], v[140:143]
    s_waitcnt lgkmcnt(12)
    s_waitcnt lgkmcnt(10)
    v_mfma_f32_16x16x32_bf16 v[72:75], v[144:147], a[16:19], v[72:75]
    ds_read_b128 a[20:23], v24 offset:4096
    s_waitcnt lgkmcnt(9)
    v_mfma_f32_16x16x32_bf16 v[76:79], a[16:19], v[148:151], v[76:79]
    buffer_load_dwordx4 v15, s[28:31], s60 offen offset:3072 lds
    s_waitcnt lgkmcnt(7)
    v_mfma_f32_16x16x32_bf16 v[80:83], v[152:155], a[16:19], v[80:83]
    ds_read_b64_tr_b16 v[160:161], v33 offset:30720
    s_waitcnt lgkmcnt(6)
    v_mfma_f32_16x16x32_bf16 v[84:87], a[16:19], v[156:159], v[84:87]
    s_add_u32 m0, s67, 16384
    s_lshl_b32 s60, s17, 7
    s_add_u32 s60, s60, s55
    s_mov_b32 exec_hi, 0
    buffer_load_dwordx4 v18, s[24:27], s60 offen lds
    s_mov_b32 exec_hi, -1
    s_waitcnt lgkmcnt(5)
    v_mfma_f32_16x16x32_bf16 v[88:91], v[144:147], a[80:83], v[88:91]
    ds_read_b64_tr_b16 v[162:163], v33 offset:31232
    v_mfma_f32_16x16x32_bf16 v[92:95], a[80:83], v[148:151], v[92:95]
    s_add_u32 s17, s16, 5
    s_and_b32 s17, s17, 7
    s_add_u32 m0, s57, 34816
    s_lshl_b32 s60, s17, 7
    s_add_u32 s60, s60, s54
    buffer_load_dwordx4 v10, s[24:27], s60 offen offset:0 lds
    v_mfma_f32_16x16x32_bf16 v[96:99], v[152:155], a[80:83], v[96:99]
    ds_read_b64_tr_b16 v[164:165], v33 offset:31744
    v_mfma_f32_16x16x32_bf16 v[100:103], a[80:83], v[156:159], v[100:103]
    buffer_load_dwordx4 v10, s[24:27], s60 offen offset:1024 lds
    s_waitcnt lgkmcnt(6)
    v_mfma_f32_16x16x32_bf16 v[104:107], v[144:147], a[144:147], v[104:107]
    ds_read_b64_tr_b16 v[166:167], v33 offset:32256
    v_mfma_f32_16x16x32_bf16 v[108:111], a[144:147], v[148:151], v[108:111]
    buffer_load_dwordx4 v11, s[24:27], s60 offen offset:2048 lds
    v_mfma_f32_16x16x32_bf16 v[112:115], v[152:155], a[144:147], v[112:115]
    ds_read_b64_tr_b16 v[168:169], v36 offset:30720
    v_mfma_f32_16x16x32_bf16 v[116:119], a[144:147], v[156:159], v[116:119]
    buffer_load_dwordx4 v11, s[24:27], s60 offen offset:3072 lds
    s_waitcnt lgkmcnt(7)
    v_mfma_f32_16x16x32_bf16 v[120:123], v[144:147], a[208:211], v[120:123]
    ds_read_b64_tr_b16 v[170:171], v36 offset:31232
    v_mfma_f32_16x16x32_bf16 v[124:127], a[208:211], v[148:151], v[124:127]
    s_add_u32 m0, s57, 53248
    s_mul_i32 s60, s17, 196608
    s_add_u32 s60, s60, s66
    buffer_load_dwordx4 v14, s[28:31], s60 offen offset:0 lds
    v_mfma_f32_16x16x32_bf16 v[128:131], v[152:155], a[208:211], v[128:131]
    ds_read_b64_tr_b16 v[172:173], v36 offset:31744
    v_mfma_f32_16x16x32_bf16 v[132:135], a[208:211], v[156:159], v[132:135]
    buffer_load_dwordx4 v14, s[28:31], s60 offen offset:1024 lds
    s_waitcnt lgkmcnt(8)
    v_mfma_f32_16x16x32_bf16 v[136:139], v[176:179], v[148:151], v[136:139]
    ds_read_b64_tr_b16 v[174:175], v36 offset:32256
    v_mfma_f32_16x16x32_bf16 v[140:143], v[176:179], v[156:159], v[140:143]
    buffer_load_dwordx4 v15, s[28:31], s60 offen offset:2048 lds
    ds_read_b128 a[84:87], v24 offset:5120
    ds_read_b128 a[148:151], v24 offset:8192
    ds_read_b128 a[212:215], v24 offset:9216
    ds_read_b128 v[180:183], v30 offset:4096
    s_waitcnt lgkmcnt(12)
    s_waitcnt lgkmcnt(10)
    v_mfma_f32_16x16x32_bf16 v[72:75], v[160:163], a[20:23], v[72:75]
    s_waitcnt lgkmcnt(8)
    v_mfma_f32_16x16x32_bf16 v[76:79], a[20:23], v[164:167], v[76:79]
    buffer_load_dwordx4 v15, s[28:31], s60 offen offset:3072 lds
    s_waitcnt lgkmcnt(6)
    v_mfma_f32_16x16x32_bf16 v[80:83], v[168:171], a[20:23], v[80:83]
    s_waitcnt lgkmcnt(4)
    v_mfma_f32_16x16x32_bf16 v[84:87], a[20:23], v[172:175], v[84:87]
    s_waitcnt lgkmcnt(0)
    s_waitcnt vmcnt(17)
    s_barrier
    v_mfma_f32_16x16x32_bf16 v[88:91], v[160:163], a[84:87], v[88:91]
    ds_read_b128 a[24:27], v21 offset:38912
    ds_read_b64_tr_b16 v[144:145], v33 offset:57344
    v_mfma_f32_16x16x32_bf16 v[92:95], a[84:87], v[164:167], v[92:95]
    ds_read_b64_tr_b16 v[146:147], v33 offset:57856
    ds_read_b64_tr_b16 v[148:149], v33 offset:58368
    v_mfma_f32_16x16x32_bf16 v[96:99], v[168:171], a[84:87], v[96:99]
    ds_read_b64_tr_b16 v[150:151], v33 offset:58880
    ds_read_b64_tr_b16 v[152:153], v36 offset:57344
    v_mfma_f32_16x16x32_bf16 v[100:103], a[84:87], v[172:175], v[100:103]
    s_add_u32 m0, s67, 51200
    s_lshl_b32 s60, s17, 7
    s_add_u32 s60, s60, s55
    s_mov_b32 exec_hi, 0
    buffer_load_dwordx4 v18, s[24:27], s60 offen lds
    s_mov_b32 exec_hi, -1
    v_mfma_f32_16x16x32_bf16 v[104:107], v[160:163], a[148:151], v[104:107]
    ds_read_b64_tr_b16 v[154:155], v36 offset:57856
    ds_read_b64_tr_b16 v[156:157], v36 offset:58368
    v_mfma_f32_16x16x32_bf16 v[108:111], a[148:151], v[164:167], v[108:111]
    ds_read_b64_tr_b16 v[158:159], v36 offset:58880
    ds_read_b128 a[88:91], v21 offset:39936
    v_mfma_f32_16x16x32_bf16 v[112:115], v[168:171], a[148:151], v[112:115]
    ds_read_b128 a[152:155], v21 offset:43008
    ds_read_b128 a[216:219], v21 offset:44032
    v_mfma_f32_16x16x32_bf16 v[116:119], a[148:151], v[172:175], v[116:119]
    s_add_u32 s17, s16, 6
    s_and_b32 s17, s17, 7
    s_add_u32 m0, s57, 69632
    s_lshl_b32 s60, s17, 7
    s_add_u32 s60, s60, s54
    buffer_load_dwordx4 v10, s[24:27], s60 offen offset:0 lds
    v_mfma_f32_16x16x32_bf16 v[120:123], v[160:163], a[212:215], v[120:123]
    ds_read_b128 v[176:179], v27 offset:38912
    v_mfma_f32_16x16x32_bf16 v[124:127], a[212:215], v[164:167], v[124:127]
    v_mfma_f32_16x16x32_bf16 v[128:131], v[168:171], a[212:215], v[128:131]
    v_mfma_f32_16x16x32_bf16 v[132:135], a[212:215], v[172:175], v[132:135]
    buffer_load_dwordx4 v10, s[24:27], s60 offen offset:1024 lds
    v_mfma_f32_16x16x32_bf16 v[136:139], v[180:183], v[164:167], v[136:139]
    v_mfma_f32_16x16x32_bf16 v[140:143], v[180:183], v[172:175], v[140:143]
    s_waitcnt lgkmcnt(12)
    s_waitcnt lgkmcnt(10)
    v_mfma_f32_16x16x32_bf16 v[72:75], v[144:147], a[24:27], v[72:75]
    ds_read_b128 a[28:31], v24 offset:38912
    s_waitcnt lgkmcnt(9)
    v_mfma_f32_16x16x32_bf16 v[76:79], a[24:27], v[148:151], v[76:79]
    ds_read_b64_tr_b16 v[160:161], v34 offset:0
    s_waitcnt lgkmcnt(8)
    v_mfma_f32_16x16x32_bf16 v[80:83], v[152:155], a[24:27], v[80:83]
    ds_read_b64_tr_b16 v[162:163], v34 offset:512
    s_waitcnt lgkmcnt(7)
    v_mfma_f32_16x16x32_bf16 v[84:87], a[24:27], v[156:159], v[84:87]
    buffer_load_dwordx4 v11, s[24:27], s60 offen offset:2048 lds
    s_waitcnt lgkmcnt(6)
    v_mfma_f32_16x16x32_bf16 v[88:91], v[144:147], a[88:91], v[88:91]
    ds_read_b64_tr_b16 v[164:165], v34 offset:1024
    v_mfma_f32_16x16x32_bf16 v[92:95], a[88:91], v[148:151], v[92:95]
    ds_read_b64_tr_b16 v[166:167], v34 offset:1536
    v_mfma_f32_16x16x32_bf16 v[96:99], v[152:155], a[88:91], v[96:99]
    ds_read_b64_tr_b16 v[168:169], v37 offset:0
    v_mfma_f32_16x16x32_bf16 v[100:103], a[88:91], v[156:159], v[100:103]
    buffer_load_dwordx4 v11, s[24:27], s60 offen offset:3072 lds
    s_waitcnt lgkmcnt(8)
    v_mfma_f32_16x16x32_bf16 v[104:107], v[144:147], a[152:155], v[104:107]
    ds_read_b64_tr_b16 v[170:171], v37 offset:512
    v_mfma_f32_16x16x32_bf16 v[108:111], a[152:155], v[148:151], v[108:111]
    ds_read_b64_tr_b16 v[172:173], v37 offset:1024
    v_mfma_f32_16x16x32_bf16 v[112:115], v[152:155], a[152:155], v[112:115]
    ds_read_b64_tr_b16 v[174:175], v37 offset:1536
    v_mfma_f32_16x16x32_bf16 v[116:119], a[152:155], v[156:159], v[116:119]
    s_add_u32 m0, s57, 88064
    s_mul_i32 s60, s17, 196608
    s_add_u32 s60, s60, s66
    buffer_load_dwordx4 v14, s[28:31], s60 offen offset:0 lds
    s_waitcnt lgkmcnt(10)
    v_mfma_f32_16x16x32_bf16 v[120:123], v[144:147], a[216:219], v[120:123]
    ds_read_b128 a[92:95], v24 offset:39936
    v_mfma_f32_16x16x32_bf16 v[124:127], a[216:219], v[148:151], v[124:127]
    ds_read_b128 a[156:159], v24 offset:43008
    v_mfma_f32_16x16x32_bf16 v[128:131], v[152:155], a[216:219], v[128:131]
    ds_read_b128 a[220:223], v24 offset:44032
    v_mfma_f32_16x16x32_bf16 v[132:135], a[216:219], v[156:159], v[132:135]
    buffer_load_dwordx4 v14, s[28:31], s60 offen offset:1024 lds
    s_waitcnt lgkmcnt(12)
    v_mfma_f32_16x16x32_bf16 v[136:139], v[176:179], v[148:151], v[136:139]
    ds_read_b128 v[180:183], v30 offset:38912
    v_mfma_f32_16x16x32_bf16 v[140:143], v[176:179], v[156:159], v[140:143]
    s_waitcnt lgkmcnt(12)
    s_waitcnt lgkmcnt(10)
    v_mfma_f32_16x16x32_bf16 v[72:75], v[160:163], a[28:31], v[72:75]
    s_waitcnt lgkmcnt(8)
    v_mfma_f32_16x16x32_bf16 v[76:79], a[28:31], v[164:167], v[76:79]
    buffer_load_dwordx4 v15, s[28:31], s60 offen offset:2048 lds
    s_waitcnt lgkmcnt(6)
    v_mfma_f32_16x16x32_bf16 v[80:83], v[168:171], a[28:31], v[80:83]
    s_waitcnt lgkmcnt(4)
    v_mfma_f32_16x16x32_bf16 v[84:87], a[28:31], v[172:175], v[84:87]
    s_waitcnt lgkmcnt(0)
    s_waitcnt vmcnt(16)
    s_barrier
    v_mfma_f32_16x16x32_bf16 v[88:91], v[160:163], a[92:95], v[88:91]
    ds_read_b128 a[32:35], v20 offset:0
    ds_read_b64_tr_b16 v[144:145], v32 offset:18432
    v_mfma_f32_16x16x32_bf16 v[92:95], a[92:95], v[164:167], v[92:95]
    ds_read_b64_tr_b16 v[146:147], v32 offset:18944
    ds_read_b64_tr_b16 v[148:149], v32 offset:19456
    v_mfma_f32_16x16x32_bf16 v[96:99], v[168:171], a[92:95], v[96:99]
    ds_read_b64_tr_b16 v[150:151], v32 offset:19968
    ds_read_b64_tr_b16 v[152:153], v35 offset:18432
    v_mfma_f32_16x16x32_bf16 v[100:103], a[92:95], v[172:175], v[100:103]
    buffer_load_dwordx4 v15, s[28:31], s60 offen offset:3072 lds
    ds_read_b64_tr_b16 v[154:155], v35 offset:18944
    v_mfma_f32_16x16x32_bf16 v[104:107], v[160:163], a[156:159], v[104:107]
    ds_read_b64_tr_b16 v[156:157], v35 offset:19456
    ds_read_b64_tr_b16 v[158:159], v35 offset:19968
    v_mfma_f32_16x16x32_bf16 v[108:111], a[156:159], v[164:167], v[108:111]
    ds_read_b128 a[96:99], v20 offset:1024
    ds_read_b128 a[160:163], v20 offset:4096
    v_mfma_f32_16x16x32_bf16 v[112:115], v[168:171], a[156:159], v[112:115]
    ds_read_b128 a[224:227], v20 offset:5120
    ds_read_b128 v[176:179], v26 offset:0
    v_mfma_f32_16x16x32_bf16 v[116:119], a[156:159], v[172:175], v[116:119]
    s_add_u32 m0, s67, 86016
    s_lshl_b32 s60, s17, 7
    s_add_u32 s60, s60, s55
    s_mov_b32 exec_hi, 0
    buffer_load_dwordx4 v18, s[24:27], s60 offen lds
    s_mov_b32 exec_hi, -1
    v_mfma_f32_16x16x32_bf16 v[120:123], v[160:163], a[220:223], v[120:123]
    v_mfma_f32_16x16x32_bf16 v[124:127], a[220:223], v[164:167], v[124:127]
    v_mfma_f32_16x16x32_bf16 v[128:131], v[168:171], a[220:223], v[128:131]
    v_mfma_f32_16x16x32_bf16 v[132:135], a[220:223], v[172:175], v[132:135]
    s_add_u32 s17, s16, 7
    s_and_b32 s17, s17, 7
    s_add_u32 m0, s57, 104448
    s_lshl_b32 s60, s17, 7
    s_add_u32 s60, s60, s54
    buffer_load_dwordx4 v10, s[24:27], s60 offen offset:0 lds
    v_mfma_f32_16x16x32_bf16 v[136:139], v[180:183], v[164:167], v[136:139]
    v_mfma_f32_16x16x32_bf16 v[140:143], v[180:183], v[172:175], v[140:143]
    s_waitcnt lgkmcnt(12)
    s_waitcnt lgkmcnt(10)
    v_mfma_f32_16x16x32_bf16 v[72:75], v[144:147], a[32:35], v[72:75]
    ds_read_b128 a[36:39], v23 offset:0
    s_waitcnt lgkmcnt(9)
    v_mfma_f32_16x16x32_bf16 v[76:79], a[32:35], v[148:151], v[76:79]
    ds_read_b64_tr_b16 v[160:161], v32 offset:26624
    s_waitcnt lgkmcnt(8)
    v_mfma_f32_16x16x32_bf16 v[80:83], v[152:155], a[32:35], v[80:83]
    ds_read_b64_tr_b16 v[162:163], v32 offset:27136
    s_waitcnt lgkmcnt(7)
    v_mfma_f32_16x16x32_bf16 v[84:87], a[32:35], v[156:159], v[84:87]
    buffer_load_dwordx4 v10, s[24:27], s60 offen offset:1024 lds
    s_waitcnt lgkmcnt(6)
    v_mfma_f32_16x16x32_bf16 v[88:91], v[144:147], a[96:99], v[88:91]
    ds_read_b64_tr_b16 v[164:165], v32 offset:27648
    v_mfma_f32_16x16x32_bf16 v[92:95], a[96:99], v[148:151], v[92:95]
    ds_read_b64_tr_b16 v[166:167], v32 offset:28160
    v_mfma_f32_16x16x32_bf16 v[96:99], v[152:155], a[96:99], v[96:99]
    ds_read_b64_tr_b16 v[168:169], v35 offset:26624
    v_mfma_f32_16x16x32_bf16 v[100:103], a[96:99], v[156:159], v[100:103]
    buffer_load_dwordx4 v11, s[24:27], s60 offen offset:2048 lds
    s_waitcnt lgkmcnt(8)
    v_mfma_f32_16x16x32_bf16 v[104:107], v[144:147], a[160:163], v[104:107]
    ds_read_b64_tr_b16 v[170:171], v35 offset:27136
    v_mfma_f32_16x16x32_bf16 v[108:111], a[160:163], v[148:151], v[108:111]
    ds_read_b64_tr_b16 v[172:173], v35 offset:27648
    v_mfma_f32_16x16x32_bf16 v[112:115], v[152:155], a[160:163], v[112:115]
    ds_read_b64_tr_b16 v[174:175], v35 offset:28160
    v_mfma_f32_16x16x32_bf16 v[116:119], a[160:163], v[156:159], v[116:119]
    buffer_load_dwordx4 v11, s[24:27], s60 offen offset:3072 lds
    s_waitcnt lgkmcnt(10)
    v_mfma_f32_16x16x32_bf16 v[120:123], v[144:147], a[224:227], v[120:123]
    ds_read_b128 a[100:103], v23 offset:1024
    v_mfma_f32_16x16x32_bf16 v[124:127], a[224:227], v[148:151], v[124:127]
    ds_read_b128 a[164:167], v23 offset:4096
    v_mfma_f32_16x16x32_bf16 v[128:131], v[152:155], a[224:227], v[128:131]
    ds_read_b128 a[228:231], v23 offset:5120
    v_mfma_f32_16x16x32_bf16 v[132:135], a[224:227], v[156:159], v[132:135]
    s_add_u32 m0, s57, 122880
    s_mul_i32 s60, s17, 196608
    s_add_u32 s60, s60, s66
    buffer_load_dwordx4 v14, s[28:31], s60 offen offset:0 lds
    s_waitcnt lgkmcnt(12)
    v_mfma_f32_16x16x32_bf16 v[136:139], v[176:179], v[148:151], v[136:139]
    ds_read_b128 v[180:183], v29 offset:0
    v_mfma_f32_16x16x32_bf16 v[140:143], v[176:179], v[156:159], v[140:143]
    s_waitcnt lgkmcnt(12)
    s_waitcnt lgkmcnt(10)
    v_mfma_f32_16x16x32_bf16 v[72:75], v[160:163], a[36:39], v[72:75]
    s_waitcnt lgkmcnt(8)
    v_mfma_f32_16x16x32_bf16 v[76:79], a[36:39], v[164:167], v[76:79]
    buffer_load_dwordx4 v14, s[28:31], s60 offen offset:1024 lds
    s_waitcnt lgkmcnt(6)
    v_mfma_f32_16x16x32_bf16 v[80:83], v[168:171], a[36:39], v[80:83]
    s_waitcnt lgkmcnt(4)
    v_mfma_f32_16x16x32_bf16 v[84:87], a[36:39], v[172:175], v[84:87]
    s_waitcnt lgkmcnt(0)
    s_waitcnt vmcnt(15)
    s_barrier
    v_mfma_f32_16x16x32_bf16 v[88:91], v[160:163], a[100:103], v[88:91]
    ds_read_b128 a[40:43], v20 offset:34816
    ds_read_b64_tr_b16 v[144:145], v32 offset:53248
    v_mfma_f32_16x16x32_bf16 v[92:95], a[100:103], v[164:167], v[92:95]
    ds_read_b64_tr_b16 v[146:147], v32 offset:53760
    ds_read_b64_tr_b16 v[148:149], v32 offset:54272
    v_mfma_f32_16x16x32_bf16 v[96:99], v[168:171], a[100:103], v[96:99]
    ds_read_b64_tr_b16 v[150:151], v32 offset:54784
    ds_read_b64_tr_b16 v[152:153], v35 offset:53248
    v_mfma_f32_16x16x32_bf16 v[100:103], a[100:103], v[172:175], v[100:103]
    buffer_load_dwordx4 v15, s[28:31], s60 offen offset:2048 lds
    ds_read_b64_tr_b16 v[154:155], v35 offset:53760
    v_mfma_f32_16x16x32_bf16 v[104:107], v[160:163], a[164:167], v[104:107]
    ds_read_b64_tr_b16 v[156:157], v35 offset:54272
    ds_read_b64_tr_b16 v[158:159], v35 offset:54784
    v_mfma_f32_16x16x32_bf16 v[108:111], a[164:167], v[164:167], v[108:111]
    ds_read_b128 a[104:107], v20 offset:35840
    ds_read_b128 a[168:171], v20 offset:38912
    v_mfma_f32_16x16x32_bf16 v[112:115], v[168:171], a[164:167], v[112:115]
    ds_read_b128 a[232:235], v20 offset:39936
    ds_read_b128 v[176:179], v26 offset:34816
    v_mfma_f32_16x16x32_bf16 v[116:119], a[164:167], v[172:175], v[116:119]
    buffer_load_dwordx4 v15, s[28:31], s60 offen offset:3072 lds
    v_mfma_f32_16x16x32_bf16 v[120:123], v[160:163], a[228:231], v[120:123]
    v_mfma_f32_16x16x32_bf16 v[124:127], a[228:231], v[164:167], v[124:127]
    v_mfma_f32_16x16x32_bf16 v[128:131], v[168:171], a[228:231], v[128:131]
    v_mfma_f32_16x16x32_bf16 v[132:135], a[228:231], v[172:175], v[132:135]
    s_add_u32 m0, s67, 120832
    s_lshl_b32 s60, s17, 7
    s_add_u32 s60, s60, s55
    s_mov_b32 exec_hi, 0
    buffer_load_dwordx4 v18, s[24:27], s60 offen lds
    s_mov_b32 exec_hi, -1
    v_mfma_f32_16x16x32_bf16 v[136:139], v[180:183], v[164:167], v[136:139]
    v_mfma_f32_16x16x32_bf16 v[140:143], v[180:183], v[172:175], v[140:143]
    s_waitcnt lgkmcnt(12)
    s_waitcnt lgkmcnt(10)
    v_mfma_f32_16x16x32_bf16 v[72:75], v[144:147], a[40:43], v[72:75]
    ds_read_b128 a[44:47], v23 offset:34816
    s_waitcnt lgkmcnt(9)
    v_mfma_f32_16x16x32_bf16 v[76:79], a[40:43], v[148:151], v[76:79]
    ds_read_b64_tr_b16 v[160:161], v32 offset:61440
    s_waitcnt lgkmcnt(8)
    v_mfma_f32_16x16x32_bf16 v[80:83], v[152:155], a[40:43], v[80:83]
    ds_read_b64_tr_b16 v[162:163], v32 offset:61952
    s_waitcnt lgkmcnt(7)
    v_mfma_f32_16x16x32_bf16 v[84:87], a[40:43], v[156:159], v[84:87]
    s_add_u32 s17, s16, 0
    s_and_b32 s17, s17, 7
    s_add_u32 m0, s57, 0
    s_mul_i32 s60, s17, 196608
    s_add_u32 s60, s60, s56
    buffer_load_dwordx4 v14, s[28:31], s60 offen offset:0 lds
    s_waitcnt lgkmcnt(6)
    v_mfma_f32_16x16x32_bf16 v[88:91], v[144:147], a[104:107], v[88:91]
    ds_read_b64_tr_b16 v[164:165], v32 offset:62464
    v_mfma_f32_16x16x32_bf16 v[92:95], a[104:107], v[148:151], v[92:95]
    ds_read_b64_tr_b16 v[166:167], v32 offset:62976
    v_mfma_f32_16x16x32_bf16 v[96:99], v[152:155], a[104:107], v[96:99]
    ds_read_b64_tr_b16 v[168:169], v35 offset:61440
    v_mfma_f32_16x16x32_bf16 v[100:103], a[104:107], v[156:159], v[100:103]
    buffer_load_dwordx4 v15, s[28:31], s60 offen offset:2048 lds
    s_waitcnt lgkmcnt(8)
    v_mfma_f32_16x16x32_bf16 v[104:107], v[144:147], a[168:171], v[104:107]
    ds_read_b64_tr_b16 v[170:171], v35 offset:61952
    v_mfma_f32_16x16x32_bf16 v[108:111], a[168:171], v[148:151], v[108:111]
    ds_read_b64_tr_b16 v[172:173], v35 offset:62464
    v_mfma_f32_16x16x32_bf16 v[112:115], v[152:155], a[168:171], v[112:115]
    ds_read_b64_tr_b16 v[174:175], v35 offset:62976
    v_mfma_f32_16x16x32_bf16 v[116:119], a[168:171], v[156:159], v[116:119]
    s_add_u32 s17, s16, 1
    s_and_b32 s17, s17, 7
    s_add_u32 m0, s57, 1024
    s_mul_i32 s60, s17, 196608
    s_add_u32 s60, s60, s56
    buffer_load_dwordx4 v14, s[28:31], s60 offen offset:0 lds
    s_waitcnt lgkmcnt(10)
    v_mfma_f32_16x16x32_bf16 v[120:123], v[144:147], a[232:235], v[120:123]
    ds_read_b128 a[108:111], v23 offset:35840
    v_mfma_f32_16x16x32_bf16 v[124:127], a[232:235], v[148:151], v[124:127]
    ds_read_b128 a[172:175], v23 offset:38912
    v_mfma_f32_16x16x32_bf16 v[128:131], v[152:155], a[232:235], v[128:131]
    ds_read_b128 a[236:239], v23 offset:39936
    v_mfma_f32_16x16x32_bf16 v[132:135], a[232:235], v[156:159], v[132:135]
    buffer_load_dwordx4 v15, s[28:31], s60 offen offset:2048 lds
    s_waitcnt lgkmcnt(12)
    v_mfma_f32_16x16x32_bf16 v[136:139], v[176:179], v[148:151], v[136:139]
    ds_read_b128 v[180:183], v29 offset:34816
    v_mfma_f32_16x16x32_bf16 v[140:143], v[176:179], v[156:159], v[140:143]
    s_waitcnt lgkmcnt(12)
    s_waitcnt lgkmcnt(10)
    v_mfma_f32_16x16x32_bf16 v[72:75], v[160:163], a[44:47], v[72:75]
    s_waitcnt lgkmcnt(8)
    v_mfma_f32_16x16x32_bf16 v[76:79], a[44:47], v[164:167], v[76:79]
    s_add_u32 s17, s16, 2
    s_and_b32 s17, s17, 7
    s_add_u32 m0, s57, 16384
    s_mul_i32 s60, s17, 196608
    s_add_u32 s60, s60, s56
    buffer_load_dwordx4 v14, s[28:31], s60 offen offset:0 lds
    s_waitcnt lgkmcnt(6)
    v_mfma_f32_16x16x32_bf16 v[80:83], v[168:171], a[44:47], v[80:83]
    s_waitcnt lgkmcnt(4)
    v_mfma_f32_16x16x32_bf16 v[84:87], a[44:47], v[172:175], v[84:87]
    s_waitcnt lgkmcnt(0)
    s_waitcnt vmcnt(14)
    s_barrier
    v_mfma_f32_16x16x32_bf16 v[88:91], v[160:163], a[108:111], v[88:91]
    ds_read_b128 a[48:51], v21 offset:4096
    ds_read_b64_tr_b16 v[144:145], v33 offset:22528
    v_mfma_f32_16x16x32_bf16 v[92:95], a[108:111], v[164:167], v[92:95]
    ds_read_b64_tr_b16 v[146:147], v33 offset:23040
    ds_read_b64_tr_b16 v[148:149], v33 offset:23552
    v_mfma_f32_16x16x32_bf16 v[96:99], v[168:171], a[108:111], v[96:99]
    ds_read_b64_tr_b16 v[150:151], v33 offset:24064
    ds_read_b64_tr_b16 v[152:153], v36 offset:22528
    v_mfma_f32_16x16x32_bf16 v[100:103], a[108:111], v[172:175], v[100:103]
    buffer_load_dwordx4 v15, s[28:31], s60 offen offset:2048 lds
    ds_read_b64_tr_b16 v[154:155], v36 offset:23040
    v_mfma_f32_16x16x32_bf16 v[104:107], v[160:163], a[172:175], v[104:107]
    ds_read_b64_tr_b16 v[156:157], v36 offset:23552
    ds_read_b64_tr_b16 v[158:159], v36 offset:24064
    v_mfma_f32_16x16x32_bf16 v[108:111], a[172:175], v[164:167], v[108:111]
    ds_read_b128 a[112:115], v21 offset:5120
    ds_read_b128 a[176:179], v21 offset:8192
    v_mfma_f32_16x16x32_bf16 v[112:115], v[168:171], a[172:175], v[112:115]
    ds_read_b128 a[240:243], v21 offset:9216
    ds_read_b128 v[176:179], v27 offset:4096
    v_mfma_f32_16x16x32_bf16 v[116:119], a[172:175], v[172:175], v[116:119]
    s_add_u32 s17, s16, 3
    s_and_b32 s17, s17, 7
    s_add_u32 m0, s57, 17408
    s_mul_i32 s60, s17, 196608
    s_add_u32 s60, s60, s56
    buffer_load_dwordx4 v14, s[28:31], s60 offen offset:0 lds
    v_mfma_f32_16x16x32_bf16 v[120:123], v[160:163], a[236:239], v[120:123]
    v_mfma_f32_16x16x32_bf16 v[124:127], a[236:239], v[164:167], v[124:127]
    v_mfma_f32_16x16x32_bf16 v[128:131], v[168:171], a[236:239], v[128:131]
    v_mfma_f32_16x16x32_bf16 v[132:135], a[236:239], v[172:175], v[132:135]
    buffer_load_dwordx4 v15, s[28:31], s60 offen offset:2048 lds
    v_mfma_f32_16x16x32_bf16 v[136:139], v[180:183], v[164:167], v[136:139]
    v_mfma_f32_16x16x32_bf16 v[140:143], v[180:183], v[172:175], v[140:143]
    s_waitcnt lgkmcnt(12)
    s_waitcnt lgkmcnt(10)
    v_mfma_f32_16x16x32_bf16 v[72:75], v[144:147], a[48:51], v[72:75]
    ds_read_b128 a[52:55], v24 offset:4096
    s_waitcnt lgkmcnt(9)
    v_mfma_f32_16x16x32_bf16 v[76:79], a[48:51], v[148:151], v[76:79]
    ds_read_b64_tr_b16 v[160:161], v33 offset:30720
    s_waitcnt lgkmcnt(8)
    v_mfma_f32_16x16x32_bf16 v[80:83], v[152:155], a[48:51], v[80:83]
    ds_read_b64_tr_b16 v[162:163], v33 offset:31232
    s_waitcnt lgkmcnt(7)
    v_mfma_f32_16x16x32_bf16 v[84:87], a[48:51], v[156:159], v[84:87]
    s_add_u32 s17, s16, 4
    s_and_b32 s17, s17, 7
    s_add_u32 m0, s57, 34816
    s_mul_i32 s60, s17, 196608
    s_add_u32 s60, s60, s56
    buffer_load_dwordx4 v14, s[28:31], s60 offen offset:0 lds
    s_waitcnt lgkmcnt(6)
    v_mfma_f32_16x16x32_bf16 v[88:91], v[144:147], a[112:115], v[88:91]
    ds_read_b64_tr_b16 v[164:165], v33 offset:31744
    v_mfma_f32_16x16x32_bf16 v[92:95], a[112:115], v[148:151], v[92:95]
    ds_read_b64_tr_b16 v[166:167], v33 offset:32256
    v_mfma_f32_16x16x32_bf16 v[96:99], v[152:155], a[112:115], v[96:99]
    ds_read_b64_tr_b16 v[168:169], v36 offset:30720
    v_mfma_f32_16x16x32_bf16 v[100:103], a[112:115], v[156:159], v[100:103]
    buffer_load_dwordx4 v15, s[28:31], s60 offen offset:2048 lds
    s_waitcnt lgkmcnt(8)
    v_mfma_f32_16x16x32_bf16 v[104:107], v[144:147], a[176:179], v[104:107]
    ds_read_b64_tr_b16 v[170:171], v36 offset:31232
    v_mfma_f32_16x16x32_bf16 v[108:111], a[176:179], v[148:151], v[108:111]
    ds_read_b64_tr_b16 v[172:173], v36 offset:31744
    v_mfma_f32_16x16x32_bf16 v[112:115], v[152:155], a[176:179], v[112:115]
    ds_read_b64_tr_b16 v[174:175], v36 offset:32256
    v_mfma_f32_16x16x32_bf16 v[116:119], a[176:179], v[156:159], v[116:119]
    s_add_u32 s17, s16, 5
    s_and_b32 s17, s17, 7
    s_add_u32 m0, s57, 35840
    s_mul_i32 s60, s17, 196608
    s_add_u32 s60, s60, s56
    buffer_load_dwordx4 v14, s[28:31], s60 offen offset:0 lds
    s_waitcnt lgkmcnt(10)
    v_mfma_f32_16x16x32_bf16 v[120:123], v[144:147], a[240:243], v[120:123]
    ds_read_b128 a[116:119], v24 offset:5120
    v_mfma_f32_16x16x32_bf16 v[124:127], a[240:243], v[148:151], v[124:127]
    ds_read_b128 a[180:183], v24 offset:8192
    v_mfma_f32_16x16x32_bf16 v[128:131], v[152:155], a[240:243], v[128:131]
    ds_read_b128 a[244:247], v24 offset:9216
    v_mfma_f32_16x16x32_bf16 v[132:135], a[240:243], v[156:159], v[132:135]
    buffer_load_dwordx4 v15, s[28:31], s60 offen offset:2048 lds
    s_waitcnt lgkmcnt(12)
    v_mfma_f32_16x16x32_bf16 v[136:139], v[176:179], v[148:151], v[136:139]
    ds_read_b128 v[180:183], v30 offset:4096
    v_mfma_f32_16x16x32_bf16 v[140:143], v[176:179], v[156:159], v[140:143]
    s_waitcnt lgkmcnt(12)
    s_waitcnt lgkmcnt(10)
    v_mfma_f32_16x16x32_bf16 v[72:75], v[160:163], a[52:55], v[72:75]
    s_waitcnt lgkmcnt(8)
    v_mfma_f32_16x16x32_bf16 v[76:79], a[52:55], v[164:167], v[76:79]
    s_add_u32 s17, s16, 6
    s_and_b32 s17, s17, 7
    s_add_u32 m0, s57, 51200
    s_mul_i32 s60, s17, 196608
    s_add_u32 s60, s60, s56
    buffer_load_dwordx4 v14, s[28:31], s60 offen offset:0 lds
    s_waitcnt lgkmcnt(6)
    v_mfma_f32_16x16x32_bf16 v[80:83], v[168:171], a[52:55], v[80:83]
    s_waitcnt lgkmcnt(4)
    v_mfma_f32_16x16x32_bf16 v[84:87], a[52:55], v[172:175], v[84:87]
    s_waitcnt lgkmcnt(0)
    s_waitcnt vmcnt(13)
    s_barrier
    v_mfma_f32_16x16x32_bf16 v[88:91], v[160:163], a[116:119], v[88:91]
    ds_read_b128 a[56:59], v21 offset:38912
    ds_read_b64_tr_b16 v[144:145], v33 offset:57344
    v_mfma_f32_16x16x32_bf16 v[92:95], a[116:119], v[164:167], v[92:95]
    ds_read_b64_tr_b16 v[146:147], v33 offset:57856
    ds_read_b64_tr_b16 v[148:149], v33 offset:58368
    v_mfma_f32_16x16x32_bf16 v[96:99], v[168:171], a[116:119], v[96:99]
    ds_read_b64_tr_b16 v[150:151], v33 offset:58880
    ds_read_b64_tr_b16 v[152:153], v36 offset:57344
    v_mfma_f32_16x16x32_bf16 v[100:103], a[116:119], v[172:175], v[100:103]
    buffer_load_dwordx4 v15, s[28:31], s60 offen offset:2048 lds
    ds_read_b64_tr_b16 v[154:155], v36 offset:57856
    v_mfma_f32_16x16x32_bf16 v[104:107], v[160:163], a[180:183], v[104:107]
    ds_read_b64_tr_b16 v[156:157], v36 offset:58368
    ds_read_b64_tr_b16 v[158:159], v36 offset:58880
    v_mfma_f32_16x16x32_bf16 v[108:111], a[180:183], v[164:167], v[108:111]
    ds_read_b128 a[120:123], v21 offset:39936
    ds_read_b128 a[184:187], v21 offset:43008
    v_mfma_f32_16x16x32_bf16 v[112:115], v[168:171], a[180:183], v[112:115]
    ds_read_b128 a[248:251], v21 offset:44032
    ds_read_b128 v[176:179], v27 offset:38912
    v_mfma_f32_16x16x32_bf16 v[116:119], a[180:183], v[172:175], v[116:119]
    s_add_u32 s17, s16, 7
    s_and_b32 s17, s17, 7
    s_add_u32 m0, s57, 52224
    s_mul_i32 s60, s17, 196608
    s_add_u32 s60, s60, s56
    buffer_load_dwordx4 v14, s[28:31], s60 offen offset:0 lds
    v_mfma_f32_16x16x32_bf16 v[120:123], v[160:163], a[244:247], v[120:123]
    v_mfma_f32_16x16x32_bf16 v[124:127], a[244:247], v[164:167], v[124:127]
    v_mfma_f32_16x16x32_bf16 v[128:131], v[168:171], a[244:247], v[128:131]
    v_mfma_f32_16x16x32_bf16 v[132:135], a[244:247], v[172:175], v[132:135]
    buffer_load_dwordx4 v15, s[28:31], s60 offen offset:2048 lds
    v_mfma_f32_16x16x32_bf16 v[136:139], v[180:183], v[164:167], v[136:139]
    v_mfma_f32_16x16x32_bf16 v[140:143], v[180:183], v[172:175], v[140:143]
    s_waitcnt lgkmcnt(12)
    s_waitcnt lgkmcnt(10)
    v_mfma_f32_16x16x32_bf16 v[72:75], v[144:147], a[56:59], v[72:75]
    ds_read_b128 a[60:63], v24 offset:38912
    s_waitcnt lgkmcnt(9)
    v_mfma_f32_16x16x32_bf16 v[76:79], a[56:59], v[148:151], v[76:79]
    ds_read_b64_tr_b16 v[160:161], v34 offset:0
    s_waitcnt lgkmcnt(8)
    v_mfma_f32_16x16x32_bf16 v[80:83], v[152:155], a[56:59], v[80:83]
    ds_read_b64_tr_b16 v[162:163], v34 offset:512
    s_waitcnt lgkmcnt(7)
    v_mfma_f32_16x16x32_bf16 v[84:87], a[56:59], v[156:159], v[84:87]
    s_add_u32 m0, s7, 67584
    s_add_u32 s60, s65, 0
    buffer_load_dwordx4 v12, s[40:43], s60 offen offset:0 lds
    s_waitcnt lgkmcnt(6)
    v_mfma_f32_16x16x32_bf16 v[88:91], v[144:147], a[120:123], v[88:91]
    ds_read_b64_tr_b16 v[164:165], v34 offset:1024
    v_mfma_f32_16x16x32_bf16 v[92:95], a[120:123], v[148:151], v[92:95]
    ds_read_b64_tr_b16 v[166:167], v34 offset:1536
    v_mfma_f32_16x16x32_bf16 v[96:99], v[152:155], a[120:123], v[96:99]
    ds_read_b64_tr_b16 v[168:169], v37 offset:0
    v_mfma_f32_16x16x32_bf16 v[100:103], a[120:123], v[156:159], v[100:103]
    buffer_load_dwordx4 v13, s[40:43], s60 offen offset:1024 lds
    s_waitcnt lgkmcnt(8)
    v_mfma_f32_16x16x32_bf16 v[104:107], v[144:147], a[184:187], v[104:107]
    ds_read_b64_tr_b16 v[170:171], v37 offset:512
    v_mfma_f32_16x16x32_bf16 v[108:111], a[184:187], v[148:151], v[108:111]
    ds_read_b64_tr_b16 v[172:173], v37 offset:1024
    v_mfma_f32_16x16x32_bf16 v[112:115], v[152:155], a[184:187], v[112:115]
    ds_read_b64_tr_b16 v[174:175], v37 offset:1536
    v_mfma_f32_16x16x32_bf16 v[116:119], a[184:187], v[156:159], v[116:119]
    buffer_load_dwordx4 v16, s[40:43], s60 offen offset:2048 lds
    s_waitcnt lgkmcnt(10)
    v_mfma_f32_16x16x32_bf16 v[120:123], v[144:147], a[248:251], v[120:123]
    ds_read_b128 a[124:127], v24 offset:39936
    v_mfma_f32_16x16x32_bf16 v[124:127], a[248:251], v[148:151], v[124:127]
    ds_read_b128 a[188:191], v24 offset:43008
    v_mfma_f32_16x16x32_bf16 v[128:131], v[152:155], a[248:251], v[128:131]
    ds_read_b128 a[252:255], v24 offset:44032
    v_mfma_f32_16x16x32_bf16 v[132:135], a[248:251], v[156:159], v[132:135]
    buffer_load_dwordx4 v17, s[40:43], s60 offen offset:3072 lds
    s_waitcnt lgkmcnt(12)
    v_mfma_f32_16x16x32_bf16 v[136:139], v[176:179], v[148:151], v[136:139]
    ds_read_b128 v[180:183], v30 offset:38912
    v_mfma_f32_16x16x32_bf16 v[140:143], v[176:179], v[156:159], v[140:143]
    s_waitcnt lgkmcnt(12)
    s_waitcnt lgkmcnt(10)
    v_mfma_f32_16x16x32_bf16 v[72:75], v[160:163], a[60:63], v[72:75]
    s_waitcnt lgkmcnt(8)
    v_mfma_f32_16x16x32_bf16 v[76:79], a[60:63], v[164:167], v[76:79]
    s_add_u32 m0, s7, 71680
    s_add_u32 s60, s65, 16384
    buffer_load_dwordx4 v12, s[40:43], s60 offen offset:0 lds
    s_waitcnt lgkmcnt(6)
    v_mfma_f32_16x16x32_bf16 v[80:83], v[168:171], a[60:63], v[80:83]
    s_waitcnt lgkmcnt(4)
    v_mfma_f32_16x16x32_bf16 v[84:87], a[60:63], v[172:175], v[84:87]
    s_waitcnt lgkmcnt(0)
    s_waitcnt vmcnt(13)
    s_barrier
    v_mfma_f32_16x16x32_bf16 v[88:91], v[160:163], a[124:127], v[88:91]
    ds_read_b64_tr_b16 v[144:145], v32 offset:0
    ds_read_b64_tr_b16 v[146:147], v32 offset:512
    v_mfma_f32_16x16x32_bf16 v[92:95], a[124:127], v[164:167], v[92:95]
    ds_read_b64_tr_b16 v[148:149], v32 offset:8192
    ds_read_b64_tr_b16 v[150:151], v32 offset:8704
    v_mfma_f32_16x16x32_bf16 v[96:99], v[168:171], a[124:127], v[96:99]
    ds_read_b64_tr_b16 v[152:153], v32 offset:1024
    ds_read_b64_tr_b16 v[154:155], v32 offset:1536
    v_mfma_f32_16x16x32_bf16 v[100:103], a[124:127], v[172:175], v[100:103]
    buffer_load_dwordx4 v13, s[40:43], s60 offen offset:1024 lds
    v_mfma_f32_16x16x32_bf16 v[104:107], v[160:163], a[188:191], v[104:107]
    v_mfma_f32_16x16x32_bf16 v[108:111], a[188:191], v[164:167], v[108:111]
    v_mfma_f32_16x16x32_bf16 v[112:115], v[168:171], a[188:191], v[112:115]
    v_mfma_f32_16x16x32_bf16 v[116:119], a[188:191], v[172:175], v[116:119]
    buffer_load_dwordx4 v16, s[40:43], s60 offen offset:2048 lds
    v_mfma_f32_16x16x32_bf16 v[120:123], v[160:163], a[252:255], v[120:123]
    v_mfma_f32_16x16x32_bf16 v[124:127], a[252:255], v[164:167], v[124:127]
    v_mfma_f32_16x16x32_bf16 v[128:131], v[168:171], a[252:255], v[128:131]
    v_mfma_f32_16x16x32_bf16 v[132:135], a[252:255], v[172:175], v[132:135]
    buffer_load_dwordx4 v17, s[40:43], s60 offen offset:3072 lds
    v_mfma_f32_16x16x32_bf16 v[136:139], v[180:183], v[164:167], v[136:139]
    v_mfma_f32_16x16x32_bf16 v[140:143], v[180:183], v[172:175], v[140:143]
L_q_01:
    s_waitcnt lgkmcnt(4)
    v_mfma_f32_16x16x32_bf16 v[184:187], v[144:147], a[0:3], 0
    ds_read_b64_tr_b16 v[156:157], v32 offset:9216
    ds_read_b64_tr_b16 v[158:159], v32 offset:9728
    s_nop 2
    v_cvt_pk_bf16_f32 v4, v136, v137
    v_mfma_f32_16x16x32_bf16 v[188:191], v[144:147], a[64:67], 0
    v_cvt_pk_bf16_f32 v5, v138, v139
    ds_write_b64 v9, v[4:5] offset:4096
    v_cvt_pk_bf16_f32 v6, v140, v141
    v_mfma_f32_16x16x32_bf16 v[192:195], v[144:147], a[128:131], 0
    v_cvt_pk_bf16_f32 v7, v142, v143
    ds_write_b64 v9, v[6:7] offset:4608
    v_cvt_pk_bf16_f32 v240, v72, v73
    v_mfma_f32_16x16x32_bf16 v[196:199], v[144:147], a[192:195], 0
    s_add_u32 m0, s7, 100352
    s_add_u32 s60, s65, 131072
    buffer_load_dwordx4 v12, s[40:43], s60 offen offset:0 lds
    v_cvt_pk_bf16_f32 v241, v74, v75
    s_waitcnt lgkmcnt(6)
    v_mfma_f32_16x16x32_bf16 v[184:187], v[148:151], a[4:7], v[184:187]
    ds_read_b64_tr_b16 v[160:161], v32 offset:16384
    ds_read_b64_tr_b16 v[162:163], v32 offset:16896
    v_cvt_pk_bf16_f32 v218, v76, v77
    v_mfma_f32_16x16x32_bf16 v[188:191], v[148:151], a[68:71], v[188:191]
    v_cvt_pk_bf16_f32 v219, v78, v79
    v_cvt_pk_bf16_f32 v242, v80, v81
    v_cvt_pk_bf16_f32 v243, v82, v83
    v_mfma_f32_16x16x32_bf16 v[192:195], v[148:151], a[132:135], v[192:195]
    v_cvt_pk_bf16_f32 v224, v84, v85
    v_cvt_pk_bf16_f32 v225, v86, v87
    v_cvt_pk_bf16_f32 v244, v88, v89
    v_mfma_f32_16x16x32_bf16 v[196:199], v[148:151], a[196:199], v[196:199]
    buffer_load_dwordx4 v13, s[40:43], s60 offen offset:1024 lds
    v_cvt_pk_bf16_f32 v245, v90, v91
    v_cvt_pk_bf16_f32 v230, v92, v93
    s_waitcnt lgkmcnt(6)
    v_mfma_f32_16x16x32_bf16 v[184:187], v[152:155], a[8:11], v[184:187]
    ds_read_b64_tr_b16 v[164:165], v32 offset:24576
    ds_read_b64_tr_b16 v[166:167], v32 offset:25088
    v_cvt_pk_bf16_f32 v231, v94, v95
    v_mfma_f32_16x16x32_bf16 v[188:191], v[152:155], a[72:75], v[188:191]
    v_cvt_pk_bf16_f32 v246, v96, v97
    v_cvt_pk_bf16_f32 v247, v98, v99
    v_cvt_pk_bf16_f32 v236, v100, v101
    v_mfma_f32_16x16x32_bf16 v[192:195], v[152:155], a[136:139], v[192:195]
    v_cvt_pk_bf16_f32 v237, v102, v103
    v_cvt_pk_bf16_f32 v248, v104, v105
    v_cvt_pk_bf16_f32 v249, v106, v107
    v_mfma_f32_16x16x32_bf16 v[196:199], v[152:155], a[200:203], v[196:199]
    buffer_load_dwordx4 v16, s[40:43], s60 offen offset:2048 lds
    v_cvt_pk_bf16_f32 v220, v108, v109
    v_cvt_pk_bf16_f32 v221, v110, v111
    s_waitcnt lgkmcnt(6)
    v_mfma_f32_16x16x32_bf16 v[184:187], v[156:159], a[12:15], v[184:187]
    ds_read_b64_tr_b16 v[168:169], v32 offset:17408
    ds_read_b64_tr_b16 v[170:171], v32 offset:17920
    v_cvt_pk_bf16_f32 v250, v112, v113
    v_mfma_f32_16x16x32_bf16 v[188:191], v[156:159], a[76:79], v[188:191]
    v_cvt_pk_bf16_f32 v251, v114, v115
    v_cvt_pk_bf16_f32 v226, v116, v117
    v_cvt_pk_bf16_f32 v227, v118, v119
    v_mfma_f32_16x16x32_bf16 v[192:195], v[156:159], a[140:143], v[192:195]
    v_cvt_pk_bf16_f32 v252, v120, v121
    v_cvt_pk_bf16_f32 v253, v122, v123
    v_cvt_pk_bf16_f32 v232, v124, v125
    v_mfma_f32_16x16x32_bf16 v[196:199], v[156:159], a[204:207], v[196:199]
    buffer_load_dwordx4 v17, s[40:43], s60 offen offset:3072 lds
    v_cvt_pk_bf16_f32 v233, v126, v127
    v_cvt_pk_bf16_f32 v254, v128, v129
    s_waitcnt lgkmcnt(4)
    v_mfma_f32_16x16x32_bf16 v[184:187], v[160:163], a[16:19], v[184:187]
    ds_read_b64_tr_b16 v[172:173], v32 offset:25600
    ds_read_b64_tr_b16 v[174:175], v32 offset:26112
    v_cvt_pk_bf16_f32 v255, v130, v131
    v_mfma_f32_16x16x32_bf16 v[188:191], v[160:163], a[80:83], v[188:191]
    v_cvt_pk_bf16_f32 v238, v132, v133
    v_cvt_pk_bf16_f32 v239, v134, v135
    v_mfma_f32_16x16x32_bf16 v[192:195], v[160:163], a[144:147], v[192:195]
    v_mfma_f32_16x16x32_bf16 v[196:199], v[160:163], a[208:211], v[196:199]
    s_add_u32 m0, s7, 104448
    s_add_u32 s60, s65, 147456
    buffer_load_dwordx4 v12, s[40:43], s60 offen offset:0 lds
    s_waitcnt lgkmcnt(0)
    s_waitcnt vmcnt(13)
    s_barrier
    v_mfma_f32_16x16x32_bf16 v[184:187], v[164:167], a[20:23], v[184:187]
    ds_read_b64_tr_b16 v[144:145], v32 offset:34816
    ds_read_b64_tr_b16 v[146:147], v32 offset:35328
    ds_read_b64 v[176:177], v9 offset:0
    v_mfma_f32_16x16x32_bf16 v[188:191], v[164:167], a[84:87], v[188:191]
    ds_read_b64 v[216:217], v9 offset:512
    ds_read_b64 v[178:179], v9 offset:1024
    ds_read_b64 v[222:223], v9 offset:1536
    v_mfma_f32_16x16x32_bf16 v[192:195], v[164:167], a[148:151], v[192:195]
    ds_read_b64 v[180:181], v9 offset:2048
    ds_read_b64 v[228:229], v9 offset:2560
    ds_read_b64 v[182:183], v9 offset:3072
    v_mfma_f32_16x16x32_bf16 v[196:199], v[164:167], a[212:215], v[196:199]
    buffer_load_dwordx4 v13, s[40:43], s60 offen offset:1024 lds
    ds_read_b64 v[234:235], v9 offset:3584
    v_mfma_f32_16x16x32_bf16 v[184:187], v[168:171], a[24:27], v[184:187]
    ds_read_b64_tr_b16 v[148:149], v32 offset:43008
    ds_read_b64_tr_b16 v[150:151], v32 offset:43520
    v_mfma_f32_16x16x32_bf16 v[188:191], v[168:171], a[88:91], v[188:191]
    v_mfma_f32_16x16x32_bf16 v[192:195], v[168:171], a[152:155], v[192:195]
    v_mfma_f32_16x16x32_bf16 v[196:199], v[168:171], a[216:219], v[196:199]
    buffer_load_dwordx4 v16, s[40:43], s60 offen offset:2048 lds
    v_mfma_f32_16x16x32_bf16 v[184:187], v[172:175], a[28:31], v[184:187]
    ds_read_b64_tr_b16 v[152:153], v32 offset:35840
    ds_read_b64_tr_b16 v[154:155], v32 offset:36352
    v_mfma_f32_16x16x32_bf16 v[188:191], v[172:175], a[92:95], v[188:191]
    v_mfma_f32_16x16x32_bf16 v[192:195], v[172:175], a[156:159], v[192:195]
    v_mfma_f32_16x16x32_bf16 v[196:199], v[172:175], a[220:223], v[196:199]
    buffer_load_dwordx4 v17, s[40:43], s60 offen offset:3072 lds
    s_waitcnt lgkmcnt(12)
    v_mfma_f32_16x16x32_bf16 v[184:187], v[144:147], a[32:35], v[184:187]
    ds_read_b64_tr_b16 v[156:157], v32 offset:44032
    ds_read_b64_tr_b16 v[158:159], v32 offset:44544
    v_mfma_f32_16x16x32_bf16 v[188:191], v[144:147], a[96:99], v[188:191]
    v_mfma_f32_16x16x32_bf16 v[192:195], v[144:147], a[160:163], v[192:195]
    v_mfma_f32_16x16x32_bf16 v[196:199], v[144:147], a[224:227], v[196:199]
    s_waitcnt lgkmcnt(4)
    v_mfma_f32_16x16x32_bf16 v[184:187], v[148:151], a[36:39], v[184:187]
    ds_read_b64_tr_b16 v[160:161], v32 offset:51200
    ds_read_b64_tr_b16 v[162:163], v32 offset:51712
    v_mfma_f32_16x16x32_bf16 v[188:191], v[148:151], a[100:103], v[188:191]
    v_mfma_f32_16x16x32_bf16 v[192:195], v[148:151], a[164:167], v[192:195]
    v_mfma_f32_16x16x32_bf16 v[196:199], v[148:151], a[228:231], v[196:199]
    s_waitcnt lgkmcnt(4)
    v_mfma_f32_16x16x32_bf16 v[184:187], v[152:155], a[40:43], v[184:187]
    ds_read_b64_tr_b16 v[164:165], v32 offset:59392
    ds_read_b64_tr_b16 v[166:167], v32 offset:59904
    v_mfma_f32_16x16x32_bf16 v[188:191], v[152:155], a[104:107], v[188:191]
    v_mfma_f32_16x16x32_bf16 v[192:195], v[152:155], a[168:171], v[192:195]
    v_mfma_f32_16x16x32_bf16 v[196:199], v[152:155], a[232:235], v[196:199]
    s_waitcnt lgkmcnt(4)
    v_mfma_f32_16x16x32_bf16 v[184:187], v[156:159], a[44:47], v[184:187]
    ds_read_b64_tr_b16 v[168:169], v32 offset:52224
    ds_read_b64_tr_b16 v[170:171], v32 offset:52736
    v_mfma_f32_16x16x32_bf16 v[188:191], v[156:159], a[108:111], v[188:191]
    v_mfma_f32_16x16x32_bf16 v[192:195], v[156:159], a[172:175], v[192:195]
    v_mfma_f32_16x16x32_bf16 v[196:199], v[156:159], a[236:239], v[196:199]
    s_waitcnt lgkmcnt(4)
    v_mfma_f32_16x16x32_bf16 v[184:187], v[160:163], a[48:51], v[184:187]
    ds_read_b64_tr_b16 v[172:173], v32 offset:60416
    ds_read_b64_tr_b16 v[174:175], v32 offset:60928
    v_mfma_f32_16x16x32_bf16 v[188:191], v[160:163], a[112:115], v[188:191]
    v_mfma_f32_16x16x32_bf16 v[192:195], v[160:163], a[176:179], v[192:195]
    v_mfma_f32_16x16x32_bf16 v[196:199], v[160:163], a[240:243], v[196:199]
    s_waitcnt lgkmcnt(4)
    v_mfma_f32_16x16x32_bf16 v[184:187], v[164:167], a[52:55], v[184:187]
    ds_read_b64_tr_b16 v[144:145], v35 offset:0
    ds_read_b64_tr_b16 v[146:147], v35 offset:512
    v_mfma_f32_16x16x32_bf16 v[188:191], v[164:167], a[116:119], v[188:191]
    v_mfma_f32_16x16x32_bf16 v[192:195], v[164:167], a[180:183], v[192:195]
    v_mfma_f32_16x16x32_bf16 v[196:199], v[164:167], a[244:247], v[196:199]
    s_waitcnt lgkmcnt(4)
    v_mfma_f32_16x16x32_bf16 v[184:187], v[168:171], a[56:59], v[184:187]
    ds_read_b64_tr_b16 v[148:149], v35 offset:8192
    ds_read_b64_tr_b16 v[150:151], v35 offset:8704
    v_mfma_f32_16x16x32_bf16 v[188:191], v[168:171], a[120:123], v[188:191]
    v_mfma_f32_16x16x32_bf16 v[192:195], v[168:171], a[184:187], v[192:195]
    v_mfma_f32_16x16x32_bf16 v[196:199], v[168:171], a[248:251], v[196:199]
    s_waitcnt lgkmcnt(4)
    v_mfma_f32_16x16x32_bf16 v[184:187], v[172:175], a[60:63], v[184:187]
    ds_read_b64_tr_b16 v[152:153], v35 offset:1024
    ds_read_b64_tr_b16 v[154:155], v35 offset:1536
    v_mfma_f32_16x16x32_bf16 v[188:191], v[172:175], a[124:127], v[188:191]
    v_mfma_f32_16x16x32_bf16 v[192:195], v[172:175], a[188:191], v[192:195]
    v_mfma_f32_16x16x32_bf16 v[196:199], v[172:175], a[252:255], v[196:199]
    s_waitcnt lgkmcnt(4)
    v_mfma_f32_16x16x32_bf16 v[200:203], v[144:147], a[0:3], 0
    ds_read_b64_tr_b16 v[156:157], v35 offset:9216
    ds_read_b64_tr_b16 v[158:159], v35 offset:9728
    v_mfma_f32_16x16x32_bf16 v[204:207], v[144:147], a[64:67], 0
    v_cvt_pk_bf16_f32 v136, v184, v185
    v_cvt_pk_bf16_f32 v137, v186, v187
    v_mfma_f32_16x16x32_bf16 v[208:211], v[144:147], a[128:131], 0
    v_cvt_pk_bf16_f32 v138, v188, v189
    v_cvt_pk_bf16_f32 v139, v190, v191
    v_mfma_f32_16x16x32_bf16 v[212:215], v[144:147], a[192:195], 0
    v_cvt_pk_bf16_f32 v140, v192, v193
    v_cvt_pk_bf16_f32 v141, v194, v195
    s_waitcnt lgkmcnt(4)
    v_mfma_f32_16x16x32_bf16 v[200:203], v[148:151], a[4:7], v[200:203]
    ds_read_b64_tr_b16 v[160:161], v35 offset:16384
    ds_read_b64_tr_b16 v[162:163], v35 offset:16896
    v_mfma_f32_16x16x32_bf16 v[204:207], v[148:151], a[68:71], v[204:207]
    v_cvt_pk_bf16_f32 v142, v196, v197
    v_cvt_pk_bf16_f32 v143, v198, v199
    v_mfma_f32_16x16x32_bf16 v[208:211], v[148:151], a[132:135], v[208:211]
    v_mfma_f32_16x16x16_bf16 v[72:75], v[240:241], v[136:137], v[48:51]
    v_mfma_f32_16x16x32_bf16 v[212:215], v[148:151], a[196:199], v[212:215]
    v_mfma_f32_16x16x16_bf16 v[76:79], v[176:177], v[136:137], v[52:55]
    v_mfma_f32_16x16x16_bf16 v[84:87], v[244:245], v[138:139], v[48:51]
    s_waitcnt lgkmcnt(4)
    v_mfma_f32_16x16x32_bf16 v[200:203], v[152:155], a[8:11], v[200:203]
    ds_read_b64_tr_b16 v[164:165], v35 offset:24576
    ds_read_b64_tr_b16 v[166:167], v35 offset:25088
    v_mfma_f32_16x16x32_bf16 v[204:207], v[152:155], a[72:75], v[204:207]
    v_mfma_f32_16x16x16_bf16 v[88:91], v[180:181], v[138:139], v[52:55]
    v_mfma_f32_16x16x16_bf16 v[96:99], v[248:249], v[140:141], v[48:51]
    v_mfma_f32_16x16x32_bf16 v[208:211], v[152:155], a[136:139], v[208:211]
    v_mfma_f32_16x16x16_bf16 v[100:103], v[240:241], v[140:141], v[52:55]
    v_mfma_f32_16x16x16_bf16 v[108:111], v[252:253], v[142:143], v[48:51]
    v_mfma_f32_16x16x32_bf16 v[212:215], v[152:155], a[200:203], v[212:215]
    v_mfma_f32_16x16x16_bf16 v[112:115], v[244:245], v[142:143], v[52:55]
    v_max_f32 v72, v72, v76
    s_waitcnt lgkmcnt(4)
    v_mfma_f32_16x16x32_bf16 v[200:203], v[156:159], a[12:15], v[200:203]
    ds_read_b64_tr_b16 v[168:169], v35 offset:17408
    ds_read_b64_tr_b16 v[170:171], v35 offset:17920
    v_mfma_f32_16x16x32_bf16 v[204:207], v[156:159], a[76:79], v[204:207]
    v_max_f32 v73, v73, v77
    v_max_f32 v74, v74, v78
    v_mfma_f32_16x16x32_bf16 v[208:211], v[156:159], a[140:143], v[208:211]
    v_max_f32 v75, v75, v79
    v_max_f32 v84, v84, v88
    v_mfma_f32_16x16x32_bf16 v[212:215], v[156:159], a[204:207], v[212:215]
    v_max_f32 v85, v85, v89
    v_max_f32 v86, v86, v90
    s_waitcnt lgkmcnt(4)
    v_mfma_f32_16x16x32_bf16 v[200:203], v[160:163], a[16:19], v[200:203]
    ds_read_b64_tr_b16 v[172:173], v35 offset:25600
    ds_read_b64_tr_b16 v[174:175], v35 offset:26112
    v_mfma_f32_16x16x32_bf16 v[204:207], v[160:163], a[80:83], v[204:207]
    v_max_f32 v87, v87, v91
    v_max_f32 v96, v96, v100
    v_mfma_f32_16x16x32_bf16 v[208:211], v[160:163], a[144:147], v[208:211]
    v_max_f32 v97, v97, v101
    v_max_f32 v98, v98, v102
    v_mfma_f32_16x16x32_bf16 v[212:215], v[160:163], a[208:211], v[212:215]
    v_max_f32 v99, v99, v103
    v_max_f32 v108, v108, v112
    s_waitcnt lgkmcnt(4)
    v_mfma_f32_16x16x32_bf16 v[200:203], v[164:167], a[20:23], v[200:203]
    ds_read_b64_tr_b16 v[144:145], v35 offset:34816
    ds_read_b64_tr_b16 v[146:147], v35 offset:35328
    v_mfma_f32_16x16x32_bf16 v[204:207], v[164:167], a[84:87], v[204:207]
    v_max_f32 v109, v109, v113
    v_max_f32 v110, v110, v114
    v_mfma_f32_16x16x32_bf16 v[208:211], v[164:167], a[148:151], v[208:211]
    v_max_f32 v111, v111, v115
    v_max3_f32 v76, v72, v73, v74
    v_mfma_f32_16x16x32_bf16 v[212:215], v[164:167], a[212:215], v[212:215]
    v_max3_f32 v88, v84, v85, v86
    v_max3_f32 v100, v96, v97, v98
    s_waitcnt lgkmcnt(4)
    v_mfma_f32_16x16x32_bf16 v[200:203], v[168:171], a[24:27], v[200:203]
    ds_read_b64_tr_b16 v[148:149], v35 offset:43008
    ds_read_b64_tr_b16 v[150:151], v35 offset:43520
    v_mfma_f32_16x16x32_bf16 v[204:207], v[168:171], a[88:91], v[204:207]
    v_max3_f32 v112, v108, v109, v110
    v_max_f32 v76, v76, v75
    v_mfma_f32_16x16x32_bf16 v[208:211], v[168:171], a[152:155], v[208:211]
    v_max_f32 v88, v88, v87
    v_max_f32 v100, v100, v99
    v_mfma_f32_16x16x32_bf16 v[212:215], v[168:171], a[216:219], v[212:215]
    v_max_f32 v112, v112, v111
    v_mov_b32 v77, v76
    s_waitcnt lgkmcnt(4)
    v_mfma_f32_16x16x32_bf16 v[200:203], v[172:175], a[28:31], v[200:203]
    ds_read_b64_tr_b16 v[152:153], v35 offset:35840
    ds_read_b64_tr_b16 v[154:155], v35 offset:36352
    v_mfma_f32_16x16x32_bf16 v[204:207], v[172:175], a[92:95], v[204:207]
    v_mov_b32 v89, v88
    v_mov_b32 v101, v100
    v_mfma_f32_16x16x32_bf16 v[208:211], v[172:175], a[156:159], v[208:211]
    v_mov_b32 v113, v112
    v_permlane32_swap_b32 v76, v77
    v_mfma_f32_16x16x32_bf16 v[212:215], v[172:175], a[220:223], v[212:215]
    v_permlane32_swap_b32 v88, v89
    v_permlane32_swap_b32 v100, v101
    s_waitcnt lgkmcnt(4)
    v_mfma_f32_16x16x32_bf16 v[200:203], v[144:147], a[32:35], v[200:203]
    ds_read_b64_tr_b16 v[156:157], v35 offset:44032
    ds_read_b64_tr_b16 v[158:159], v35 offset:44544
    v_mfma_f32_16x16x32_bf16 v[204:207], v[144:147], a[96:99], v[204:207]
    v_permlane32_swap_b32 v112, v113
    v_max_f32 v76, v76, v77
    v_mfma_f32_16x16x32_bf16 v[208:211], v[144:147], a[160:163], v[208:211]
    v_max_f32 v88, v88, v89
    v_max_f32 v100, v100, v101
    v_mfma_f32_16x16x32_bf16 v[212:215], v[144:147], a[224:227], v[212:215]
    v_max_f32 v112, v112, v113
    v_mov_b32 v77, v76
    s_waitcnt lgkmcnt(4)
    v_mfma_f32_16x16x32_bf16 v[200:203], v[148:151], a[36:39], v[200:203]
    ds_read_b64_tr_b16 v[160:161], v35 offset:51200
    ds_read_b64_tr_b16 v[162:163], v35 offset:51712
    v_mfma_f32_16x16x32_bf16 v[204:207], v[148:151], a[100:103], v[204:207]
    v_mov_b32 v89, v88
    v_mov_b32 v101, v100
    v_mfma_f32_16x16x32_bf16 v[208:211], v[148:151], a[164:167], v[208:211]
    v_mov_b32 v113, v112
    v_permlane16_swap_b32 v76, v77
    v_mfma_f32_16x16x32_bf16 v[212:215], v[148:151], a[228:231], v[212:215]
    v_permlane16_swap_b32 v88, v89
    v_permlane16_swap_b32 v100, v101
    s_waitcnt lgkmcnt(4)
    v_mfma_f32_16x16x32_bf16 v[200:203], v[152:155], a[40:43], v[200:203]
    ds_read_b64_tr_b16 v[164:165], v35 offset:59392
    ds_read_b64_tr_b16 v[166:167], v35 offset:59904
    v_mfma_f32_16x16x32_bf16 v[204:207], v[152:155], a[104:107], v[204:207]
    v_permlane16_swap_b32 v112, v113
    v_max_f32 v76, v76, v77
    v_mfma_f32_16x16x32_bf16 v[208:211], v[152:155], a[168:171], v[208:211]
    v_max_f32 v88, v88, v89
    v_max_f32 v100, v100, v101
    v_mfma_f32_16x16x32_bf16 v[212:215], v[152:155], a[232:235], v[212:215]
    v_max_f32 v112, v112, v113
    v_mul_f32 v76, s62, v76
    s_waitcnt lgkmcnt(4)
    v_mfma_f32_16x16x32_bf16 v[200:203], v[156:159], a[44:47], v[200:203]
    ds_read_b64_tr_b16 v[168:169], v35 offset:52224
    ds_read_b64_tr_b16 v[170:171], v35 offset:52736
    v_mfma_f32_16x16x32_bf16 v[204:207], v[156:159], a[108:111], v[204:207]
    v_mul_f32 v88, s62, v88
    v_mul_f32 v100, s62, v100
    v_mfma_f32_16x16x32_bf16 v[208:211], v[156:159], a[172:175], v[208:211]
    v_mul_f32 v112, s62, v112
    v_pk_fma_f32 v[72:73], v[72:73], s[96:97], v[76:77] op_sel_hi:[1,1,0]
    v_mfma_f32_16x16x32_bf16 v[212:215], v[156:159], a[236:239], v[212:215]
    v_pk_fma_f32 v[74:75], v[74:75], s[96:97], v[76:77] op_sel_hi:[1,1,0]
    v_pk_fma_f32 v[84:85], v[84:85], s[96:97], v[88:89] op_sel_hi:[1,1,0]
    s_waitcnt lgkmcnt(4)
    v_mfma_f32_16x16x32_bf16 v[200:203], v[160:163], a[48:51], v[200:203]
    ds_read_b64_tr_b16 v[172:173], v35 offset:60416
    ds_read_b64_tr_b16 v[174:175], v35 offset:60928
    v_mfma_f32_16x16x32_bf16 v[204:207], v[160:163], a[112:115], v[204:207]
    v_pk_fma_f32 v[86:87], v[86:87], s[96:97], v[88:89] op_sel_hi:[1,1,0]
    v_pk_fma_f32 v[96:97], v[96:97], s[96:97], v[100:101] op_sel_hi:[1,1,0]
    v_mfma_f32_16x16x32_bf16 v[208:211], v[160:163], a[176:179], v[208:211]
    v_pk_fma_f32 v[98:99], v[98:99], s[96:97], v[100:101] op_sel_hi:[1,1,0]
    v_pk_fma_f32 v[108:109], v[108:109], s[96:97], v[112:113] op_sel_hi:[1,1,0]
    v_mfma_f32_16x16x32_bf16 v[212:215], v[160:163], a[240:243], v[212:215]
    v_pk_fma_f32 v[110:111], v[110:111], s[96:97], v[112:113] op_sel_hi:[1,1,0]
    v_exp_f32 v72, v72
    s_waitcnt lgkmcnt(4)
    v_mfma_f32_16x16x32_bf16 v[200:203], v[164:167], a[52:55], v[200:203]
    v_exp_f32 v73, v73
    v_exp_f32 v74, v74
    v_mfma_f32_16x16x32_bf16 v[204:207], v[164:167], a[116:119], v[204:207]
    v_exp_f32 v75, v75
    v_exp_f32 v84, v84
    v_mfma_f32_16x16x32_bf16 v[208:211], v[164:167], a[180:183], v[208:211]
    v_exp_f32 v85, v85
    v_exp_f32 v86, v86
    v_mfma_f32_16x16x32_bf16 v[212:215], v[164:167], a[244:247], v[212:215]
    v_exp_f32 v87, v87
    v_exp_f32 v96, v96
    s_waitcnt lgkmcnt(2)
    v_mfma_f32_16x16x32_bf16 v[200:203], v[168:171], a[56:59], v[200:203]
    v_exp_f32 v97, v97
    v_exp_f32 v98, v98
    v_mfma_f32_16x16x32_bf16 v[204:207], v[168:171], a[120:123], v[204:207]
    v_exp_f32 v99, v99
    v_exp_f32 v108, v108
    v_mfma_f32_16x16x32_bf16 v[208:211], v[168:171], a[184:187], v[208:211]
    v_exp_f32 v109, v109
    v_exp_f32 v110, v110
    v_mfma_f32_16x16x32_bf16 v[212:215], v[168:171], a[248:251], v[212:215]
    v_exp_f32 v111, v111
    v_cvt_pk_bf16_f32 v76, v72, v73
    s_waitcnt lgkmcnt(0)
    v_mfma_f32_16x16x32_bf16 v[200:203], v[172:175], a[60:63], v[200:203]
    v_cvt_pk_bf16_f32 v77, v74, v75
    v_cvt_pk_bf16_f32 v88, v84, v85
    v_mfma_f32_16x16x32_bf16 v[204:207], v[172:175], a[124:127], v[204:207]
    v_cvt_pk_bf16_f32 v89, v86, v87
    v_cvt_pk_bf16_f32 v100, v96, v97
    v_mfma_f32_16x16x32_bf16 v[208:211], v[172:175], a[188:191], v[208:211]
    v_cvt_pk_bf16_f32 v101, v98, v99
    v_cvt_pk_bf16_f32 v112, v108, v109
    v_mfma_f32_16x16x32_bf16 v[212:215], v[172:175], a[252:255], v[212:215]
    v_cvt_pk_bf16_f32 v113, v110, v111
    v_and_b32 v82, v76, v64
    v_and_b32 v83, v77, v65
    v_xor_b32 v80, v76, v82
    v_xor_b32 v81, v77, v83
    v_and_b32 v94, v88, v64
    v_and_b32 v95, v89, v65
    v_xor_b32 v92, v88, v94
    v_xor_b32 v93, v89, v95
    v_and_b32 v106, v100, v64
    v_and_b32 v107, v101, v65
    v_xor_b32 v104, v100, v106
    v_xor_b32 v105, v101, v107
    v_and_b32 v118, v112, v64
    v_and_b32 v119, v113, v65
    v_xor_b32 v116, v112, v118
    v_xor_b32 v117, v113, v119
    v_mfma_f32_16x16x16_bf16 v[184:187], v[66:67], v[76:77], 0
    v_mfma_f32_16x16x16_bf16 v[188:191], v[66:67], v[88:89], 0
    v_mfma_f32_16x16x16_bf16 v[192:195], v[66:67], v[100:101], 0
    v_mfma_f32_16x16x16_bf16 v[196:199], v[66:67], v[112:113], 0
    v_mfma_f32_16x16x32_bf16 v[72:75], v[216:219], v[80:83], 0
    v_mfma_f32_16x16x32_bf16 v[84:87], v[228:231], v[92:95], 0
    v_mfma_f32_16x16x32_bf16 v[96:99], v[218:221], v[104:107], 0
    v_mfma_f32_16x16x32_bf16 v[108:111], v[230:233], v[116:119], 0
    s_nop 0
    v_rcp_f32 v184, v184
    v_rcp_f32 v188, v188
    v_rcp_f32 v192, v192
    v_rcp_f32 v196, v196
    v_pk_mul_f32 v[72:73], v[72:73], v[184:185] op_sel_hi:[1,0]
    v_pk_mul_f32 v[74:75], v[74:75], v[184:185] op_sel_hi:[1,0]
    v_pk_mul_f32 v[84:85], v[84:85], v[188:189] op_sel_hi:[1,0]
    v_pk_mul_f32 v[86:87], v[86:87], v[188:189] op_sel_hi:[1,0]
    v_pk_mul_f32 v[96:97], v[96:97], v[192:193] op_sel_hi:[1,0]
    v_pk_mul_f32 v[98:99], v[98:99], v[192:193] op_sel_hi:[1,0]
    v_pk_mul_f32 v[108:109], v[108:109], v[196:197] op_sel_hi:[1,0]
    v_pk_mul_f32 v[110:111], v[110:111], v[196:197] op_sel_hi:[1,0]
    v_cvt_pk_bf16_f32 v120, v72, v73
    v_cvt_pk_bf16_f32 v121, v74, v75
    v_cvt_pk_bf16_f32 v124, v84, v85
    v_cvt_pk_bf16_f32 v125, v86, v87
    v_cvt_pk_bf16_f32 v128, v96, v97
    v_cvt_pk_bf16_f32 v129, v98, v99
    v_cvt_pk_bf16_f32 v132, v108, v109
    v_cvt_pk_bf16_f32 v133, v110, v111
    s_waitcnt lgkmcnt(0)
    s_waitcnt vmcnt(0)
    s_barrier
    v_cvt_pk_bf16_f32 v136, v200, v201
    v_cvt_pk_bf16_f32 v137, v202, v203
    v_cvt_pk_bf16_f32 v138, v204, v205
    v_cvt_pk_bf16_f32 v139, v206, v207
    v_cvt_pk_bf16_f32 v140, v208, v209
    v_cvt_pk_bf16_f32 v141, v210, v211
    v_cvt_pk_bf16_f32 v142, v212, v213
    v_cvt_pk_bf16_f32 v143, v214, v215
    s_add_u32 m0, s7, 0
    s_add_u32 s60, s65, 262144
    buffer_load_dwordx4 v12, s[40:43], s60 offen offset:0 lds
    v_mfma_f32_16x16x16_bf16 v[72:75], v[242:243], v[136:137], v[48:51]
    v_mfma_f32_16x16x16_bf16 v[76:79], v[178:179], v[136:137], v[52:55]
    v_mfma_f32_16x16x16_bf16 v[84:87], v[246:247], v[138:139], v[48:51]
    v_mfma_f32_16x16x16_bf16 v[88:91], v[182:183], v[138:139], v[52:55]
    v_mfma_f32_16x16x16_bf16 v[96:99], v[250:251], v[140:141], v[48:51]
    v_mfma_f32_16x16x16_bf16 v[100:103], v[242:243], v[140:141], v[52:55]
    v_mfma_f32_16x16x16_bf16 v[108:111], v[254:255], v[142:143], v[48:51]
    v_mfma_f32_16x16x16_bf16 v[112:115], v[246:247], v[142:143], v[52:55]
    s_nop 1
    v_max_f32 v72, v72, v76
    buffer_load_dwordx4 v13, s[40:43], s60 offen offset:1024 lds
    v_max_f32 v73, v73, v77
    v_max_f32 v74, v74, v78
    v_max_f32 v75, v75, v79
    v_max_f32 v84, v84, v88
    v_max_f32 v85, v85, v89
    v_max_f32 v86, v86, v90
    v_max_f32 v87, v87, v91
    v_max_f32 v96, v96, v100
    v_max_f32 v97, v97, v101
    buffer_load_dwordx4 v16, s[40:43], s60 offen offset:2048 lds
    v_max_f32 v98, v98, v102
    v_max_f32 v99, v99, v103
    v_max_f32 v108, v108, v112
    v_max_f32 v109, v109, v113
    v_max_f32 v110, v110, v114
    v_max_f32 v111, v111, v115
    v_max3_f32 v76, v72, v73, v74
    v_max3_f32 v88, v84, v85, v86
    v_max3_f32 v100, v96, v97, v98
    buffer_load_dwordx4 v17, s[40:43], s60 offen offset:3072 lds
    v_max3_f32 v112, v108, v109, v110
    v_max_f32 v76, v76, v75
    v_max_f32 v88, v88, v87
    v_max_f32 v100, v100, v99
    v_max_f32 v112, v112, v111
    v_mov_b32 v77, v76
    v_mov_b32 v89, v88
    v_mov_b32 v101, v100
    v_mov_b32 v113, v112
    s_add_u32 m0, s7, 4096
    s_add_u32 s60, s65, 278528
    buffer_load_dwordx4 v12, s[40:43], s60 offen offset:0 lds
    v_permlane32_swap_b32 v76, v77
    v_permlane32_swap_b32 v88, v89
    v_permlane32_swap_b32 v100, v101
    v_permlane32_swap_b32 v112, v113
    v_max_f32 v76, v76, v77
    v_max_f32 v88, v88, v89
    v_max_f32 v100, v100, v101
    v_max_f32 v112, v112, v113
    v_mov_b32 v77, v76
    buffer_load_dwordx4 v13, s[40:43], s60 offen offset:1024 lds
    v_mov_b32 v89, v88
    v_mov_b32 v101, v100
    v_mov_b32 v113, v112
    v_permlane16_swap_b32 v76, v77
    v_permlane16_swap_b32 v88, v89
    v_permlane16_swap_b32 v100, v101
    v_permlane16_swap_b32 v112, v113
    v_max_f32 v76, v76, v77
    v_max_f32 v88, v88, v89
    buffer_load_dwordx4 v16, s[40:43], s60 offen offset:2048 lds
    v_max_f32 v100, v100, v101
    v_max_f32 v112, v112, v113
    v_mul_f32 v76, s62, v76
    v_mul_f32 v88, s62, v88
    v_mul_f32 v100, s62, v100
    v_mul_f32 v112, s62, v112
    v_pk_fma_f32 v[72:73], v[72:73], s[96:97], v[76:77] op_sel_hi:[1,1,0]
    v_pk_fma_f32 v[74:75], v[74:75], s[96:97], v[76:77] op_sel_hi:[1,1,0]
    v_pk_fma_f32 v[84:85], v[84:85], s[96:97], v[88:89] op_sel_hi:[1,1,0]
    buffer_load_dwordx4 v17, s[40:43], s60 offen offset:3072 lds
    v_pk_fma_f32 v[86:87], v[86:87], s[96:97], v[88:89] op_sel_hi:[1,1,0]
    v_pk_fma_f32 v[96:97], v[96:97], s[96:97], v[100:101] op_sel_hi:[1,1,0]
    v_pk_fma_f32 v[98:99], v[98:99], s[96:97], v[100:101] op_sel_hi:[1,1,0]
    v_pk_fma_f32 v[108:109], v[108:109], s[96:97], v[112:113] op_sel_hi:[1,1,0]
    v_pk_fma_f32 v[110:111], v[110:111], s[96:97], v[112:113] op_sel_hi:[1,1,0]
    v_exp_f32 v72, v72
    v_exp_f32 v73, v73
    v_exp_f32 v74, v74
    v_exp_f32 v75, v75
    s_add_u32 m0, s7, 32768
    s_add_u32 s60, s65, 393216
    buffer_load_dwordx4 v12, s[40:43], s60 offen offset:0 lds
    v_exp_f32 v84, v84
    v_exp_f32 v85, v85
    v_exp_f32 v86, v86
    v_exp_f32 v87, v87
    v_exp_f32 v96, v96
    v_exp_f32 v97, v97
    v_exp_f32 v98, v98
    v_exp_f32 v99, v99
    v_exp_f32 v108, v108
    buffer_load_dwordx4 v13, s[40:43], s60 offen offset:1024 lds
    v_exp_f32 v109, v109
    v_exp_f32 v110, v110
    v_exp_f32 v111, v111
    v_cvt_pk_bf16_f32 v76, v72, v73
    v_cvt_pk_bf16_f32 v77, v74, v75
    v_cvt_pk_bf16_f32 v88, v84, v85
    v_cvt_pk_bf16_f32 v89, v86, v87
    v_cvt_pk_bf16_f32 v100, v96, v97
    v_cvt_pk_bf16_f32 v101, v98, v99
    buffer_load_dwordx4 v16, s[40:43], s60 offen offset:2048 lds
    v_cvt_pk_bf16_f32 v112, v108, v109
    v_cvt_pk_bf16_f32 v113, v110, v111
    v_and_b32 v82, v76, v64
    v_and_b32 v83, v77, v65
    v_xor_b32 v80, v76, v82
    v_xor_b32 v81, v77, v83
    v_and_b32 v94, v88, v64
    v_and_b32 v95, v89, v65
    v_xor_b32 v92, v88, v94
    buffer_load_dwordx4 v17, s[40:43], s60 offen offset:3072 lds
    v_xor_b32 v93, v89, v95
    v_and_b32 v106, v100, v64
    v_and_b32 v107, v101, v65
    v_xor_b32 v104, v100, v106
    v_xor_b32 v105, v101, v107
    v_and_b32 v118, v112, v64
    v_and_b32 v119, v113, v65
    v_xor_b32 v116, v112, v118
    v_xor_b32 v117, v113, v119
    s_add_u32 m0, s7, 36864
    s_add_u32 s60, s65, 409600
    buffer_load_dwordx4 v12, s[40:43], s60 offen offset:0 lds
    v_mfma_f32_16x16x16_bf16 v[200:203], v[66:67], v[76:77], 0
    v_mfma_f32_16x16x16_bf16 v[204:207], v[66:67], v[88:89], 0
    v_mfma_f32_16x16x16_bf16 v[208:211], v[66:67], v[100:101], 0
    v_mfma_f32_16x16x16_bf16 v[212:215], v[66:67], v[112:113], 0
    v_mfma_f32_16x16x32_bf16 v[72:75], v[222:225], v[80:83], 0
    v_mfma_f32_16x16x32_bf16 v[84:87], v[234:237], v[92:95], 0
    v_mfma_f32_16x16x32_bf16 v[96:99], v[224:227], v[104:107], 0
    v_mfma_f32_16x16x32_bf16 v[108:111], v[236:239], v[116:119], 0
    s_nop 0
    v_rcp_f32 v200, v200
    buffer_load_dwordx4 v13, s[40:43], s60 offen offset:1024 lds
    v_rcp_f32 v204, v204
    v_rcp_f32 v208, v208
    v_rcp_f32 v212, v212
    v_pk_mul_f32 v[72:73], v[72:73], v[200:201] op_sel_hi:[1,0]
    v_pk_mul_f32 v[74:75], v[74:75], v[200:201] op_sel_hi:[1,0]
    v_pk_mul_f32 v[84:85], v[84:85], v[204:205] op_sel_hi:[1,0]
    v_pk_mul_f32 v[86:87], v[86:87], v[204:205] op_sel_hi:[1,0]
    v_pk_mul_f32 v[96:97], v[96:97], v[208:209] op_sel_hi:[1,0]
    v_pk_mul_f32 v[98:99], v[98:99], v[208:209] op_sel_hi:[1,0]
    buffer_load_dwordx4 v16, s[40:43], s60 offen offset:2048 lds
    v_pk_mul_f32 v[108:109], v[108:109], v[212:213] op_sel_hi:[1,0]
    v_pk_mul_f32 v[110:111], v[110:111], v[212:213] op_sel_hi:[1,0]
    v_cvt_pk_bf16_f32 v122, v72, v73
    v_cvt_pk_bf16_f32 v123, v74, v75
    v_cvt_pk_bf16_f32 v126, v84, v85
    v_cvt_pk_bf16_f32 v127, v86, v87
    v_cvt_pk_bf16_f32 v130, v96, v97
    v_cvt_pk_bf16_f32 v131, v98, v99
    v_cvt_pk_bf16_f32 v134, v108, v109
    buffer_load_dwordx4 v17, s[40:43], s60 offen offset:3072 lds
    v_cvt_pk_bf16_f32 v135, v110, v111
    s_add_u32 s60, s4, 0
    buffer_store_dwordx4 v[120:123], v46, s[32:35], s60 offen sc1
    s_add_u32 s60, s4, 16384
    buffer_store_dwordx4 v[124:127], v46, s[32:35], s60 offen sc1
    s_add_u32 s60, s4, 32768
    buffer_store_dwordx4 v[128:131], v46, s[32:35], s60 offen sc1
    s_add_u32 s60, s4, 49152
    buffer_store_dwordx4 v[132:135], v46, s[32:35], s60 offen sc1
    s_branch L_phase2
L_path2:
    s_lshl_b32 s58, s48, 4
    s_add_u32 s58, s58, s49
    s_lshl_b32 s13, s58, 7
    s_add_u32 s13, s13, 5242880
    s_lshl_b32 s11, s58, 8
    s_add_u32 s11, s11, 5251072
    s_lshl_b32 s14, s50, 7
    s_add_u32 s14, s14, 5246976
    s_load_dwordx2 s[36:37], s[20:21], s13
    s_load_dwordx2 s[38:39], s[20:21], s14
    s_lshl_b32 s59, s50, 1
    s_add_u32 s59, s59, s53
    s_lshl_b32 s12, s59, 3
    s_add_u32 s12, s12, s11
    s_add_u32 s12, s12, 0
    s_lshr_b32 s60, s50, 2
    s_lshl_b32 s60, s60, 7
    s_add_u32 s11, s11, s60
    v_lshrrev_b32 v2, 4, v1
    v_and_b32 v3, 15, v1
    v_lshlrev_b32 v5, 1, v2
    v_xor_b32 v5, v3, v5
    v_lshlrev_b32 v6, 10, v2
    v_lshl_add_u32 v12, v5, 4, v6
    v_xor_b32 v6, 128, v12
    v_add_u32 v13, 3072, v6
    v_add_u32 v16, 6144, v12
    v_add_u32 v17, 9216, v6
    v_and_b32 v2, 15, v1
    v_lshrrev_b32 v3, 4, v1
    v_lshrrev_b32 v4, 1, v2
    v_xor_b32 v5, v3, v4
    v_lshlrev_b32 v6, 7, v2
    v_lshl_add_u32 v6, v5, 4, v6
    v_lshrrev_b32 v7, 3, v2
    v_lshl_add_u32 v7, v7, 10, v6
    v_add_u32 v20, 0, v7
    v_xor_b32 v23, 64, v20
    v_add_u32 v21, 65536, v20
    v_add_u32 v22, 131072, v20
    v_add_u32 v24, 65536, v23
    v_add_u32 v25, 131072, v23
    v_lshrrev_b32 v4, 2, v2
    v_and_b32 v5, 3, v2
    v_lshrrev_b32 v8, 3, v2
    v_and_b32 v7, 1, v3
    v_lshl_or_b32 v8, v7, 1, v8
    v_lshrrev_b32 v6, 1, v3
    v_lshlrev_b32 v6, 12, v6
    v_lshl_add_u32 v6, v7, 11, v6
    v_lshl_add_u32 v6, v4, 7, v6
    v_lshl_add_u32 v6, v5, 3, v6
    s_lshl_b32 s58, s53, 1
    v_xor_b32 v7, s58, v8
    v_lshl_add_u32 v32, v7, 5, v6
    v_xor_b32 v35, 32, v32
    v_add_u32 v33, 65536, v32
    v_add_u32 v34, 131072, v32
    v_add_u32 v36, 65536, v35
    v_add_u32 v37, 131072, v35
    v_lshlrev_b32 v46, 4, v1
    v_lshlrev_b32 v47, 3, v1
    s_mov_b32 s61, 0x3eb8aa3b
    s_mov_b32 s62, 0xbeb8aa3b
    s_mov_b32 s63, 0x3fb8aa3b
    s_mov_b32 s64, 0x358637bd
    s_mov_b32 s71, 300000
    s_mov_b32 s18, 0x3fb8aa3b
    s_mov_b32 s19, 0x3fb8aa3b
    s_mov_b32 s96, 0x3eb8aa3b
    s_mov_b32 s97, 0x3eb8aa3b
    v_mov_b32 v66, 0x3f803f80
    v_mov_b32 v67, 0x3f803f80
    v_mov_b32 v68, 0x3f803f80
    v_mov_b32 v69, 0x3f803f80
    s_lshl_b32 s58, s49, 3
    s_add_u32 s8, s58, 128
    s_add_u32 s4, s8, 0
    s_lshl_b32 s4, s4, 4
    s_add_u32 s4, s4, s59
    s_lshl_b32 s4, s4, 10
    s_lshr_b32 s59, s50, 2
    s_lshl_b32 s59, s59, 2
    s_add_u32 s8, s8, s59
    s_add_u32 s8, s8, s51
    s_lshl_b32 s8, s8, 14
    s_lshl_b32 s7, s51, 13
    s_lshl_b32 s58, s53, 13
    v_add_u32 v9, s58, v46
    v_add_u32 v9, 139264, v9
    s_lshl_b32 s58, s50, 2
    s_lshl_b32 s59, s53, 1
    s_add_u32 s58, s58, s59
    s_add_u32 s70, s58, 0
    s_lshl_b32 s58, s70, 4
    s_add_u32 s58, s58, s49
    s_lshl_b32 s5, s58, 10
    s_add_u32 s5, s5, 4194304
    s_lshl_b32 s6, s58, 6
    s_add_u32 s6, s6, 4718592
    s_add_u32 s17, s16, 2
    s_and_b32 s17, s17, 7
    s_add_u32 m0, s57, 69632
    s_lshl_b32 s60, s17, 7
    s_add_u32 s60, s60, s54
    buffer_load_dwordx4 v10, s[24:27], s60 offen offset:0 lds
    buffer_load_dwordx4 v10, s[24:27], s60 offen offset:1024 lds
    buffer_load_dwordx4 v11, s[24:27], s60 offen offset:2048 lds
    buffer_load_dwordx4 v11, s[24:27], s60 offen offset:3072 lds
    s_add_u32 m0, s57, 88064
    s_mul_i32 s60, s17, 196608
    s_add_u32 s60, s60, s66
    buffer_load_dwordx4 v14, s[28:31], s60 offen offset:0 lds
    buffer_load_dwordx4 v14, s[28:31], s60 offen offset:1024 lds
    buffer_load_dwordx4 v15, s[28:31], s60 offen offset:2048 lds
    buffer_load_dwordx4 v15, s[28:31], s60 offen offset:3072 lds
    s_waitcnt vmcnt(18)
    s_barrier
    ds_read_b128 a[0:3], v20 offset:0
    ds_read_b64_tr_b16 v[144:145], v32 offset:18432
    ds_read_b64_tr_b16 v[146:147], v32 offset:18944
    ds_read_b64_tr_b16 v[148:149], v32 offset:19456
    ds_read_b64_tr_b16 v[150:151], v32 offset:19968
    ds_read_b64_tr_b16 v[152:153], v35 offset:18432
    ds_read_b64_tr_b16 v[154:155], v35 offset:18944
    ds_read_b64_tr_b16 v[156:157], v35 offset:19456
    ds_read_b64_tr_b16 v[158:159], v35 offset:19968
    ds_read_b128 a[64:67], v20 offset:1024
    ds_read_b128 a[128:131], v20 offset:4096
    ds_read_b128 a[192:195], v20 offset:5120
    s_waitcnt lgkmcnt(11)
    s_waitcnt lgkmcnt(9)
    v_mfma_f32_16x16x32_bf16 v[72:75], a[0:3], v[144:147], 0
    ds_read_b128 a[4:7], v23 offset:0
    s_waitcnt lgkmcnt(8)
    v_mfma_f32_16x16x32_bf16 v[76:79], a[0:3], v[148:151], 0
    ds_read_b64_tr_b16 v[160:161], v32 offset:26624
    s_waitcnt lgkmcnt(7)
    v_mfma_f32_16x16x32_bf16 v[80:83], a[0:3], v[152:155], 0
    ds_read_b64_tr_b16 v[162:163], v32 offset:27136
    s_waitcnt lgkmcnt(6)
    v_mfma_f32_16x16x32_bf16 v[84:87], a[0:3], v[156:159], 0
    s_add_u32 s17, s16, 3
    s_and_b32 s17, s17, 7
    s_add_u32 m0, s57, 104448
    s_lshl_b32 s60, s17, 7
    s_add_u32 s60, s60, s54
    buffer_load_dwordx4 v10, s[24:27], s60 offen offset:0 lds
    s_waitcnt lgkmcnt(5)
    v_mfma_f32_16x16x32_bf16 v[88:91], a[64:67], v[144:147], 0
    ds_read_b64_tr_b16 v[164:165], v32 offset:27648
    v_mfma_f32_16x16x32_bf16 v[92:95], a[64:67], v[148:151], 0
    ds_read_b64_tr_b16 v[166:167], v32 offset:28160
    v_mfma_f32_16x16x32_bf16 v[96:99], a[64:67], v[152:155], 0
    ds_read_b64_tr_b16 v[168:169], v35 offset:26624
    v_mfma_f32_16x16x32_bf16 v[100:103], a[64:67], v[156:159], 0
    buffer_load_dwordx4 v10, s[24:27], s60 offen offset:1024 lds
    s_waitcnt lgkmcnt(7)
    v_mfma_f32_16x16x32_bf16 v[104:107], a[128:131], v[144:147], 0
    ds_read_b64_tr_b16 v[170:171], v35 offset:27136
    v_mfma_f32_16x16x32_bf16 v[108:111], a[128:131], v[148:151], 0
    ds_read_b64_tr_b16 v[172:173], v35 offset:27648
    v_mfma_f32_16x16x32_bf16 v[112:115], a[128:131], v[152:155], 0
    ds_read_b64_tr_b16 v[174:175], v35 offset:28160
    v_mfma_f32_16x16x32_bf16 v[116:119], a[128:131], v[156:159], 0
    buffer_load_dwordx4 v11, s[24:27], s60 offen offset:2048 lds
    s_waitcnt lgkmcnt(9)
    v_mfma_f32_16x16x32_bf16 v[120:123], a[192:195], v[144:147], 0
    ds_read_b128 a[68:71], v23 offset:1024
    v_mfma_f32_16x16x32_bf16 v[124:127], a[192:195], v[148:151], 0
    ds_read_b128 a[132:135], v23 offset:4096
    v_mfma_f32_16x16x32_bf16 v[128:131], a[192:195], v[152:155], 0
    ds_read_b128 a[196:199], v23 offset:5120
    v_mfma_f32_16x16x32_bf16 v[132:135], a[192:195], v[156:159], 0
    buffer_load_dwordx4 v11, s[24:27], s60 offen offset:3072 lds
    s_waitcnt lgkmcnt(11)
    s_waitcnt lgkmcnt(9)
    v_mfma_f32_16x16x32_bf16 v[72:75], a[4:7], v[160:163], v[72:75]
    s_waitcnt lgkmcnt(7)
    v_mfma_f32_16x16x32_bf16 v[76:79], a[4:7], v[164:167], v[76:79]
    s_add_u32 m0, s57, 122880
    s_mul_i32 s60, s17, 196608
    s_add_u32 s60, s60, s66
    buffer_load_dwordx4 v14, s[28:31], s60 offen offset:0 lds
    s_waitcnt lgkmcnt(5)
    v_mfma_f32_16x16x32_bf16 v[80:83], a[4:7], v[168:171], v[80:83]
    s_waitcnt lgkmcnt(3)
    v_mfma_f32_16x16x32_bf16 v[84:87], a[4:7], v[172:175], v[84:87]
    s_waitcnt lgkmcnt(0)
    s_waitcnt vmcnt(15)
    s_barrier
    v_mfma_f32_16x16x32_bf16 v[88:91], a[68:71], v[160:163], v[88:91]
    ds_read_b128 a[8:11], v20 offset:34816
    ds_read_b64_tr_b16 v[144:145], v32 offset:53248
    v_mfma_f32_16x16x32_bf16 v[92:95], a[68:71], v[164:167], v[92:95]
    ds_read_b64_tr_b16 v[146:147], v32 offset:53760
    ds_read_b64_tr_b16 v[148:149], v32 offset:54272
    v_mfma_f32_16x16x32_bf16 v[96:99], a[68:71], v[168:171], v[96:99]
    ds_read_b64_tr_b16 v[150:151], v32 offset:54784
    ds_read_b64_tr_b16 v[152:153], v35 offset:53248
    v_mfma_f32_16x16x32_bf16 v[100:103], a[68:71], v[172:175], v[100:103]
    buffer_load_dwordx4 v14, s[28:31], s60 offen offset:1024 lds
    ds_read_b64_tr_b16 v[154:155], v35 offset:53760
    v_mfma_f32_16x16x32_bf16 v[104:107], a[132:135], v[160:163], v[104:107]
    ds_read_b64_tr_b16 v[156:157], v35 offset:54272
    ds_read_b64_tr_b16 v[158:159], v35 offset:54784
    v_mfma_f32_16x16x32_bf16 v[108:111], a[132:135], v[164:167], v[108:111]
    ds_read_b128 a[72:75], v20 offset:35840
    ds_read_b128 a[136:139], v20 offset:38912
    v_mfma_f32_16x16x32_bf16 v[112:115], a[132:135], v[168:171], v[112:115]
    ds_read_b128 a[200:203], v20 offset:39936
    v_mfma_f32_16x16x32_bf16 v[116:119], a[132:135], v[172:175], v[116:119]
    buffer_load_dwordx4 v15, s[28:31], s60 offen offset:2048 lds
    v_mfma_f32_16x16x32_bf16 v[120:123], a[196:199], v[160:163], v[120:123]
    v_mfma_f32_16x16x32_bf16 v[124:127], a[196:199], v[164:167], v[124:127]
    v_mfma_f32_16x16x32_bf16 v[128:131], a[196:199], v[168:171], v[128:131]
    v_mfma_f32_16x16x32_bf16 v[132:135], a[196:199], v[172:175], v[132:135]
    buffer_load_dwordx4 v15, s[28:31], s60 offen offset:3072 lds
    s_waitcnt lgkmcnt(11)
    s_waitcnt lgkmcnt(9)
    v_mfma_f32_16x16x32_bf16 v[72:75], a[8:11], v[144:147], v[72:75]
    ds_read_b128 a[12:15], v23 offset:34816
    s_waitcnt lgkmcnt(8)
    v_mfma_f32_16x16x32_bf16 v[76:79], a[8:11], v[148:151], v[76:79]
    ds_read_b64_tr_b16 v[160:161], v32 offset:61440
    s_waitcnt lgkmcnt(7)
    v_mfma_f32_16x16x32_bf16 v[80:83], a[8:11], v[152:155], v[80:83]
    ds_read_b64_tr_b16 v[162:163], v32 offset:61952
    s_waitcnt lgkmcnt(6)
    v_mfma_f32_16x16x32_bf16 v[84:87], a[8:11], v[156:159], v[84:87]
    s_add_u32 s17, s16, 4
    s_and_b32 s17, s17, 7
    s_add_u32 m0, s57, 0
    s_lshl_b32 s60, s17, 7
    s_add_u32 s60, s60, s54
    buffer_load_dwordx4 v10, s[24:27], s60 offen offset:0 lds
    s_waitcnt lgkmcnt(5)
    v_mfma_f32_16x16x32_bf16 v[88:91], a[72:75], v[144:147], v[88:91]
    ds_read_b64_tr_b16 v[164:165], v32 offset:62464
    v_mfma_f32_16x16x32_bf16 v[92:95], a[72:75], v[148:151], v[92:95]
    ds_read_b64_tr_b16 v[166:167], v32 offset:62976
    v_mfma_f32_16x16x32_bf16 v[96:99], a[72:75], v[152:155], v[96:99]
    ds_read_b64_tr_b16 v[168:169], v35 offset:61440
    v_mfma_f32_16x16x32_bf16 v[100:103], a[72:75], v[156:159], v[100:103]
    buffer_load_dwordx4 v10, s[24:27], s60 offen offset:1024 lds
    s_waitcnt lgkmcnt(7)
    v_mfma_f32_16x16x32_bf16 v[104:107], a[136:139], v[144:147], v[104:107]
    ds_read_b64_tr_b16 v[170:171], v35 offset:61952
    v_mfma_f32_16x16x32_bf16 v[108:111], a[136:139], v[148:151], v[108:111]
    ds_read_b64_tr_b16 v[172:173], v35 offset:62464
    v_mfma_f32_16x16x32_bf16 v[112:115], a[136:139], v[152:155], v[112:115]
    ds_read_b64_tr_b16 v[174:175], v35 offset:62976
    v_mfma_f32_16x16x32_bf16 v[116:119], a[136:139], v[156:159], v[116:119]
    buffer_load_dwordx4 v11, s[24:27], s60 offen offset:2048 lds
    s_waitcnt lgkmcnt(9)
    v_mfma_f32_16x16x32_bf16 v[120:123], a[200:203], v[144:147], v[120:123]
    ds_read_b128 a[76:79], v23 offset:35840
    v_mfma_f32_16x16x32_bf16 v[124:127], a[200:203], v[148:151], v[124:127]
    ds_read_b128 a[140:143], v23 offset:38912
    v_mfma_f32_16x16x32_bf16 v[128:131], a[200:203], v[152:155], v[128:131]
    ds_read_b128 a[204:207], v23 offset:39936
    v_mfma_f32_16x16x32_bf16 v[132:135], a[200:203], v[156:159], v[132:135]
    buffer_load_dwordx4 v11, s[24:27], s60 offen offset:3072 lds
    s_waitcnt lgkmcnt(11)
    s_waitcnt lgkmcnt(9)
    v_mfma_f32_16x16x32_bf16 v[72:75], a[12:15], v[160:163], v[72:75]
    s_waitcnt lgkmcnt(7)
    v_mfma_f32_16x16x32_bf16 v[76:79], a[12:15], v[164:167], v[76:79]
    s_add_u32 m0, s57, 18432
    s_mul_i32 s60, s17, 196608
    s_add_u32 s60, s60, s66
    buffer_load_dwordx4 v14, s[28:31], s60 offen offset:0 lds
    s_waitcnt lgkmcnt(5)
    v_mfma_f32_16x16x32_bf16 v[80:83], a[12:15], v[168:171], v[80:83]
    s_waitcnt lgkmcnt(3)
    v_mfma_f32_16x16x32_bf16 v[84:87], a[12:15], v[172:175], v[84:87]
    s_waitcnt lgkmcnt(0)
    s_waitcnt vmcnt(13)
    s_barrier
    v_mfma_f32_16x16x32_bf16 v[88:91], a[76:79], v[160:163], v[88:91]
    ds_read_b128 a[16:19], v21 offset:4096
    ds_read_b64_tr_b16 v[144:145], v33 offset:22528
    v_mfma_f32_16x16x32_bf16 v[92:95], a[76:79], v[164:167], v[92:95]
    ds_read_b64_tr_b16 v[146:147], v33 offset:23040
    ds_read_b64_tr_b16 v[148:149], v33 offset:23552
    v_mfma_f32_16x16x32_bf16 v[96:99], a[76:79], v[168:171], v[96:99]
    ds_read_b64_tr_b16 v[150:151], v33 offset:24064
    ds_read_b64_tr_b16 v[152:153], v36 offset:22528
    v_mfma_f32_16x16x32_bf16 v[100:103], a[76:79], v[172:175], v[100:103]
    buffer_load_dwordx4 v14, s[28:31], s60 offen offset:1024 lds
    ds_read_b64_tr_b16 v[154:155], v36 offset:23040
    v_mfma_f32_16x16x32_bf16 v[104:107], a[140:143], v[160:163], v[104:107]
    ds_read_b64_tr_b16 v[156:157], v36 offset:23552
    ds_read_b64_tr_b16 v[158:159], v36 offset:24064
    v_mfma_f32_16x16x32_bf16 v[108:111], a[140:143], v[164:167], v[108:111]
    ds_read_b128 a[80:83], v21 offset:5120
    ds_read_b128 a[144:147], v21 offset:8192
    v_mfma_f32_16x16x32_bf16 v[112:115], a[140:143], v[168:171], v[112:115]
    ds_read_b128 a[208:211], v21 offset:9216
    v_mfma_f32_16x16x32_bf16 v[116:119], a[140:143], v[172:175], v[116:119]
    buffer_load_dwordx4 v15, s[28:31], s60 offen offset:2048 lds
    v_mfma_f32_16x16x32_bf16 v[120:123], a[204:207], v[160:163], v[120:123]
    v_mfma_f32_16x16x32_bf16 v[124:127], a[204:207], v[164:167], v[124:127]
    v_mfma_f32_16x16x32_bf16 v[128:131], a[204:207], v[168:171], v[128:131]
    v_mfma_f32_16x16x32_bf16 v[132:135], a[204:207], v[172:175], v[132:135]
    buffer_load_dwordx4 v15, s[28:31], s60 offen offset:3072 lds
    s_waitcnt lgkmcnt(11)
    s_waitcnt lgkmcnt(9)
    v_mfma_f32_16x16x32_bf16 v[72:75], a[16:19], v[144:147], v[72:75]
    ds_read_b128 a[20:23], v24 offset:4096
    s_waitcnt lgkmcnt(8)
    v_mfma_f32_16x16x32_bf16 v[76:79], a[16:19], v[148:151], v[76:79]
    ds_read_b64_tr_b16 v[160:161], v33 offset:30720
    s_waitcnt lgkmcnt(7)
    v_mfma_f32_16x16x32_bf16 v[80:83], a[16:19], v[152:155], v[80:83]
    ds_read_b64_tr_b16 v[162:163], v33 offset:31232
    s_waitcnt lgkmcnt(6)
    v_mfma_f32_16x16x32_bf16 v[84:87], a[16:19], v[156:159], v[84:87]
    s_add_u32 s17, s16, 5
    s_and_b32 s17, s17, 7
    s_add_u32 m0, s57, 34816
    s_lshl_b32 s60, s17, 7
    s_add_u32 s60, s60, s54
    buffer_load_dwordx4 v10, s[24:27], s60 offen offset:0 lds
    s_waitcnt lgkmcnt(5)
    v_mfma_f32_16x16x32_bf16 v[88:91], a[80:83], v[144:147], v[88:91]
    ds_read_b64_tr_b16 v[164:165], v33 offset:31744
    v_mfma_f32_16x16x32_bf16 v[92:95], a[80:83], v[148:151], v[92:95]
    ds_read_b64_tr_b16 v[166:167], v33 offset:32256
    v_mfma_f32_16x16x32_bf16 v[96:99], a[80:83], v[152:155], v[96:99]
    ds_read_b64_tr_b16 v[168:169], v36 offset:30720
    v_mfma_f32_16x16x32_bf16 v[100:103], a[80:83], v[156:159], v[100:103]
    buffer_load_dwordx4 v10, s[24:27], s60 offen offset:1024 lds
    s_waitcnt lgkmcnt(7)
    v_mfma_f32_16x16x32_bf16 v[104:107], a[144:147], v[144:147], v[104:107]
    ds_read_b64_tr_b16 v[170:171], v36 offset:31232
    v_mfma_f32_16x16x32_bf16 v[108:111], a[144:147], v[148:151], v[108:111]
    ds_read_b64_tr_b16 v[172:173], v36 offset:31744
    v_mfma_f32_16x16x32_bf16 v[112:115], a[144:147], v[152:155], v[112:115]
    ds_read_b64_tr_b16 v[174:175], v36 offset:32256
    v_mfma_f32_16x16x32_bf16 v[116:119], a[144:147], v[156:159], v[116:119]
    buffer_load_dwordx4 v11, s[24:27], s60 offen offset:2048 lds
    s_waitcnt lgkmcnt(9)
    v_mfma_f32_16x16x32_bf16 v[120:123], a[208:211], v[144:147], v[120:123]
    ds_read_b128 a[84:87], v24 offset:5120
    v_mfma_f32_16x16x32_bf16 v[124:127], a[208:211], v[148:151], v[124:127]
    ds_read_b128 a[148:151], v24 offset:8192
    v_mfma_f32_16x16x32_bf16 v[128:131], a[208:211], v[152:155], v[128:131]
    ds_read_b128 a[212:215], v24 offset:9216
    v_mfma_f32_16x16x32_bf16 v[132:135], a[208:211], v[156:159], v[132:135]
    buffer_load_dwordx4 v11, s[24:27], s60 offen offset:3072 lds
    s_waitcnt lgkmcnt(11)
    s_waitcnt lgkmcnt(9)
    v_mfma_f32_16x16x32_bf16 v[72:75], a[20:23], v[160:163], v[72:75]
    s_waitcnt lgkmcnt(7)
    v_mfma_f32_16x16x32_bf16 v[76:79], a[20:23], v[164:167], v[76:79]
    s_add_u32 m0, s57, 53248
    s_mul_i32 s60, s17, 196608
    s_add_u32 s60, s60, s66
    buffer_load_dwordx4 v14, s[28:31], s60 offen offset:0 lds
    s_waitcnt lgkmcnt(5)
    v_mfma_f32_16x16x32_bf16 v[80:83], a[20:23], v[168:171], v[80:83]
    s_waitcnt lgkmcnt(3)
    v_mfma_f32_16x16x32_bf16 v[84:87], a[20:23], v[172:175], v[84:87]
    s_waitcnt lgkmcnt(0)
    s_waitcnt vmcnt(13)
    s_barrier
    v_mfma_f32_16x16x32_bf16 v[88:91], a[84:87], v[160:163], v[88:91]
    ds_read_b128 a[24:27], v21 offset:38912
    ds_read_b64_tr_b16 v[144:145], v33 offset:57344
    v_mfma_f32_16x16x32_bf16 v[92:95], a[84:87], v[164:167], v[92:95]
    ds_read_b64_tr_b16 v[146:147], v33 offset:57856
    ds_read_b64_tr_b16 v[148:149], v33 offset:58368
    v_mfma_f32_16x16x32_bf16 v[96:99], a[84:87], v[168:171], v[96:99]
    ds_read_b64_tr_b16 v[150:151], v33 offset:58880
    ds_read_b64_tr_b16 v[152:153], v36 offset:57344
    v_mfma_f32_16x16x32_bf16 v[100:103], a[84:87], v[172:175], v[100:103]
    buffer_load_dwordx4 v14, s[28:31], s60 offen offset:1024 lds
    ds_read_b64_tr_b16 v[154:155], v36 offset:57856
    v_mfma_f32_16x16x32_bf16 v[104:107], a[148:151], v[160:163], v[104:107]
    ds_read_b64_tr_b16 v[156:157], v36 offset:58368
    ds_read_b64_tr_b16 v[158:159], v36 offset:58880
    v_mfma_f32_16x16x32_bf16 v[108:111], a[148:151], v[164:167], v[108:111]
    ds_read_b128 a[88:91], v21 offset:39936
    ds_read_b128 a[152:155], v21 offset:43008
    v_mfma_f32_16x16x32_bf16 v[112:115], a[148:151], v[168:171], v[112:115]
    ds_read_b128 a[216:219], v21 offset:44032
    v_mfma_f32_16x16x32_bf16 v[116:119], a[148:151], v[172:175], v[116:119]
    buffer_load_dwordx4 v15, s[28:31], s60 offen offset:2048 lds
    v_mfma_f32_16x16x32_bf16 v[120:123], a[212:215], v[160:163], v[120:123]
    v_mfma_f32_16x16x32_bf16 v[124:127], a[212:215], v[164:167], v[124:127]
    v_mfma_f32_16x16x32_bf16 v[128:131], a[212:215], v[168:171], v[128:131]
    v_mfma_f32_16x16x32_bf16 v[132:135], a[212:215], v[172:175], v[132:135]
    buffer_load_dwordx4 v15, s[28:31], s60 offen offset:3072 lds
    s_waitcnt lgkmcnt(11)
    s_waitcnt lgkmcnt(9)
    v_mfma_f32_16x16x32_bf16 v[72:75], a[24:27], v[144:147], v[72:75]
    ds_read_b128 a[28:31], v24 offset:38912
    s_waitcnt lgkmcnt(8)
    v_mfma_f32_16x16x32_bf16 v[76:79], a[24:27], v[148:151], v[76:79]
    ds_read_b64_tr_b16 v[160:161], v34 offset:0
    s_waitcnt lgkmcnt(7)
    v_mfma_f32_16x16x32_bf16 v[80:83], a[24:27], v[152:155], v[80:83]
    ds_read_b64_tr_b16 v[162:163], v34 offset:512
    s_waitcnt lgkmcnt(6)
    v_mfma_f32_16x16x32_bf16 v[84:87], a[24:27], v[156:159], v[84:87]
    s_add_u32 s17, s16, 6
    s_and_b32 s17, s17, 7
    s_add_u32 m0, s57, 69632
    s_lshl_b32 s60, s17, 7
    s_add_u32 s60, s60, s54
    buffer_load_dwordx4 v10, s[24:27], s60 offen offset:0 lds
    s_waitcnt lgkmcnt(5)
    v_mfma_f32_16x16x32_bf16 v[88:91], a[88:91], v[144:147], v[88:91]
    ds_read_b64_tr_b16 v[164:165], v34 offset:1024
    v_mfma_f32_16x16x32_bf16 v[92:95], a[88:91], v[148:151], v[92:95]
    ds_read_b64_tr_b16 v[166:167], v34 offset:1536
    v_mfma_f32_16x16x32_bf16 v[96:99], a[88:91], v[152:155], v[96:99]
    ds_read_b64_tr_b16 v[168:169], v37 offset:0
    v_mfma_f32_16x16x32_bf16 v[100:103], a[88:91], v[156:159], v[100:103]
    buffer_load_dwordx4 v10, s[24:27], s60 offen offset:1024 lds
    s_waitcnt lgkmcnt(7)
    v_mfma_f32_16x16x32_bf16 v[104:107], a[152:155], v[144:147], v[104:107]
    ds_read_b64_tr_b16 v[170:171], v37 offset:512
    v_mfma_f32_16x16x32_bf16 v[108:111], a[152:155], v[148:151], v[108:111]
    ds_read_b64_tr_b16 v[172:173], v37 offset:1024
    v_mfma_f32_16x16x32_bf16 v[112:115], a[152:155], v[152:155], v[112:115]
    ds_read_b64_tr_b16 v[174:175], v37 offset:1536
    v_mfma_f32_16x16x32_bf16 v[116:119], a[152:155], v[156:159], v[116:119]
    buffer_load_dwordx4 v11, s[24:27], s60 offen offset:2048 lds
    s_waitcnt lgkmcnt(9)
    v_mfma_f32_16x16x32_bf16 v[120:123], a[216:219], v[144:147], v[120:123]
    ds_read_b128 a[92:95], v24 offset:39936
    v_mfma_f32_16x16x32_bf16 v[124:127], a[216:219], v[148:151], v[124:127]
    ds_read_b128 a[156:159], v24 offset:43008
    v_mfma_f32_16x16x32_bf16 v[128:131], a[216:219], v[152:155], v[128:131]
    ds_read_b128 a[220:223], v24 offset:44032
    v_mfma_f32_16x16x32_bf16 v[132:135], a[216:219], v[156:159], v[132:135]
    buffer_load_dwordx4 v11, s[24:27], s60 offen offset:3072 lds
    s_waitcnt lgkmcnt(11)
    s_waitcnt lgkmcnt(9)
    v_mfma_f32_16x16x32_bf16 v[72:75], a[28:31], v[160:163], v[72:75]
    s_waitcnt lgkmcnt(7)
    v_mfma_f32_16x16x32_bf16 v[76:79], a[28:31], v[164:167], v[76:79]
    s_add_u32 m0, s57, 88064
    s_mul_i32 s60, s17, 196608
    s_add_u32 s60, s60, s66
    buffer_load_dwordx4 v14, s[28:31], s60 offen offset:0 lds
    s_waitcnt lgkmcnt(5)
    v_mfma_f32_16x16x32_bf16 v[80:83], a[28:31], v[168:171], v[80:83]
    s_waitcnt lgkmcnt(3)
    v_mfma_f32_16x16x32_bf16 v[84:87], a[28:31], v[172:175], v[84:87]
    s_waitcnt lgkmcnt(0)
    s_waitcnt vmcnt(13)
    s_barrier
    v_mfma_f32_16x16x32_bf16 v[88:91], a[92:95], v[160:163], v[88:91]
    ds_read_b128 a[32:35], v20 offset:0
    ds_read_b64_tr_b16 v[144:145], v32 offset:18432
    v_mfma_f32_16x16x32_bf16 v[92:95], a[92:95], v[164:167], v[92:95]
    ds_read_b64_tr_b16 v[146:147], v32 offset:18944
    ds_read_b64_tr_b16 v[148:149], v32 offset:19456
    v_mfma_f32_16x16x32_bf16 v[96:99], a[92:95], v[168:171], v[96:99]
    ds_read_b64_tr_b16 v[150:151], v32 offset:19968
    ds_read_b64_tr_b16 v[152:153], v35 offset:18432
    v_mfma_f32_16x16x32_bf16 v[100:103], a[92:95], v[172:175], v[100:103]
    buffer_load_dwordx4 v14, s[28:31], s60 offen offset:1024 lds
    ds_read_b64_tr_b16 v[154:155], v35 offset:18944
    v_mfma_f32_16x16x32_bf16 v[104:107], a[156:159], v[160:163], v[104:107]
    ds_read_b64_tr_b16 v[156:157], v35 offset:19456
    ds_read_b64_tr_b16 v[158:159], v35 offset:19968
    v_mfma_f32_16x16x32_bf16 v[108:111], a[156:159], v[164:167], v[108:111]
    ds_read_b128 a[96:99], v20 offset:1024
    ds_read_b128 a[160:163], v20 offset:4096
    v_mfma_f32_16x16x32_bf16 v[112:115], a[156:159], v[168:171], v[112:115]
    ds_read_b128 a[224:227], v20 offset:5120
    v_mfma_f32_16x16x32_bf16 v[116:119], a[156:159], v[172:175], v[116:119]
    buffer_load_dwordx4 v15, s[28:31], s60 offen offset:2048 lds
    v_mfma_f32_16x16x32_bf16 v[120:123], a[220:223], v[160:163], v[120:123]
    v_mfma_f32_16x16x32_bf16 v[124:127], a[220:223], v[164:167], v[124:127]
    v_mfma_f32_16x16x32_bf16 v[128:131], a[220:223], v[168:171], v[128:131]
    v_mfma_f32_16x16x32_bf16 v[132:135], a[220:223], v[172:175], v[132:135]
    buffer_load_dwordx4 v15, s[28:31], s60 offen offset:3072 lds
    s_waitcnt lgkmcnt(11)
    s_waitcnt lgkmcnt(9)
    v_mfma_f32_16x16x32_bf16 v[72:75], a[32:35], v[144:147], v[72:75]
    ds_read_b128 a[36:39], v23 offset:0
    s_waitcnt lgkmcnt(8)
    v_mfma_f32_16x16x32_bf16 v[76:79], a[32:35], v[148:151], v[76:79]
    ds_read_b64_tr_b16 v[160:161], v32 offset:26624
    s_waitcnt lgkmcnt(7)
    v_mfma_f32_16x16x32_bf16 v[80:83], a[32:35], v[152:155], v[80:83]
    ds_read_b64_tr_b16 v[162:163], v32 offset:27136
    s_waitcnt lgkmcnt(6)
    v_mfma_f32_16x16x32_bf16 v[84:87], a[32:35], v[156:159], v[84:87]
    s_add_u32 s17, s16, 7
    s_and_b32 s17, s17, 7
    s_add_u32 m0, s57, 104448
    s_lshl_b32 s60, s17, 7
    s_add_u32 s60, s60, s54
    buffer_load_dwordx4 v10, s[24:27], s60 offen offset:0 lds
    s_waitcnt lgkmcnt(5)
    v_mfma_f32_16x16x32_bf16 v[88:91], a[96:99], v[144:147], v[88:91]
    ds_read_b64_tr_b16 v[164:165], v32 offset:27648
    v_mfma_f32_16x16x32_bf16 v[92:95], a[96:99], v[148:151], v[92:95]
    ds_read_b64_tr_b16 v[166:167], v32 offset:28160
    v_mfma_f32_16x16x32_bf16 v[96:99], a[96:99], v[152:155], v[96:99]
    ds_read_b64_tr_b16 v[168:169], v35 offset:26624
    v_mfma_f32_16x16x32_bf16 v[100:103], a[96:99], v[156:159], v[100:103]
    buffer_load_dwordx4 v10, s[24:27], s60 offen offset:1024 lds
    s_waitcnt lgkmcnt(7)
    v_mfma_f32_16x16x32_bf16 v[104:107], a[160:163], v[144:147], v[104:107]
    ds_read_b64_tr_b16 v[170:171], v35 offset:27136
    v_mfma_f32_16x16x32_bf16 v[108:111], a[160:163], v[148:151], v[108:111]
    ds_read_b64_tr_b16 v[172:173], v35 offset:27648
    v_mfma_f32_16x16x32_bf16 v[112:115], a[160:163], v[152:155], v[112:115]
    ds_read_b64_tr_b16 v[174:175], v35 offset:28160
    v_mfma_f32_16x16x32_bf16 v[116:119], a[160:163], v[156:159], v[116:119]
    buffer_load_dwordx4 v11, s[24:27], s60 offen offset:2048 lds
    s_waitcnt lgkmcnt(9)
    v_mfma_f32_16x16x32_bf16 v[120:123], a[224:227], v[144:147], v[120:123]
    ds_read_b128 a[100:103], v23 offset:1024
    v_mfma_f32_16x16x32_bf16 v[124:127], a[224:227], v[148:151], v[124:127]
    ds_read_b128 a[164:167], v23 offset:4096
    v_mfma_f32_16x16x32_bf16 v[128:131], a[224:227], v[152:155], v[128:131]
    ds_read_b128 a[228:231], v23 offset:5120
    v_mfma_f32_16x16x32_bf16 v[132:135], a[224:227], v[156:159], v[132:135]
    buffer_load_dwordx4 v11, s[24:27], s60 offen offset:3072 lds
    s_waitcnt lgkmcnt(11)
    s_waitcnt lgkmcnt(9)
    v_mfma_f32_16x16x32_bf16 v[72:75], a[36:39], v[160:163], v[72:75]
    s_waitcnt lgkmcnt(7)
    v_mfma_f32_16x16x32_bf16 v[76:79], a[36:39], v[164:167], v[76:79]
    s_add_u32 m0, s57, 122880
    s_mul_i32 s60, s17, 196608
    s_add_u32 s60, s60, s66
    buffer_load_dwordx4 v14, s[28:31], s60 offen offset:0 lds
    s_waitcnt lgkmcnt(5)
    v_mfma_f32_16x16x32_bf16 v[80:83], a[36:39], v[168:171], v[80:83]
    s_waitcnt lgkmcnt(3)
    v_mfma_f32_16x16x32_bf16 v[84:87], a[36:39], v[172:175], v[84:87]
    s_waitcnt lgkmcnt(0)
    s_waitcnt vmcnt(13)
    s_barrier
    v_mfma_f32_16x16x32_bf16 v[88:91], a[100:103], v[160:163], v[88:91]
    ds_read_b128 a[40:43], v20 offset:34816
    ds_read_b64_tr_b16 v[144:145], v32 offset:53248
    v_mfma_f32_16x16x32_bf16 v[92:95], a[100:103], v[164:167], v[92:95]
    ds_read_b64_tr_b16 v[146:147], v32 offset:53760
    ds_read_b64_tr_b16 v[148:149], v32 offset:54272
    v_mfma_f32_16x16x32_bf16 v[96:99], a[100:103], v[168:171], v[96:99]
    ds_read_b64_tr_b16 v[150:151], v32 offset:54784
    ds_read_b64_tr_b16 v[152:153], v35 offset:53248
    v_mfma_f32_16x16x32_bf16 v[100:103], a[100:103], v[172:175], v[100:103]
    buffer_load_dwordx4 v14, s[28:31], s60 offen offset:1024 lds
    ds_read_b64_tr_b16 v[154:155], v35 offset:53760
    v_mfma_f32_16x16x32_bf16 v[104:107], a[164:167], v[160:163], v[104:107]
    ds_read_b64_tr_b16 v[156:157], v35 offset:54272
    ds_read_b64_tr_b16 v[158:159], v35 offset:54784
    v_mfma_f32_16x16x32_bf16 v[108:111], a[164:167], v[164:167], v[108:111]
    ds_read_b128 a[104:107], v20 offset:35840
    ds_read_b128 a[168:171], v20 offset:38912
    v_mfma_f32_16x16x32_bf16 v[112:115], a[164:167], v[168:171], v[112:115]
    ds_read_b128 a[232:235], v20 offset:39936
    v_mfma_f32_16x16x32_bf16 v[116:119], a[164:167], v[172:175], v[116:119]
    buffer_load_dwordx4 v15, s[28:31], s60 offen offset:2048 lds
    v_mfma_f32_16x16x32_bf16 v[120:123], a[228:231], v[160:163], v[120:123]
    v_mfma_f32_16x16x32_bf16 v[124:127], a[228:231], v[164:167], v[124:127]
    v_mfma_f32_16x16x32_bf16 v[128:131], a[228:231], v[168:171], v[128:131]
    v_mfma_f32_16x16x32_bf16 v[132:135], a[228:231], v[172:175], v[132:135]
    buffer_load_dwordx4 v15, s[28:31], s60 offen offset:3072 lds
    s_waitcnt lgkmcnt(11)
    s_waitcnt lgkmcnt(9)
    v_mfma_f32_16x16x32_bf16 v[72:75], a[40:43], v[144:147], v[72:75]
    ds_read_b128 a[44:47], v23 offset:34816
    s_waitcnt lgkmcnt(8)
    v_mfma_f32_16x16x32_bf16 v[76:79], a[40:43], v[148:151], v[76:79]
    ds_read_b64_tr_b16 v[160:161], v32 offset:61440
    s_waitcnt lgkmcnt(7)
    v_mfma_f32_16x16x32_bf16 v[80:83], a[40:43], v[152:155], v[80:83]
    ds_read_b64_tr_b16 v[162:163], v32 offset:61952
    s_waitcnt lgkmcnt(6)
    v_mfma_f32_16x16x32_bf16 v[84:87], a[40:43], v[156:159], v[84:87]
    s_add_u32 s17, s16, 0
    s_and_b32 s17, s17, 7
    s_add_u32 m0, s57, 0
    s_mul_i32 s60, s17, 196608
    s_add_u32 s60, s60, s56
    buffer_load_dwordx4 v14, s[28:31], s60 offen offset:0 lds
    s_waitcnt lgkmcnt(5)
    v_mfma_f32_16x16x32_bf16 v[88:91], a[104:107], v[144:147], v[88:91]
    ds_read_b64_tr_b16 v[164:165], v32 offset:62464
    v_mfma_f32_16x16x32_bf16 v[92:95], a[104:107], v[148:151], v[92:95]
    ds_read_b64_tr_b16 v[166:167], v32 offset:62976
    v_mfma_f32_16x16x32_bf16 v[96:99], a[104:107], v[152:155], v[96:99]
    ds_read_b64_tr_b16 v[168:169], v35 offset:61440
    v_mfma_f32_16x16x32_bf16 v[100:103], a[104:107], v[156:159], v[100:103]
    buffer_load_dwordx4 v15, s[28:31], s60 offen offset:2048 lds
    s_waitcnt lgkmcnt(7)
    v_mfma_f32_16x16x32_bf16 v[104:107], a[168:171], v[144:147], v[104:107]
    ds_read_b64_tr_b16 v[170:171], v35 offset:61952
    v_mfma_f32_16x16x32_bf16 v[108:111], a[168:171], v[148:151], v[108:111]
    ds_read_b64_tr_b16 v[172:173], v35 offset:62464
    v_mfma_f32_16x16x32_bf16 v[112:115], a[168:171], v[152:155], v[112:115]
    ds_read_b64_tr_b16 v[174:175], v35 offset:62976
    v_mfma_f32_16x16x32_bf16 v[116:119], a[168:171], v[156:159], v[116:119]
    s_add_u32 s17, s16, 1
    s_and_b32 s17, s17, 7
    s_add_u32 m0, s57, 1024
    s_mul_i32 s60, s17, 196608
    s_add_u32 s60, s60, s56
    buffer_load_dwordx4 v14, s[28:31], s60 offen offset:0 lds
    s_waitcnt lgkmcnt(9)
    v_mfma_f32_16x16x32_bf16 v[120:123], a[232:235], v[144:147], v[120:123]
    ds_read_b128 a[108:111], v23 offset:35840
    v_mfma_f32_16x16x32_bf16 v[124:127], a[232:235], v[148:151], v[124:127]
    ds_read_b128 a[172:175], v23 offset:38912
    v_mfma_f32_16x16x32_bf16 v[128:131], a[232:235], v[152:155], v[128:131]
    ds_read_b128 a[236:239], v23 offset:39936
    v_mfma_f32_16x16x32_bf16 v[132:135], a[232:235], v[156:159], v[132:135]
    buffer_load_dwordx4 v15, s[28:31], s60 offen offset:2048 lds
    s_waitcnt lgkmcnt(11)
    s_waitcnt lgkmcnt(9)
    v_mfma_f32_16x16x32_bf16 v[72:75], a[44:47], v[160:163], v[72:75]
    s_waitcnt lgkmcnt(7)
    v_mfma_f32_16x16x32_bf16 v[76:79], a[44:47], v[164:167], v[76:79]
    s_add_u32 s17, s16, 2
    s_and_b32 s17, s17, 7
    s_add_u32 m0, s57, 16384
    s_mul_i32 s60, s17, 196608
    s_add_u32 s60, s60, s56
    buffer_load_dwordx4 v14, s[28:31], s60 offen offset:0 lds
    s_waitcnt lgkmcnt(5)
    v_mfma_f32_16x16x32_bf16 v[80:83], a[44:47], v[168:171], v[80:83]
    s_waitcnt lgkmcnt(3)
    v_mfma_f32_16x16x32_bf16 v[84:87], a[44:47], v[172:175], v[84:87]
    s_waitcnt lgkmcnt(0)
    s_waitcnt vmcnt(13)
    s_barrier
    v_mfma_f32_16x16x32_bf16 v[88:91], a[108:111], v[160:163], v[88:91]
    ds_read_b128 a[48:51], v21 offset:4096
    ds_read_b64_tr_b16 v[144:145], v33 offset:22528
    v_mfma_f32_16x16x32_bf16 v[92:95], a[108:111], v[164:167], v[92:95]
    ds_read_b64_tr_b16 v[146:147], v33 offset:23040
    ds_read_b64_tr_b16 v[148:149], v33 offset:23552
    v_mfma_f32_16x16x32_bf16 v[96:99], a[108:111], v[168:171], v[96:99]
    ds_read_b64_tr_b16 v[150:151], v33 offset:24064
    ds_read_b64_tr_b16 v[152:153], v36 offset:22528
    v_mfma_f32_16x16x32_bf16 v[100:103], a[108:111], v[172:175], v[100:103]
    buffer_load_dwordx4 v15, s[28:31], s60 offen offset:2048 lds
    ds_read_b64_tr_b16 v[154:155], v36 offset:23040
    v_mfma_f32_16x16x32_bf16 v[104:107], a[172:175], v[160:163], v[104:107]
    ds_read_b64_tr_b16 v[156:157], v36 offset:23552
    ds_read_b64_tr_b16 v[158:159], v36 offset:24064
    v_mfma_f32_16x16x32_bf16 v[108:111], a[172:175], v[164:167], v[108:111]
    ds_read_b128 a[112:115], v21 offset:5120
    ds_read_b128 a[176:179], v21 offset:8192
    v_mfma_f32_16x16x32_bf16 v[112:115], a[172:175], v[168:171], v[112:115]
    ds_read_b128 a[240:243], v21 offset:9216
    v_mfma_f32_16x16x32_bf16 v[116:119], a[172:175], v[172:175], v[116:119]
    s_add_u32 s17, s16, 3
    s_and_b32 s17, s17, 7
    s_add_u32 m0, s57, 17408
    s_mul_i32 s60, s17, 196608
    s_add_u32 s60, s60, s56
    buffer_load_dwordx4 v14, s[28:31], s60 offen offset:0 lds
    v_mfma_f32_16x16x32_bf16 v[120:123], a[236:239], v[160:163], v[120:123]
    v_mfma_f32_16x16x32_bf16 v[124:127], a[236:239], v[164:167], v[124:127]
    v_mfma_f32_16x16x32_bf16 v[128:131], a[236:239], v[168:171], v[128:131]
    v_mfma_f32_16x16x32_bf16 v[132:135], a[236:239], v[172:175], v[132:135]
    buffer_load_dwordx4 v15, s[28:31], s60 offen offset:2048 lds
    s_waitcnt lgkmcnt(11)
    s_waitcnt lgkmcnt(9)
    v_mfma_f32_16x16x32_bf16 v[72:75], a[48:51], v[144:147], v[72:75]
    ds_read_b128 a[52:55], v24 offset:4096
    s_waitcnt lgkmcnt(8)
    v_mfma_f32_16x16x32_bf16 v[76:79], a[48:51], v[148:151], v[76:79]
    ds_read_b64_tr_b16 v[160:161], v33 offset:30720
    s_waitcnt lgkmcnt(7)
    v_mfma_f32_16x16x32_bf16 v[80:83], a[48:51], v[152:155], v[80:83]
    ds_read_b64_tr_b16 v[162:163], v33 offset:31232
    s_waitcnt lgkmcnt(6)
    v_mfma_f32_16x16x32_bf16 v[84:87], a[48:51], v[156:159], v[84:87]
    s_add_u32 s17, s16, 4
    s_and_b32 s17, s17, 7
    s_add_u32 m0, s57, 34816
    s_mul_i32 s60, s17, 196608
    s_add_u32 s60, s60, s56
    buffer_load_dwordx4 v14, s[28:31], s60 offen offset:0 lds
    s_waitcnt lgkmcnt(5)
    v_mfma_f32_16x16x32_bf16 v[88:91], a[112:115], v[144:147], v[88:91]
    ds_read_b64_tr_b16 v[164:165], v33 offset:31744
    v_mfma_f32_16x16x32_bf16 v[92:95], a[112:115], v[148:151], v[92:95]
    ds_read_b64_tr_b16 v[166:167], v33 offset:32256
    v_mfma_f32_16x16x32_bf16 v[96:99], a[112:115], v[152:155], v[96:99]
    ds_read_b64_tr_b16 v[168:169], v36 offset:30720
    v_mfma_f32_16x16x32_bf16 v[100:103], a[112:115], v[156:159], v[100:103]
    buffer_load_dwordx4 v15, s[28:31], s60 offen offset:2048 lds
    s_waitcnt lgkmcnt(7)
    v_mfma_f32_16x16x32_bf16 v[104:107], a[176:179], v[144:147], v[104:107]
    ds_read_b64_tr_b16 v[170:171], v36 offset:31232
    v_mfma_f32_16x16x32_bf16 v[108:111], a[176:179], v[148:151], v[108:111]
    ds_read_b64_tr_b16 v[172:173], v36 offset:31744
    v_mfma_f32_16x16x32_bf16 v[112:115], a[176:179], v[152:155], v[112:115]
    ds_read_b64_tr_b16 v[174:175], v36 offset:32256
    v_mfma_f32_16x16x32_bf16 v[116:119], a[176:179], v[156:159], v[116:119]
    s_add_u32 s17, s16, 5
    s_and_b32 s17, s17, 7
    s_add_u32 m0, s57, 35840
    s_mul_i32 s60, s17, 196608
    s_add_u32 s60, s60, s56
    buffer_load_dwordx4 v14, s[28:31], s60 offen offset:0 lds
    s_waitcnt lgkmcnt(9)
    v_mfma_f32_16x16x32_bf16 v[120:123], a[240:243], v[144:147], v[120:123]
    ds_read_b128 a[116:119], v24 offset:5120
    v_mfma_f32_16x16x32_bf16 v[124:127], a[240:243], v[148:151], v[124:127]
    ds_read_b128 a[180:183], v24 offset:8192
    v_mfma_f32_16x16x32_bf16 v[128:131], a[240:243], v[152:155], v[128:131]
    ds_read_b128 a[244:247], v24 offset:9216
    v_mfma_f32_16x16x32_bf16 v[132:135], a[240:243], v[156:159], v[132:135]
    buffer_load_dwordx4 v15, s[28:31], s60 offen offset:2048 lds
    s_waitcnt lgkmcnt(11)
    s_waitcnt lgkmcnt(9)
    v_mfma_f32_16x16x32_bf16 v[72:75], a[52:55], v[160:163], v[72:75]
    s_waitcnt lgkmcnt(7)
    v_mfma_f32_16x16x32_bf16 v[76:79], a[52:55], v[164:167], v[76:79]
    s_add_u32 s17, s16, 6
    s_and_b32 s17, s17, 7
    s_add_u32 m0, s57, 51200
    s_mul_i32 s60, s17, 196608
    s_add_u32 s60, s60, s56
    buffer_load_dwordx4 v14, s[28:31], s60 offen offset:0 lds
    s_waitcnt lgkmcnt(5)
    v_mfma_f32_16x16x32_bf16 v[80:83], a[52:55], v[168:171], v[80:83]
    s_waitcnt lgkmcnt(3)
    v_mfma_f32_16x16x32_bf16 v[84:87], a[52:55], v[172:175], v[84:87]
    s_waitcnt lgkmcnt(0)
    s_waitcnt vmcnt(13)
    s_barrier
    v_mfma_f32_16x16x32_bf16 v[88:91], a[116:119], v[160:163], v[88:91]
    ds_read_b128 a[56:59], v21 offset:38912
    ds_read_b64_tr_b16 v[144:145], v33 offset:57344
    v_mfma_f32_16x16x32_bf16 v[92:95], a[116:119], v[164:167], v[92:95]
    ds_read_b64_tr_b16 v[146:147], v33 offset:57856
    ds_read_b64_tr_b16 v[148:149], v33 offset:58368
    v_mfma_f32_16x16x32_bf16 v[96:99], a[116:119], v[168:171], v[96:99]
    ds_read_b64_tr_b16 v[150:151], v33 offset:58880
    ds_read_b64_tr_b16 v[152:153], v36 offset:57344
    v_mfma_f32_16x16x32_bf16 v[100:103], a[116:119], v[172:175], v[100:103]
    buffer_load_dwordx4 v15, s[28:31], s60 offen offset:2048 lds
    ds_read_b64_tr_b16 v[154:155], v36 offset:57856
    v_mfma_f32_16x16x32_bf16 v[104:107], a[180:183], v[160:163], v[104:107]
    ds_read_b64_tr_b16 v[156:157], v36 offset:58368
    ds_read_b64_tr_b16 v[158:159], v36 offset:58880
    v_mfma_f32_16x16x32_bf16 v[108:111], a[180:183], v[164:167], v[108:111]
    ds_read_b128 a[120:123], v21 offset:39936
    ds_read_b128 a[184:187], v21 offset:43008
    v_mfma_f32_16x16x32_bf16 v[112:115], a[180:183], v[168:171], v[112:115]
    ds_read_b128 a[248:251], v21 offset:44032
    v_mfma_f32_16x16x32_bf16 v[116:119], a[180:183], v[172:175], v[116:119]
    s_add_u32 s17, s16, 7
    s_and_b32 s17, s17, 7
    s_add_u32 m0, s57, 52224
    s_mul_i32 s60, s17, 196608
    s_add_u32 s60, s60, s56
    buffer_load_dwordx4 v14, s[28:31], s60 offen offset:0 lds
    v_mfma_f32_16x16x32_bf16 v[120:123], a[244:247], v[160:163], v[120:123]
    v_mfma_f32_16x16x32_bf16 v[124:127], a[244:247], v[164:167], v[124:127]
    v_mfma_f32_16x16x32_bf16 v[128:131], a[244:247], v[168:171], v[128:131]
    v_mfma_f32_16x16x32_bf16 v[132:135], a[244:247], v[172:175], v[132:135]
    buffer_load_dwordx4 v15, s[28:31], s60 offen offset:2048 lds
    s_waitcnt lgkmcnt(11)
    s_waitcnt lgkmcnt(9)
    v_mfma_f32_16x16x32_bf16 v[72:75], a[56:59], v[144:147], v[72:75]
    ds_read_b128 a[60:63], v24 offset:38912
    s_waitcnt lgkmcnt(8)
    v_mfma_f32_16x16x32_bf16 v[76:79], a[56:59], v[148:151], v[76:79]
    ds_read_b64_tr_b16 v[160:161], v34 offset:0
    s_waitcnt lgkmcnt(7)
    v_mfma_f32_16x16x32_bf16 v[80:83], a[56:59], v[152:155], v[80:83]
    ds_read_b64_tr_b16 v[162:163], v34 offset:512
    s_waitcnt lgkmcnt(6)
    v_mfma_f32_16x16x32_bf16 v[84:87], a[56:59], v[156:159], v[84:87]
    s_add_u32 m0, s7, 67584
    s_add_u32 s60, s65, 0
    buffer_load_dwordx4 v12, s[40:43], s60 offen offset:0 lds
    s_waitcnt lgkmcnt(5)
    v_mfma_f32_16x16x32_bf16 v[88:91], a[120:123], v[144:147], v[88:91]
    ds_read_b64_tr_b16 v[164:165], v34 offset:1024
    v_mfma_f32_16x16x32_bf16 v[92:95], a[120:123], v[148:151], v[92:95]
    ds_read_b64_tr_b16 v[166:167], v34 offset:1536
    v_mfma_f32_16x16x32_bf16 v[96:99], a[120:123], v[152:155], v[96:99]
    ds_read_b64_tr_b16 v[168:169], v37 offset:0
    v_mfma_f32_16x16x32_bf16 v[100:103], a[120:123], v[156:159], v[100:103]
    buffer_load_dwordx4 v13, s[40:43], s60 offen offset:1024 lds
    s_waitcnt lgkmcnt(7)
    v_mfma_f32_16x16x32_bf16 v[104:107], a[184:187], v[144:147], v[104:107]
    ds_read_b64_tr_b16 v[170:171], v37 offset:512
    v_mfma_f32_16x16x32_bf16 v[108:111], a[184:187], v[148:151], v[108:111]
    ds_read_b64_tr_b16 v[172:173], v37 offset:1024
    v_mfma_f32_16x16x32_bf16 v[112:115], a[184:187], v[152:155], v[112:115]
    ds_read_b64_tr_b16 v[174:175], v37 offset:1536
    v_mfma_f32_16x16x32_bf16 v[116:119], a[184:187], v[156:159], v[116:119]
    buffer_load_dwordx4 v16, s[40:43], s60 offen offset:2048 lds
    s_waitcnt lgkmcnt(9)
    v_mfma_f32_16x16x32_bf16 v[120:123], a[248:251], v[144:147], v[120:123]
    ds_read_b128 a[124:127], v24 offset:39936
    v_mfma_f32_16x16x32_bf16 v[124:127], a[248:251], v[148:151], v[124:127]
    ds_read_b128 a[188:191], v24 offset:43008
    v_mfma_f32_16x16x32_bf16 v[128:131], a[248:251], v[152:155], v[128:131]
    ds_read_b128 a[252:255], v24 offset:44032
    v_mfma_f32_16x16x32_bf16 v[132:135], a[248:251], v[156:159], v[132:135]
    buffer_load_dwordx4 v17, s[40:43], s60 offen offset:3072 lds
    s_waitcnt lgkmcnt(11)
    s_waitcnt lgkmcnt(9)
    v_mfma_f32_16x16x32_bf16 v[72:75], a[60:63], v[160:163], v[72:75]
    s_waitcnt lgkmcnt(7)
    v_mfma_f32_16x16x32_bf16 v[76:79], a[60:63], v[164:167], v[76:79]
    s_add_u32 m0, s7, 71680
    s_add_u32 s60, s65, 16384
    buffer_load_dwordx4 v12, s[40:43], s60 offen offset:0 lds
    s_waitcnt lgkmcnt(5)
    v_mfma_f32_16x16x32_bf16 v[80:83], a[60:63], v[168:171], v[80:83]
    s_waitcnt lgkmcnt(3)
    v_mfma_f32_16x16x32_bf16 v[84:87], a[60:63], v[172:175], v[84:87]
    s_waitcnt lgkmcnt(0)
    s_waitcnt vmcnt(13)
    s_barrier
    v_mfma_f32_16x16x32_bf16 v[88:91], a[124:127], v[160:163], v[88:91]
    ds_read_b64_tr_b16 v[144:145], v32 offset:0
    ds_read_b64_tr_b16 v[146:147], v32 offset:512
    v_mfma_f32_16x16x32_bf16 v[92:95], a[124:127], v[164:167], v[92:95]
    ds_read_b64_tr_b16 v[148:149], v32 offset:8192
    ds_read_b64_tr_b16 v[150:151], v32 offset:8704
    v_mfma_f32_16x16x32_bf16 v[96:99], a[124:127], v[168:171], v[96:99]
    ds_read_b64_tr_b16 v[152:153], v32 offset:1024
    ds_read_b64_tr_b16 v[154:155], v32 offset:1536
    v_mfma_f32_16x16x32_bf16 v[100:103], a[124:127], v[172:175], v[100:103]
    buffer_load_dwordx4 v13, s[40:43], s60 offen offset:1024 lds
    v_mfma_f32_16x16x32_bf16 v[104:107], a[188:191], v[160:163], v[104:107]
    v_mfma_f32_16x16x32_bf16 v[108:111], a[188:191], v[164:167], v[108:111]
    v_mfma_f32_16x16x32_bf16 v[112:115], a[188:191], v[168:171], v[112:115]
    v_mfma_f32_16x16x32_bf16 v[116:119], a[188:191], v[172:175], v[116:119]
    buffer_load_dwordx4 v16, s[40:43], s60 offen offset:2048 lds
    v_mfma_f32_16x16x32_bf16 v[120:123], a[252:255], v[160:163], v[120:123]
    v_mfma_f32_16x16x32_bf16 v[124:127], a[252:255], v[164:167], v[124:127]
    v_mfma_f32_16x16x32_bf16 v[128:131], a[252:255], v[168:171], v[128:131]
    v_mfma_f32_16x16x32_bf16 v[132:135], a[252:255], v[172:175], v[132:135]
    buffer_load_dwordx4 v17, s[40:43], s60 offen offset:3072 lds
L_q_10:
    s_waitcnt lgkmcnt(4)
    v_mfma_f32_16x16x32_bf16 v[184:187], v[144:147], a[0:3], 0
    ds_read_b64_tr_b16 v[156:157], v32 offset:9216
    ds_read_b64_tr_b16 v[158:159], v32 offset:9728
    v_pk_mul_f32 v[200:201], v[80:81], s[18:19]
    v_pk_mul_f32 v[202:203], v[82:83], s[18:19]
    v_pk_mul_f32 v[204:205], v[96:97], s[18:19]
    v_pk_mul_f32 v[206:207], v[98:99], s[18:19]
    v_pk_mul_f32 v[208:209], v[112:113], s[18:19]
    v_pk_mul_f32 v[210:211], v[114:115], s[18:19]
    v_pk_mul_f32 v[212:213], v[128:129], s[18:19]
    v_pk_mul_f32 v[214:215], v[130:131], s[18:19]
    v_exp_f32 v200, v200 clamp
    v_max_f32 v80, s64, v80
    v_exp_f32 v201, v201 clamp
    v_max_f32 v81, s64, v81
    v_exp_f32 v202, v202 clamp
    v_max_f32 v82, s64, v82
    v_exp_f32 v203, v203 clamp
    v_max_f32 v83, s64, v83
    v_exp_f32 v204, v204 clamp
    v_max_f32 v96, s64, v96
    v_exp_f32 v205, v205 clamp
    v_max_f32 v97, s64, v97
    v_exp_f32 v206, v206 clamp
    v_max_f32 v98, s64, v98
    v_exp_f32 v207, v207 clamp
    v_max_f32 v99, s64, v99
    v_exp_f32 v208, v208 clamp
    v_max_f32 v112, s64, v112
    v_exp_f32 v209, v209 clamp
    v_max_f32 v113, s64, v113
    v_exp_f32 v210, v210 clamp
    v_max_f32 v114, s64, v114
    v_exp_f32 v211, v211 clamp
    v_max_f32 v115, s64, v115
    v_exp_f32 v212, v212 clamp
    v_max_f32 v128, s64, v128
    v_exp_f32 v213, v213 clamp
    v_max_f32 v129, s64, v129
    v_exp_f32 v214, v214 clamp
    v_max_f32 v130, s64, v130
    v_mfma_f32_16x16x32_bf16 v[188:191], v[144:147], a[64:67], 0
    v_exp_f32 v215, v215 clamp
    v_max_f32 v131, s64, v131
    v_pk_add_f32 v[80:81], v[80:81], v[200:201]
    v_pk_add_f32 v[82:83], v[82:83], v[202:203]
    v_pk_add_f32 v[96:97], v[96:97], v[204:205]
    v_pk_add_f32 v[98:99], v[98:99], v[206:207]
    v_pk_add_f32 v[112:113], v[112:113], v[208:209]
    v_pk_add_f32 v[114:115], v[114:115], v[210:211]
    v_pk_add_f32 v[128:129], v[128:129], v[212:213]
    v_pk_add_f32 v[130:131], v[130:131], v[214:215]
    v_cvt_pk_bf16_f32 v224, v80, v81
    v_cvt_pk_bf16_f32 v225, v82, v83
    v_cvt_pk_bf16_f32 v240, v84, v85
    v_cvt_pk_bf16_f32 v241, v86, v87
    v_cvt_pk_bf16_f32 v226, v96, v97
    v_cvt_pk_bf16_f32 v227, v98, v99
    v_cvt_pk_bf16_f32 v242, v100, v101
    v_cvt_pk_bf16_f32 v243, v102, v103
    v_cvt_pk_bf16_f32 v228, v112, v113
    v_cvt_pk_bf16_f32 v229, v114, v115
    v_cvt_pk_bf16_f32 v244, v116, v117
    v_cvt_pk_bf16_f32 v245, v118, v119
    v_cvt_pk_bf16_f32 v230, v128, v129
    v_cvt_pk_bf16_f32 v231, v130, v131
    v_cvt_pk_bf16_f32 v246, v132, v133
    v_cvt_pk_bf16_f32 v247, v134, v135
    v_mfma_f32_16x16x32_bf16 v[176:179], v[224:227], v[240:243], 0
    v_mfma_f32_16x16x32_bf16 v[180:183], v[224:227], v[66:69], 0
    v_mfma_f32_16x16x32_bf16 v[176:179], v[228:231], v[244:247], v[176:179]
    v_mfma_f32_16x16x32_bf16 v[180:183], v[228:231], v[66:69], v[180:183]
    v_pk_mul_f32 v[200:201], v[72:73], s[18:19]
    v_pk_mul_f32 v[202:203], v[74:75], s[18:19]
    v_pk_mul_f32 v[204:205], v[88:89], s[18:19]
    v_pk_mul_f32 v[206:207], v[90:91], s[18:19]
    v_pk_mul_f32 v[208:209], v[104:105], s[18:19]
    v_pk_mul_f32 v[210:211], v[106:107], s[18:19]
    v_pk_mul_f32 v[212:213], v[120:121], s[18:19]
    v_pk_mul_f32 v[214:215], v[122:123], s[18:19]
    v_exp_f32 v200, v200 clamp
    v_max_f32 v72, s64, v72
    v_mfma_f32_16x16x32_bf16 v[192:195], v[144:147], a[128:131], 0
    v_exp_f32 v201, v201 clamp
    v_max_f32 v73, s64, v73
    ds_write_b128 v9, v[176:179] offset:0
    ds_write_b128 v9, v[180:183] offset:1024
    v_exp_f32 v202, v202 clamp
    v_max_f32 v74, s64, v74
    v_exp_f32 v203, v203 clamp
    v_max_f32 v75, s64, v75
    v_exp_f32 v204, v204 clamp
    v_max_f32 v88, s64, v88
    v_exp_f32 v205, v205 clamp
    v_max_f32 v89, s64, v89
    v_exp_f32 v206, v206 clamp
    v_max_f32 v90, s64, v90
    v_exp_f32 v207, v207 clamp
    v_max_f32 v91, s64, v91
    v_exp_f32 v208, v208 clamp
    v_max_f32 v104, s64, v104
    v_exp_f32 v209, v209 clamp
    v_max_f32 v105, s64, v105
    v_exp_f32 v210, v210 clamp
    v_max_f32 v106, s64, v106
    v_exp_f32 v211, v211 clamp
    v_max_f32 v107, s64, v107
    v_exp_f32 v212, v212 clamp
    v_max_f32 v120, s64, v120
    v_exp_f32 v213, v213 clamp
    v_max_f32 v121, s64, v121
    v_exp_f32 v214, v214 clamp
    v_max_f32 v122, s64, v122
    v_exp_f32 v215, v215 clamp
    v_max_f32 v123, s64, v123
    v_pk_add_f32 v[72:73], v[72:73], v[200:201]
    v_pk_add_f32 v[74:75], v[74:75], v[202:203]
    v_pk_add_f32 v[88:89], v[88:89], v[204:205]
    v_pk_add_f32 v[90:91], v[90:91], v[206:207]
    v_pk_add_f32 v[104:105], v[104:105], v[208:209]
    v_pk_add_f32 v[106:107], v[106:107], v[210:211]
    v_pk_add_f32 v[120:121], v[120:121], v[212:213]
    v_pk_add_f32 v[122:123], v[122:123], v[214:215]
    v_mfma_f32_16x16x32_bf16 v[196:199], v[144:147], a[192:195], 0
    s_add_u32 m0, s7, 100352
    s_add_u32 s60, s65, 131072
    buffer_load_dwordx4 v12, s[40:43], s60 offen offset:0 lds
    v_cvt_pk_bf16_f32 v216, v72, v73
    v_cvt_pk_bf16_f32 v217, v74, v75
    v_cvt_pk_bf16_f32 v232, v76, v77
    v_cvt_pk_bf16_f32 v233, v78, v79
    v_cvt_pk_bf16_f32 v218, v88, v89
    v_cvt_pk_bf16_f32 v219, v90, v91
    v_cvt_pk_bf16_f32 v234, v92, v93
    v_cvt_pk_bf16_f32 v235, v94, v95
    v_cvt_pk_bf16_f32 v220, v104, v105
    v_cvt_pk_bf16_f32 v221, v106, v107
    v_cvt_pk_bf16_f32 v236, v108, v109
    v_cvt_pk_bf16_f32 v237, v110, v111
    v_cvt_pk_bf16_f32 v222, v120, v121
    v_cvt_pk_bf16_f32 v223, v122, v123
    v_cvt_pk_bf16_f32 v238, v124, v125
    v_cvt_pk_bf16_f32 v239, v126, v127
    v_mfma_f32_16x16x32_bf16 v[136:139], v[216:219], v[232:235], 0
    v_mfma_f32_16x16x32_bf16 v[140:143], v[216:219], v[66:69], 0
    v_mfma_f32_16x16x32_bf16 v[136:139], v[220:223], v[236:239], v[136:139]
    v_mfma_f32_16x16x32_bf16 v[140:143], v[220:223], v[66:69], v[140:143]
    s_waitcnt lgkmcnt(0)
    s_barrier
    v_mfma_f32_16x16x32_bf16 v[184:187], v[148:151], a[4:7], v[184:187]
    ds_read_b64_tr_b16 v[160:161], v32 offset:16384
    ds_read_b64_tr_b16 v[162:163], v32 offset:16896
    ds_read_b128 v[72:75], v9 offset:2048
    ds_read_b128 v[76:79], v9 offset:3072
    s_add_u32 s15, s38, 1
    s_and_b32 s15, s15, 0x7f
    s_or_b32 s15, s15, 0x80
    v_mov_b32 v4, s15
    v_mov_b32 v5, 0xff
    v_lshrrev_b32 v3, 4, v1
    v_lshlrev_b32 v3, 4, v3
    s_waitcnt lgkmcnt(0)
    v_pk_add_f32 v[136:137], v[136:137], v[72:73]
    v_pk_add_f32 v[138:139], v[138:139], v[74:75]
    v_pk_add_f32 v[140:141], v[140:141], v[76:77]
    v_pk_add_f32 v[142:143], v[142:143], v[78:79]
    v_bfi_b32 v136, v5, v4, v136
    v_bfi_b32 v137, v5, v4, v137
    v_bfi_b32 v138, v5, v4, v138
    v_bfi_b32 v139, v5, v4, v139
    v_bfi_b32 v140, v5, v4, v140
    v_bfi_b32 v141, v5, v4, v141
    v_bfi_b32 v142, v5, v4, v142
    v_bfi_b32 v143, v5, v4, v143
    buffer_store_dwordx4 v[136:139], v46, s[32:35], s5 offen sc1
    s_mov_b32 s68, 0x00010001
    s_mov_b32 s69, 0x00010001
    s_mov_b64 exec, s[68:69]
    buffer_store_dwordx4 v[140:143], v3, s[32:35], s6 offen sc1
    s_mov_b64 exec, -1
    v_mfma_f32_16x16x32_bf16 v[188:191], v[148:151], a[68:71], v[188:191]
    v_mfma_f32_16x16x32_bf16 v[192:195], v[148:151], a[132:135], v[192:195]
    v_mfma_f32_16x16x32_bf16 v[196:199], v[148:151], a[196:199], v[196:199]
    buffer_load_dwordx4 v13, s[40:43], s60 offen offset:1024 lds
    v_mfma_f32_16x16x32_bf16 v[184:187], v[152:155], a[8:11], v[184:187]
    ds_read_b64_tr_b16 v[164:165], v32 offset:24576
    ds_read_b64_tr_b16 v[166:167], v32 offset:25088
    v_mfma_f32_16x16x32_bf16 v[188:191], v[152:155], a[72:75], v[188:191]
    v_mfma_f32_16x16x32_bf16 v[192:195], v[152:155], a[136:139], v[192:195]
    v_mfma_f32_16x16x32_bf16 v[196:199], v[152:155], a[200:203], v[196:199]
    buffer_load_dwordx4 v16, s[40:43], s60 offen offset:2048 lds
    v_mfma_f32_16x16x32_bf16 v[184:187], v[156:159], a[12:15], v[184:187]
    ds_read_b64_tr_b16 v[168:169], v32 offset:17408
    ds_read_b64_tr_b16 v[170:171], v32 offset:17920
    v_mfma_f32_16x16x32_bf16 v[188:191], v[156:159], a[76:79], v[188:191]
    v_mfma_f32_16x16x32_bf16 v[192:195], v[156:159], a[140:143], v[192:195]
    v_mfma_f32_16x16x32_bf16 v[196:199], v[156:159], a[204:207], v[196:199]
    buffer_load_dwordx4 v17, s[40:43], s60 offen offset:3072 lds
    v_mfma_f32_16x16x32_bf16 v[184:187], v[160:163], a[16:19], v[184:187]
    ds_read_b64_tr_b16 v[172:173], v32 offset:25600
    ds_read_b64_tr_b16 v[174:175], v32 offset:26112
    v_mfma_f32_16x16x32_bf16 v[188:191], v[160:163], a[80:83], v[188:191]
    v_mfma_f32_16x16x32_bf16 v[192:195], v[160:163], a[144:147], v[192:195]
    v_mfma_f32_16x16x32_bf16 v[196:199], v[160:163], a[208:211], v[196:199]
    s_add_u32 m0, s7, 104448
    s_add_u32 s60, s65, 147456
    buffer_load_dwordx4 v12, s[40:43], s60 offen offset:0 lds
    s_waitcnt lgkmcnt(0)
    s_waitcnt vmcnt(15)
    s_barrier
    v_mfma_f32_16x16x32_bf16 v[184:187], v[164:167], a[20:23], v[184:187]
    ds_read_b64_tr_b16 v[144:145], v32 offset:34816
    ds_read_b64_tr_b16 v[146:147], v32 offset:35328
    v_mfma_f32_16x16x32_bf16 v[188:191], v[164:167], a[84:87], v[188:191]
    v_mfma_f32_16x16x32_bf16 v[192:195], v[164:167], a[148:151], v[192:195]
    v_mfma_f32_16x16x32_bf16 v[196:199], v[164:167], a[212:215], v[196:199]
    buffer_load_dwordx4 v13, s[40:43], s60 offen offset:1024 lds
    v_mfma_f32_16x16x32_bf16 v[184:187], v[168:171], a[24:27], v[184:187]
    ds_read_b64_tr_b16 v[148:149], v32 offset:43008
    ds_read_b64_tr_b16 v[150:151], v32 offset:43520
    v_mfma_f32_16x16x32_bf16 v[188:191], v[168:171], a[88:91], v[188:191]
    v_mfma_f32_16x16x32_bf16 v[192:195], v[168:171], a[152:155], v[192:195]
    v_mfma_f32_16x16x32_bf16 v[196:199], v[168:171], a[216:219], v[196:199]
    buffer_load_dwordx4 v16, s[40:43], s60 offen offset:2048 lds
    v_mfma_f32_16x16x32_bf16 v[184:187], v[172:175], a[28:31], v[184:187]
    ds_read_b64_tr_b16 v[152:153], v32 offset:35840
    ds_read_b64_tr_b16 v[154:155], v32 offset:36352
    v_mfma_f32_16x16x32_bf16 v[188:191], v[172:175], a[92:95], v[188:191]
    v_mfma_f32_16x16x32_bf16 v[192:195], v[172:175], a[156:159], v[192:195]
    v_mfma_f32_16x16x32_bf16 v[196:199], v[172:175], a[220:223], v[196:199]
    buffer_load_dwordx4 v17, s[40:43], s60 offen offset:3072 lds
    s_waitcnt lgkmcnt(4)
    v_mfma_f32_16x16x32_bf16 v[184:187], v[144:147], a[32:35], v[184:187]
    ds_read_b64_tr_b16 v[156:157], v32 offset:44032
    ds_read_b64_tr_b16 v[158:159], v32 offset:44544
    v_mfma_f32_16x16x32_bf16 v[188:191], v[144:147], a[96:99], v[188:191]
    v_mfma_f32_16x16x32_bf16 v[192:195], v[144:147], a[160:163], v[192:195]
    v_mfma_f32_16x16x32_bf16 v[196:199], v[144:147], a[224:227], v[196:199]
    s_waitcnt lgkmcnt(4)
    v_mfma_f32_16x16x32_bf16 v[184:187], v[148:151], a[36:39], v[184:187]
    ds_read_b64_tr_b16 v[160:161], v32 offset:51200
    ds_read_b64_tr_b16 v[162:163], v32 offset:51712
    v_mfma_f32_16x16x32_bf16 v[188:191], v[148:151], a[100:103], v[188:191]
    v_mfma_f32_16x16x32_bf16 v[192:195], v[148:151], a[164:167], v[192:195]
    v_mfma_f32_16x16x32_bf16 v[196:199], v[148:151], a[228:231], v[196:199]
    s_waitcnt lgkmcnt(4)
    v_mfma_f32_16x16x32_bf16 v[184:187], v[152:155], a[40:43], v[184:187]
    ds_read_b64_tr_b16 v[164:165], v32 offset:59392
    ds_read_b64_tr_b16 v[166:167], v32 offset:59904
    v_mfma_f32_16x16x32_bf16 v[188:191], v[152:155], a[104:107], v[188:191]
    v_mfma_f32_16x16x32_bf16 v[192:195], v[152:155], a[168:171], v[192:195]
    v_mfma_f32_16x16x32_bf16 v[196:199], v[152:155], a[232:235], v[196:199]
    s_waitcnt lgkmcnt(4)
    v_mfma_f32_16x16x32_bf16 v[184:187], v[156:159], a[44:47], v[184:187]
    ds_read_b64_tr_b16 v[168:169], v32 offset:52224
    ds_read_b64_tr_b16 v[170:171], v32 offset:52736
    v_mfma_f32_16x16x32_bf16 v[188:191], v[156:159], a[108:111], v[188:191]
    v_mfma_f32_16x16x32_bf16 v[192:195], v[156:159], a[172:175], v[192:195]
    v_mfma_f32_16x16x32_bf16 v[196:199], v[156:159], a[236:239], v[196:199]
    s_waitcnt lgkmcnt(4)
    v_mfma_f32_16x16x32_bf16 v[184:187], v[160:163], a[48:51], v[184:187]
    ds_read_b64_tr_b16 v[172:173], v32 offset:60416
    ds_read_b64_tr_b16 v[174:175], v32 offset:60928
    v_mfma_f32_16x16x32_bf16 v[188:191], v[160:163], a[112:115], v[188:191]
    v_mfma_f32_16x16x32_bf16 v[192:195], v[160:163], a[176:179], v[192:195]
    v_mfma_f32_16x16x32_bf16 v[196:199], v[160:163], a[240:243], v[196:199]
    s_waitcnt lgkmcnt(4)
    v_mfma_f32_16x16x32_bf16 v[184:187], v[164:167], a[52:55], v[184:187]
    ds_read_b64_tr_b16 v[144:145], v35 offset:0
    ds_read_b64_tr_b16 v[146:147], v35 offset:512
    v_mfma_f32_16x16x32_bf16 v[188:191], v[164:167], a[116:119], v[188:191]
    v_mfma_f32_16x16x32_bf16 v[192:195], v[164:167], a[180:183], v[192:195]
    v_mfma_f32_16x16x32_bf16 v[196:199], v[164:167], a[244:247], v[196:199]
    s_waitcnt lgkmcnt(4)
    v_mfma_f32_16x16x32_bf16 v[184:187], v[168:171], a[56:59], v[184:187]
    ds_read_b64_tr_b16 v[148:149], v35 offset:8192
    ds_read_b64_tr_b16 v[150:151], v35 offset:8704
    v_mfma_f32_16x16x32_bf16 v[188:191], v[168:171], a[120:123], v[188:191]
    v_mfma_f32_16x16x32_bf16 v[192:195], v[168:171], a[184:187], v[192:195]
    v_mfma_f32_16x16x32_bf16 v[196:199], v[168:171], a[248:251], v[196:199]
    s_waitcnt lgkmcnt(4)
    v_mfma_f32_16x16x32_bf16 v[184:187], v[172:175], a[60:63], v[184:187]
    ds_read_b64_tr_b16 v[152:153], v35 offset:1024
    ds_read_b64_tr_b16 v[154:155], v35 offset:1536
    v_mfma_f32_16x16x32_bf16 v[188:191], v[172:175], a[124:127], v[188:191]
    v_mfma_f32_16x16x32_bf16 v[192:195], v[172:175], a[188:191], v[192:195]
    v_mfma_f32_16x16x32_bf16 v[196:199], v[172:175], a[252:255], v[196:199]
    s_waitcnt lgkmcnt(4)
    v_mfma_f32_16x16x32_bf16 v[200:203], v[144:147], a[0:3], 0
    ds_read_b64_tr_b16 v[156:157], v35 offset:9216
    ds_read_b64_tr_b16 v[158:159], v35 offset:9728
    v_mfma_f32_16x16x32_bf16 v[204:207], v[144:147], a[64:67], 0
    v_pk_mul_f32 v[216:217], v[184:185], s[18:19]
    v_pk_mul_f32 v[218:219], v[186:187], s[18:19]
    v_mfma_f32_16x16x32_bf16 v[208:211], v[144:147], a[128:131], 0
    v_pk_mul_f32 v[220:221], v[188:189], s[18:19]
    v_pk_mul_f32 v[222:223], v[190:191], s[18:19]
    v_mfma_f32_16x16x32_bf16 v[212:215], v[144:147], a[192:195], 0
    v_pk_mul_f32 v[224:225], v[192:193], s[18:19]
    v_pk_mul_f32 v[226:227], v[194:195], s[18:19]
    s_waitcnt lgkmcnt(4)
    v_mfma_f32_16x16x32_bf16 v[200:203], v[148:151], a[4:7], v[200:203]
    ds_read_b64_tr_b16 v[160:161], v35 offset:16384
    ds_read_b64_tr_b16 v[162:163], v35 offset:16896
    v_mfma_f32_16x16x32_bf16 v[204:207], v[148:151], a[68:71], v[204:207]
    v_pk_mul_f32 v[228:229], v[196:197], s[18:19]
    v_pk_mul_f32 v[230:231], v[198:199], s[18:19]
    v_mfma_f32_16x16x32_bf16 v[208:211], v[148:151], a[132:135], v[208:211]
    v_exp_f32 v216, v216 clamp
    v_max_f32 v184, s64, v184
    v_mfma_f32_16x16x32_bf16 v[212:215], v[148:151], a[196:199], v[212:215]
    v_exp_f32 v217, v217 clamp
    v_max_f32 v185, s64, v185
    s_waitcnt lgkmcnt(4)
    v_mfma_f32_16x16x32_bf16 v[200:203], v[152:155], a[8:11], v[200:203]
    ds_read_b64_tr_b16 v[164:165], v35 offset:24576
    ds_read_b64_tr_b16 v[166:167], v35 offset:25088
    v_mfma_f32_16x16x32_bf16 v[204:207], v[152:155], a[72:75], v[204:207]
    v_exp_f32 v218, v218 clamp
    v_max_f32 v186, s64, v186
    v_mfma_f32_16x16x32_bf16 v[208:211], v[152:155], a[136:139], v[208:211]
    v_exp_f32 v219, v219 clamp
    v_max_f32 v187, s64, v187
    v_mfma_f32_16x16x32_bf16 v[212:215], v[152:155], a[200:203], v[212:215]
    v_exp_f32 v220, v220 clamp
    v_max_f32 v188, s64, v188
    s_waitcnt lgkmcnt(4)
    v_mfma_f32_16x16x32_bf16 v[200:203], v[156:159], a[12:15], v[200:203]
    ds_read_b64_tr_b16 v[168:169], v35 offset:17408
    ds_read_b64_tr_b16 v[170:171], v35 offset:17920
    v_mfma_f32_16x16x32_bf16 v[204:207], v[156:159], a[76:79], v[204:207]
    v_exp_f32 v221, v221 clamp
    v_max_f32 v189, s64, v189
    v_mfma_f32_16x16x32_bf16 v[208:211], v[156:159], a[140:143], v[208:211]
    v_exp_f32 v222, v222 clamp
    v_max_f32 v190, s64, v190
    v_mfma_f32_16x16x32_bf16 v[212:215], v[156:159], a[204:207], v[212:215]
    v_exp_f32 v223, v223 clamp
    v_max_f32 v191, s64, v191
    s_waitcnt lgkmcnt(4)
    v_mfma_f32_16x16x32_bf16 v[200:203], v[160:163], a[16:19], v[200:203]
    ds_read_b64_tr_b16 v[172:173], v35 offset:25600
    ds_read_b64_tr_b16 v[174:175], v35 offset:26112
    v_mfma_f32_16x16x32_bf16 v[204:207], v[160:163], a[80:83], v[204:207]
    v_exp_f32 v224, v224 clamp
    v_max_f32 v192, s64, v192
    v_mfma_f32_16x16x32_bf16 v[208:211], v[160:163], a[144:147], v[208:211]
    v_exp_f32 v225, v225 clamp
    v_max_f32 v193, s64, v193
    v_mfma_f32_16x16x32_bf16 v[212:215], v[160:163], a[208:211], v[212:215]
    v_exp_f32 v226, v226 clamp
    v_max_f32 v194, s64, v194
    s_waitcnt lgkmcnt(4)
    v_mfma_f32_16x16x32_bf16 v[200:203], v[164:167], a[20:23], v[200:203]
    ds_read_b64_tr_b16 v[144:145], v35 offset:34816
    ds_read_b64_tr_b16 v[146:147], v35 offset:35328
    v_mfma_f32_16x16x32_bf16 v[204:207], v[164:167], a[84:87], v[204:207]
    v_exp_f32 v227, v227 clamp
    v_max_f32 v195, s64, v195
    v_mfma_f32_16x16x32_bf16 v[208:211], v[164:167], a[148:151], v[208:211]
    v_exp_f32 v228, v228 clamp
    v_max_f32 v196, s64, v196
    v_mfma_f32_16x16x32_bf16 v[212:215], v[164:167], a[212:215], v[212:215]
    v_exp_f32 v229, v229 clamp
    v_max_f32 v197, s64, v197
    s_waitcnt lgkmcnt(4)
    v_mfma_f32_16x16x32_bf16 v[200:203], v[168:171], a[24:27], v[200:203]
    ds_read_b64_tr_b16 v[148:149], v35 offset:43008
    ds_read_b64_tr_b16 v[150:151], v35 offset:43520
    v_mfma_f32_16x16x32_bf16 v[204:207], v[168:171], a[88:91], v[204:207]
    v_exp_f32 v230, v230 clamp
    v_max_f32 v198, s64, v198
    v_mfma_f32_16x16x32_bf16 v[208:211], v[168:171], a[152:155], v[208:211]
    v_exp_f32 v231, v231 clamp
    v_max_f32 v199, s64, v199
    v_mfma_f32_16x16x32_bf16 v[212:215], v[168:171], a[216:219], v[212:215]
    v_pk_add_f32 v[184:185], v[184:185], v[216:217]
    v_pk_add_f32 v[186:187], v[186:187], v[218:219]
    s_waitcnt lgkmcnt(4)
    v_mfma_f32_16x16x32_bf16 v[200:203], v[172:175], a[28:31], v[200:203]
    ds_read_b64_tr_b16 v[152:153], v35 offset:35840
    ds_read_b64_tr_b16 v[154:155], v35 offset:36352
    v_mfma_f32_16x16x32_bf16 v[204:207], v[172:175], a[92:95], v[204:207]
    v_pk_add_f32 v[188:189], v[188:189], v[220:221]
    v_pk_add_f32 v[190:191], v[190:191], v[222:223]
    v_mfma_f32_16x16x32_bf16 v[208:211], v[172:175], a[156:159], v[208:211]
    v_pk_add_f32 v[192:193], v[192:193], v[224:225]
    v_pk_add_f32 v[194:195], v[194:195], v[226:227]
    v_mfma_f32_16x16x32_bf16 v[212:215], v[172:175], a[220:223], v[212:215]
    v_pk_add_f32 v[196:197], v[196:197], v[228:229]
    v_pk_add_f32 v[198:199], v[198:199], v[230:231]
    v_cvt_pk_bf16_f32 v240, v184, v185
    v_cvt_pk_bf16_f32 v241, v186, v187
    v_cvt_pk_bf16_f32 v242, v188, v189
    v_cvt_pk_bf16_f32 v243, v190, v191
    v_cvt_pk_bf16_f32 v244, v192, v193
    v_cvt_pk_bf16_f32 v245, v194, v195
    v_cvt_pk_bf16_f32 v246, v196, v197
    v_cvt_pk_bf16_f32 v247, v198, v199
    s_lshl_b32 s58, s70, 14
    s_add_u32 s58, s58, 4194304
    s_lshl_b32 s59, s70, 10
    s_add_u32 s59, s59, 4718592
    v_and_b32 v3, 15, v1
    v_lshlrev_b32 v3, 6, v3
    v_lshrrev_b32 v4, 4, v1
    v_lshl_add_u32 v3, v4, 4, v3
    s_waitcnt lgkmcnt(4)
    v_mfma_f32_16x16x32_bf16 v[200:203], v[144:147], a[32:35], v[200:203]
    s_add_u32 s60, s58, 0
    buffer_load_dwordx4 v[72:75], v46, s[32:35], s60 offen offset:0 sc1
    v_mfma_f32_16x16x32_bf16 v[204:207], v[144:147], a[96:99], v[204:207]
    ds_read_b64_tr_b16 v[156:157], v35 offset:44032
    ds_read_b64_tr_b16 v[158:159], v35 offset:44544
    v_mfma_f32_16x16x32_bf16 v[208:211], v[144:147], a[160:163], v[208:211]
    buffer_load_dwordx4 v[76:79], v46, s[32:35], s60 offen offset:1024 sc1
    v_mfma_f32_16x16x32_bf16 v[212:215], v[144:147], a[224:227], v[212:215]
    s_waitcnt lgkmcnt(4)
    v_mfma_f32_16x16x32_bf16 v[200:203], v[148:151], a[36:39], v[200:203]
    buffer_load_dwordx4 v[80:83], v46, s[32:35], s60 offen offset:2048 sc1
    ds_read_b64_tr_b16 v[160:161], v35 offset:51200
    v_mfma_f32_16x16x32_bf16 v[204:207], v[148:151], a[100:103], v[204:207]
    ds_read_b64_tr_b16 v[162:163], v35 offset:51712
    v_mfma_f32_16x16x32_bf16 v[208:211], v[148:151], a[164:167], v[208:211]
    buffer_load_dwordx4 v[84:87], v46, s[32:35], s60 offen offset:3072 sc1
    v_mfma_f32_16x16x32_bf16 v[212:215], v[148:151], a[228:231], v[212:215]
    s_waitcnt lgkmcnt(4)
    v_mfma_f32_16x16x32_bf16 v[200:203], v[152:155], a[40:43], v[200:203]
    s_add_u32 s60, s58, 4096
    buffer_load_dwordx4 v[88:91], v46, s[32:35], s60 offen offset:0 sc1
    v_mfma_f32_16x16x32_bf16 v[204:207], v[152:155], a[104:107], v[204:207]
    ds_read_b64_tr_b16 v[164:165], v35 offset:59392
    ds_read_b64_tr_b16 v[166:167], v35 offset:59904
    v_mfma_f32_16x16x32_bf16 v[208:211], v[152:155], a[168:171], v[208:211]
    buffer_load_dwordx4 v[92:95], v46, s[32:35], s60 offen offset:1024 sc1
    v_mfma_f32_16x16x32_bf16 v[212:215], v[152:155], a[232:235], v[212:215]
    s_waitcnt lgkmcnt(4)
    v_mfma_f32_16x16x32_bf16 v[200:203], v[156:159], a[44:47], v[200:203]
    buffer_load_dwordx4 v[96:99], v46, s[32:35], s60 offen offset:2048 sc1
    ds_read_b64_tr_b16 v[168:169], v35 offset:52224
    v_mfma_f32_16x16x32_bf16 v[204:207], v[156:159], a[108:111], v[204:207]
    ds_read_b64_tr_b16 v[170:171], v35 offset:52736
    v_mfma_f32_16x16x32_bf16 v[208:211], v[156:159], a[172:175], v[208:211]
    buffer_load_dwordx4 v[100:103], v46, s[32:35], s60 offen offset:3072 sc1
    v_mfma_f32_16x16x32_bf16 v[212:215], v[156:159], a[236:239], v[212:215]
    s_waitcnt lgkmcnt(4)
    v_mfma_f32_16x16x32_bf16 v[200:203], v[160:163], a[48:51], v[200:203]
    s_add_u32 s60, s58, 8192
    buffer_load_dwordx4 v[104:107], v46, s[32:35], s60 offen offset:0 sc1
    v_mfma_f32_16x16x32_bf16 v[204:207], v[160:163], a[112:115], v[204:207]
    ds_read_b64_tr_b16 v[172:173], v35 offset:60416
    ds_read_b64_tr_b16 v[174:175], v35 offset:60928
    v_mfma_f32_16x16x32_bf16 v[208:211], v[160:163], a[176:179], v[208:211]
    buffer_load_dwordx4 v[108:111], v46, s[32:35], s60 offen offset:1024 sc1
    v_mfma_f32_16x16x32_bf16 v[212:215], v[160:163], a[240:243], v[212:215]
    s_waitcnt lgkmcnt(4)
    v_mfma_f32_16x16x32_bf16 v[200:203], v[164:167], a[52:55], v[200:203]
    buffer_load_dwordx4 v[112:115], v46, s[32:35], s60 offen offset:2048 sc1
    v_mfma_f32_16x16x32_bf16 v[204:207], v[164:167], a[116:119], v[204:207]
    v_mfma_f32_16x16x32_bf16 v[208:211], v[164:167], a[180:183], v[208:211]
    buffer_load_dwordx4 v[116:119], v46, s[32:35], s60 offen offset:3072 sc1
    v_mfma_f32_16x16x32_bf16 v[212:215], v[164:167], a[244:247], v[212:215]
    s_waitcnt lgkmcnt(2)
    v_mfma_f32_16x16x32_bf16 v[200:203], v[168:171], a[56:59], v[200:203]
    s_add_u32 s60, s58, 12288
    buffer_load_dwordx4 v[120:123], v46, s[32:35], s60 offen offset:0 sc1
    v_mfma_f32_16x16x32_bf16 v[204:207], v[168:171], a[120:123], v[204:207]
    v_mfma_f32_16x16x32_bf16 v[208:211], v[168:171], a[184:187], v[208:211]
    buffer_load_dwordx4 v[124:127], v46, s[32:35], s60 offen offset:1024 sc1
    v_mfma_f32_16x16x32_bf16 v[212:215], v[168:171], a[248:251], v[212:215]
    s_waitcnt lgkmcnt(0)
    v_mfma_f32_16x16x32_bf16 v[200:203], v[172:175], a[60:63], v[200:203]
    buffer_load_dwordx4 v[128:131], v46, s[32:35], s60 offen offset:2048 sc1
    v_mfma_f32_16x16x32_bf16 v[204:207], v[172:175], a[124:127], v[204:207]
    v_mfma_f32_16x16x32_bf16 v[208:211], v[172:175], a[188:191], v[208:211]
    buffer_load_dwordx4 v[132:135], v46, s[32:35], s60 offen offset:3072 sc1
    v_mfma_f32_16x16x32_bf16 v[212:215], v[172:175], a[252:255], v[212:215]
    buffer_load_dwordx4 v[136:139], v3, s[32:35], s59 offen sc1
    s_waitcnt lgkmcnt(0)
    s_waitcnt vmcnt(17)
    s_barrier
    v_mov_b32 v6, s15
    v_pk_mul_f32 v[144:145], v[200:201], s[18:19]
    v_pk_mul_f32 v[146:147], v[202:203], s[18:19]
    v_pk_mul_f32 v[148:149], v[204:205], s[18:19]
    v_pk_mul_f32 v[150:151], v[206:207], s[18:19]
    v_pk_mul_f32 v[152:153], v[208:209], s[18:19]
    v_pk_mul_f32 v[154:155], v[210:211], s[18:19]
    v_pk_mul_f32 v[156:157], v[212:213], s[18:19]
    v_pk_mul_f32 v[158:159], v[214:215], s[18:19]
    v_exp_f32 v144, v144 clamp
    s_add_u32 m0, s7, 0
    s_add_u32 s60, s65, 262144
    buffer_load_dwordx4 v12, s[40:43], s60 offen offset:0 lds
    v_max_f32 v200, s64, v200
    v_exp_f32 v145, v145 clamp
    v_max_f32 v201, s64, v201
    v_exp_f32 v146, v146 clamp
    v_max_f32 v202, s64, v202
    v_exp_f32 v147, v147 clamp
    v_max_f32 v203, s64, v203
    v_exp_f32 v148, v148 clamp
    v_max_f32 v204, s64, v204
    buffer_load_dwordx4 v13, s[40:43], s60 offen offset:1024 lds
    v_exp_f32 v149, v149 clamp
    v_max_f32 v205, s64, v205
    v_exp_f32 v150, v150 clamp
    v_max_f32 v206, s64, v206
    v_exp_f32 v151, v151 clamp
    v_max_f32 v207, s64, v207
    v_exp_f32 v152, v152 clamp
    v_max_f32 v208, s64, v208
    v_exp_f32 v153, v153 clamp
    buffer_load_dwordx4 v16, s[40:43], s60 offen offset:2048 lds
    v_max_f32 v209, s64, v209
    v_exp_f32 v154, v154 clamp
    v_max_f32 v210, s64, v210
    v_exp_f32 v155, v155 clamp
    v_max_f32 v211, s64, v211
    v_exp_f32 v156, v156 clamp
    v_max_f32 v212, s64, v212
    v_exp_f32 v157, v157 clamp
    v_max_f32 v213, s64, v213
    buffer_load_dwordx4 v17, s[40:43], s60 offen offset:3072 lds
    v_exp_f32 v158, v158 clamp
    v_max_f32 v214, s64, v214
    v_exp_f32 v159, v159 clamp
    v_max_f32 v215, s64, v215
    v_pk_add_f32 v[200:201], v[200:201], v[144:145]
    v_pk_add_f32 v[202:203], v[202:203], v[146:147]
    v_pk_add_f32 v[204:205], v[204:205], v[148:149]
    v_pk_add_f32 v[206:207], v[206:207], v[150:151]
    v_pk_add_f32 v[208:209], v[208:209], v[152:153]
    s_add_u32 m0, s7, 4096
    s_add_u32 s60, s65, 278528
    buffer_load_dwordx4 v12, s[40:43], s60 offen offset:0 lds
    v_pk_add_f32 v[210:211], v[210:211], v[154:155]
    v_pk_add_f32 v[212:213], v[212:213], v[156:157]
    v_pk_add_f32 v[214:215], v[214:215], v[158:159]
    v_cvt_pk_bf16_f32 v248, v200, v201
    v_cvt_pk_bf16_f32 v249, v202, v203
    v_cvt_pk_bf16_f32 v250, v204, v205
    v_cvt_pk_bf16_f32 v251, v206, v207
    v_cvt_pk_bf16_f32 v252, v208, v209
    v_cvt_pk_bf16_f32 v253, v210, v211
    buffer_load_dwordx4 v13, s[40:43], s60 offen offset:1024 lds
    v_cvt_pk_bf16_f32 v254, v212, v213
    v_cvt_pk_bf16_f32 v255, v214, v215
    s_waitcnt vmcnt(22)
    v_msad_u8 v4, v72, v6, 0
    v_msad_u8 v5, v73, v6, 0
    v_msad_u8 v4, v74, v6, v4
    v_msad_u8 v5, v75, v6, v5
    s_waitcnt vmcnt(21)
    v_msad_u8 v4, v76, v6, v4
    v_msad_u8 v5, v77, v6, v5
    v_msad_u8 v4, v78, v6, v4
    v_msad_u8 v5, v79, v6, v5
    v_pk_add_f32 v[160:161], v[72:73], v[76:77]
    v_pk_add_f32 v[162:163], v[74:75], v[78:79]
    buffer_load_dwordx4 v16, s[40:43], s60 offen offset:2048 lds
    s_waitcnt vmcnt(21)
    v_msad_u8 v4, v80, v6, v4
    v_msad_u8 v5, v81, v6, v5
    v_msad_u8 v4, v82, v6, v4
    v_msad_u8 v5, v83, v6, v5
    v_pk_add_f32 v[160:161], v[160:161], v[80:81]
    v_pk_add_f32 v[162:163], v[162:163], v[82:83]
    s_waitcnt vmcnt(20)
    v_msad_u8 v4, v84, v6, v4
    v_msad_u8 v5, v85, v6, v5
    v_msad_u8 v4, v86, v6, v4
    v_msad_u8 v5, v87, v6, v5
    v_pk_add_f32 v[160:161], v[160:161], v[84:85]
    v_pk_add_f32 v[162:163], v[162:163], v[86:87]
    buffer_load_dwordx4 v17, s[40:43], s60 offen offset:3072 lds
    s_waitcnt vmcnt(20)
    v_msad_u8 v4, v88, v6, v4
    v_msad_u8 v5, v89, v6, v5
    v_msad_u8 v4, v90, v6, v4
    v_msad_u8 v5, v91, v6, v5
    v_pk_add_f32 v[160:161], v[160:161], v[88:89]
    v_pk_add_f32 v[162:163], v[162:163], v[90:91]
    s_waitcnt vmcnt(19)
    v_msad_u8 v4, v92, v6, v4
    v_msad_u8 v5, v93, v6, v5
    v_msad_u8 v4, v94, v6, v4
    v_msad_u8 v5, v95, v6, v5
    v_pk_add_f32 v[160:161], v[160:161], v[92:93]
    v_pk_add_f32 v[162:163], v[162:163], v[94:95]
    s_add_u32 m0, s7, 32768
    s_add_u32 s60, s65, 393216
    buffer_load_dwordx4 v12, s[40:43], s60 offen offset:0 lds
    s_waitcnt vmcnt(19)
    v_msad_u8 v4, v96, v6, v4
    v_msad_u8 v5, v97, v6, v5
    v_msad_u8 v4, v98, v6, v4
    v_msad_u8 v5, v99, v6, v5
    v_pk_add_f32 v[160:161], v[160:161], v[96:97]
    v_pk_add_f32 v[162:163], v[162:163], v[98:99]
    s_waitcnt vmcnt(18)
    v_msad_u8 v4, v100, v6, v4
    v_msad_u8 v5, v101, v6, v5
    v_msad_u8 v4, v102, v6, v4
    v_msad_u8 v5, v103, v6, v5
    v_pk_add_f32 v[160:161], v[160:161], v[100:101]
    v_pk_add_f32 v[162:163], v[162:163], v[102:103]
    buffer_load_dwordx4 v13, s[40:43], s60 offen offset:1024 lds
    s_waitcnt vmcnt(18)
    v_msad_u8 v4, v104, v6, v4
    v_msad_u8 v5, v105, v6, v5
    v_msad_u8 v4, v106, v6, v4
    v_msad_u8 v5, v107, v6, v5
    v_pk_add_f32 v[160:161], v[160:161], v[104:105]
    v_pk_add_f32 v[162:163], v[162:163], v[106:107]
    s_waitcnt vmcnt(17)
    v_msad_u8 v4, v108, v6, v4
    v_msad_u8 v5, v109, v6, v5
    v_msad_u8 v4, v110, v6, v4
    v_msad_u8 v5, v111, v6, v5
    v_pk_add_f32 v[160:161], v[160:161], v[108:109]
    v_pk_add_f32 v[162:163], v[162:163], v[110:111]
    buffer_load_dwordx4 v16, s[40:43], s60 offen offset:2048 lds
    s_waitcnt vmcnt(17)
    v_msad_u8 v4, v112, v6, v4
    v_msad_u8 v5, v113, v6, v5
    v_msad_u8 v4, v114, v6, v4
    v_msad_u8 v5, v115, v6, v5
    v_pk_add_f32 v[160:161], v[160:161], v[112:113]
    v_pk_add_f32 v[162:163], v[162:163], v[114:115]
    s_waitcnt vmcnt(16)
    v_msad_u8 v4, v116, v6, v4
    v_msad_u8 v5, v117, v6, v5
    v_msad_u8 v4, v118, v6, v4
    v_msad_u8 v5, v119, v6, v5
    v_pk_add_f32 v[160:161], v[160:161], v[116:117]
    v_pk_add_f32 v[162:163], v[162:163], v[118:119]
    buffer_load_dwordx4 v17, s[40:43], s60 offen offset:3072 lds
    s_waitcnt vmcnt(16)
    v_msad_u8 v4, v120, v6, v4
    v_msad_u8 v5, v121, v6, v5
    v_msad_u8 v4, v122, v6, v4
    v_msad_u8 v5, v123, v6, v5
    v_pk_add_f32 v[160:161], v[160:161], v[120:121]
    v_pk_add_f32 v[162:163], v[162:163], v[122:123]
    s_waitcnt vmcnt(15)
    v_msad_u8 v4, v124, v6, v4
    v_msad_u8 v5, v125, v6, v5
    v_msad_u8 v4, v126, v6, v4
    v_msad_u8 v5, v127, v6, v5
    v_pk_add_f32 v[160:161], v[160:161], v[124:125]
    v_pk_add_f32 v[162:163], v[162:163], v[126:127]
    s_add_u32 m0, s7, 36864
    s_add_u32 s60, s65, 409600
    buffer_load_dwordx4 v12, s[40:43], s60 offen offset:0 lds
    s_waitcnt vmcnt(15)
    v_msad_u8 v4, v128, v6, v4
    v_msad_u8 v5, v129, v6, v5
    v_msad_u8 v4, v130, v6, v4
    v_msad_u8 v5, v131, v6, v5
    v_pk_add_f32 v[160:161], v[160:161], v[128:129]
    v_pk_add_f32 v[162:163], v[162:163], v[130:131]
    s_waitcnt vmcnt(14)
    v_msad_u8 v4, v132, v6, v4
    v_msad_u8 v5, v133, v6, v5
    v_msad_u8 v4, v134, v6, v4
    v_msad_u8 v5, v135, v6, v5
    v_pk_add_f32 v[160:161], v[160:161], v[132:133]
    v_pk_add_f32 v[162:163], v[162:163], v[134:135]
    buffer_load_dwordx4 v13, s[40:43], s60 offen offset:1024 lds
    s_waitcnt vmcnt(14)
    v_msad_u8 v4, v136, v6, v4
    v_msad_u8 v5, v137, v6, v5
    v_msad_u8 v4, v138, v6, v4
    v_msad_u8 v5, v139, v6, v5
    v_or_b32 v4, v4, v5
    v_cmp_ne_u32 vcc, 0, v4
    buffer_load_dwordx4 v16, s[40:43], s60 offen offset:2048 lds
    buffer_load_dwordx4 v17, s[40:43], s60 offen offset:3072 lds
    s_cbranch_vccz L_kvok_10
L_kvretry_10:
    s_sub_u32 s71, s71, 1
    s_cbranch_scc1 L_kvok_10
    s_sleep 4
    s_add_u32 s60, s58, 0
    buffer_load_dwordx4 v[72:75], v46, s[32:35], s60 offen offset:0 sc1
    buffer_load_dwordx4 v[76:79], v46, s[32:35], s60 offen offset:1024 sc1
    buffer_load_dwordx4 v[80:83], v46, s[32:35], s60 offen offset:2048 sc1
    buffer_load_dwordx4 v[84:87], v46, s[32:35], s60 offen offset:3072 sc1
    s_add_u32 s60, s58, 4096
    buffer_load_dwordx4 v[88:91], v46, s[32:35], s60 offen offset:0 sc1
    buffer_load_dwordx4 v[92:95], v46, s[32:35], s60 offen offset:1024 sc1
    buffer_load_dwordx4 v[96:99], v46, s[32:35], s60 offen offset:2048 sc1
    buffer_load_dwordx4 v[100:103], v46, s[32:35], s60 offen offset:3072 sc1
    s_add_u32 s60, s58, 8192
    buffer_load_dwordx4 v[104:107], v46, s[32:35], s60 offen offset:0 sc1
    buffer_load_dwordx4 v[108:111], v46, s[32:35], s60 offen offset:1024 sc1
    buffer_load_dwordx4 v[112:115], v46, s[32:35], s60 offen offset:2048 sc1
    buffer_load_dwordx4 v[116:119], v46, s[32:35], s60 offen offset:3072 sc1
    s_add_u32 s60, s58, 12288
    buffer_load_dwordx4 v[120:123], v46, s[32:35], s60 offen offset:0 sc1
    buffer_load_dwordx4 v[124:127], v46, s[32:35], s60 offen offset:1024 sc1
    buffer_load_dwordx4 v[128:131], v46, s[32:35], s60 offen offset:2048 sc1
    buffer_load_dwordx4 v[132:135], v46, s[32:35], s60 offen offset:3072 sc1
    buffer_load_dwordx4 v[136:139], v3, s[32:35], s59 offen sc1
    s_waitcnt vmcnt(0)
    v_msad_u8 v4, v72, v6, 0
    v_msad_u8 v5, v73, v6, 0
    v_msad_u8 v4, v74, v6, v4
    v_msad_u8 v5, v75, v6, v5
    v_msad_u8 v4, v76, v6, v4
    v_msad_u8 v5, v77, v6, v5
    v_msad_u8 v4, v78, v6, v4
    v_msad_u8 v5, v79, v6, v5
    v_pk_add_f32 v[160:161], v[72:73], v[76:77]
    v_pk_add_f32 v[162:163], v[74:75], v[78:79]
    v_msad_u8 v4, v80, v6, v4
    v_msad_u8 v5, v81, v6, v5
    v_msad_u8 v4, v82, v6, v4
    v_msad_u8 v5, v83, v6, v5
    v_pk_add_f32 v[160:161], v[160:161], v[80:81]
    v_pk_add_f32 v[162:163], v[162:163], v[82:83]
    v_msad_u8 v4, v84, v6, v4
    v_msad_u8 v5, v85, v6, v5
    v_msad_u8 v4, v86, v6, v4
    v_msad_u8 v5, v87, v6, v5
    v_pk_add_f32 v[160:161], v[160:161], v[84:85]
    v_pk_add_f32 v[162:163], v[162:163], v[86:87]
    v_msad_u8 v4, v88, v6, v4
    v_msad_u8 v5, v89, v6, v5
    v_msad_u8 v4, v90, v6, v4
    v_msad_u8 v5, v91, v6, v5
    v_pk_add_f32 v[160:161], v[160:161], v[88:89]
    v_pk_add_f32 v[162:163], v[162:163], v[90:91]
    v_msad_u8 v4, v92, v6, v4
    v_msad_u8 v5, v93, v6, v5
    v_msad_u8 v4, v94, v6, v4
    v_msad_u8 v5, v95, v6, v5
    v_pk_add_f32 v[160:161], v[160:161], v[92:93]
    v_pk_add_f32 v[162:163], v[162:163], v[94:95]
    v_msad_u8 v4, v96, v6, v4
    v_msad_u8 v5, v97, v6, v5
    v_msad_u8 v4, v98, v6, v4
    v_msad_u8 v5, v99, v6, v5
    v_pk_add_f32 v[160:161], v[160:161], v[96:97]
    v_pk_add_f32 v[162:163], v[162:163], v[98:99]
    v_msad_u8 v4, v100, v6, v4
    v_msad_u8 v5, v101, v6, v5
    v_msad_u8 v4, v102, v6, v4
    v_msad_u8 v5, v103, v6, v5
    v_pk_add_f32 v[160:161], v[160:161], v[100:101]
    v_pk_add_f32 v[162:163], v[162:163], v[102:103]
    v_msad_u8 v4, v104, v6, v4
    v_msad_u8 v5, v105, v6, v5
    v_msad_u8 v4, v106, v6, v4
    v_msad_u8 v5, v107, v6, v5
    v_pk_add_f32 v[160:161], v[160:161], v[104:105]
    v_pk_add_f32 v[162:163], v[162:163], v[106:107]
    v_msad_u8 v4, v108, v6, v4
    v_msad_u8 v5, v109, v6, v5
    v_msad_u8 v4, v110, v6, v4
    v_msad_u8 v5, v111, v6, v5
    v_pk_add_f32 v[160:161], v[160:161], v[108:109]
    v_pk_add_f32 v[162:163], v[162:163], v[110:111]
    v_msad_u8 v4, v112, v6, v4
    v_msad_u8 v5, v113, v6, v5
    v_msad_u8 v4, v114, v6, v4
    v_msad_u8 v5, v115, v6, v5
    v_pk_add_f32 v[160:161], v[160:161], v[112:113]
    v_pk_add_f32 v[162:163], v[162:163], v[114:115]
    v_msad_u8 v4, v116, v6, v4
    v_msad_u8 v5, v117, v6, v5
    v_msad_u8 v4, v118, v6, v4
    v_msad_u8 v5, v119, v6, v5
    v_pk_add_f32 v[160:161], v[160:161], v[116:117]
    v_pk_add_f32 v[162:163], v[162:163], v[118:119]
    v_msad_u8 v4, v120, v6, v4
    v_msad_u8 v5, v121, v6, v5
    v_msad_u8 v4, v122, v6, v4
    v_msad_u8 v5, v123, v6, v5
    v_pk_add_f32 v[160:161], v[160:161], v[120:121]
    v_pk_add_f32 v[162:163], v[162:163], v[122:123]
    v_msad_u8 v4, v124, v6, v4
    v_msad_u8 v5, v125, v6, v5
    v_msad_u8 v4, v126, v6, v4
    v_msad_u8 v5, v127, v6, v5
    v_pk_add_f32 v[160:161], v[160:161], v[124:125]
    v_pk_add_f32 v[162:163], v[162:163], v[126:127]
    v_msad_u8 v4, v128, v6, v4
    v_msad_u8 v5, v129, v6, v5
    v_msad_u8 v4, v130, v6, v4
    v_msad_u8 v5, v131, v6, v5
    v_pk_add_f32 v[160:161], v[160:161], v[128:129]
    v_pk_add_f32 v[162:163], v[162:163], v[130:131]
    v_msad_u8 v4, v132, v6, v4
    v_msad_u8 v5, v133, v6, v5
    v_msad_u8 v4, v134, v6, v4
    v_msad_u8 v5, v135, v6, v5
    v_pk_add_f32 v[160:161], v[160:161], v[132:133]
    v_pk_add_f32 v[162:163], v[162:163], v[134:135]
    v_msad_u8 v4, v136, v6, v4
    v_msad_u8 v5, v137, v6, v5
    v_msad_u8 v4, v138, v6, v4
    v_msad_u8 v5, v139, v6, v5
    v_or_b32 v4, v4, v5
    v_cmp_ne_u32 vcc, 0, v4
    s_cbranch_vccnz L_kvretry_10
L_kvok_10:
    v_add_f32_dpp v136, v136, v136 row_ror:8 row_mask:0xf bank_mask:0xf
    v_add_f32_dpp v137, v137, v137 row_ror:8 row_mask:0xf bank_mask:0xf
    v_add_f32_dpp v138, v138, v138 row_ror:8 row_mask:0xf bank_mask:0xf
    v_add_f32_dpp v139, v139, v139 row_ror:8 row_mask:0xf bank_mask:0xf
    v_add_f32_dpp v136, v136, v136 row_ror:4 row_mask:0xf bank_mask:0xf
    v_add_f32_dpp v137, v137, v137 row_ror:4 row_mask:0xf bank_mask:0xf
    v_add_f32_dpp v138, v138, v138 row_ror:4 row_mask:0xf bank_mask:0xf
    v_add_f32_dpp v139, v139, v139 row_ror:4 row_mask:0xf bank_mask:0xf
    v_add_f32_dpp v136, v136, v136 row_ror:2 row_mask:0xf bank_mask:0xf
    v_add_f32_dpp v137, v137, v137 row_ror:2 row_mask:0xf bank_mask:0xf
    v_add_f32_dpp v138, v138, v138 row_ror:2 row_mask:0xf bank_mask:0xf
    v_add_f32_dpp v139, v139, v139 row_ror:2 row_mask:0xf bank_mask:0xf
    v_add_f32_dpp v136, v136, v136 row_ror:1 row_mask:0xf bank_mask:0xf
    v_add_f32_dpp v137, v137, v137 row_ror:1 row_mask:0xf bank_mask:0xf
    v_add_f32_dpp v138, v138, v138 row_ror:1 row_mask:0xf bank_mask:0xf
    v_add_f32_dpp v139, v139, v139 row_ror:1 row_mask:0xf bank_mask:0xf
    v_cvt_pk_bf16_f32 v144, v160, v161
    v_cvt_pk_bf16_f32 v145, v162, v163
    v_cvt_pk_bf16_f32 v146, v136, v137
    v_cvt_pk_bf16_f32 v147, v138, v139
    ds_write_b128 v9, v[144:147] offset:4096
    s_nop 0
    v_mfma_f32_16x16x16_bf16 v[184:187], v[146:147], v[240:241], 0
    v_mfma_f32_16x16x16_bf16 v[72:75], v[144:145], v[240:241], 0
    v_mfma_f32_16x16x16_bf16 v[188:191], v[146:147], v[242:243], 0
    v_mfma_f32_16x16x16_bf16 v[76:79], v[144:145], v[242:243], 0
    v_mfma_f32_16x16x16_bf16 v[192:195], v[146:147], v[244:245], 0
    v_mfma_f32_16x16x16_bf16 v[80:83], v[144:145], v[244:245], 0
    v_mfma_f32_16x16x16_bf16 v[196:199], v[146:147], v[246:247], 0
    v_mfma_f32_16x16x16_bf16 v[84:87], v[144:145], v[246:247], 0
    s_waitcnt lgkmcnt(0)
    s_barrier
    ds_read_b128 v[148:151], v9 offset:5120
    v_add_f32 v184, s64, v184
    v_add_f32 v188, s64, v188
    v_add_f32 v192, s64, v192
    s_nop 0
    v_add_f32 v196, s64, v196
    v_rcp_f32 v184, v184
    v_rcp_f32 v188, v188
    v_rcp_f32 v192, v192
    v_rcp_f32 v196, v196
    v_pk_mul_f32 v[72:73], v[72:73], v[184:185] op_sel_hi:[1,0]
    v_pk_mul_f32 v[74:75], v[74:75], v[184:185] op_sel_hi:[1,0]
    v_pk_mul_f32 v[76:77], v[76:77], v[188:189] op_sel_hi:[1,0]
    v_pk_mul_f32 v[78:79], v[78:79], v[188:189] op_sel_hi:[1,0]
    v_pk_mul_f32 v[80:81], v[80:81], v[192:193] op_sel_hi:[1,0]
    v_pk_mul_f32 v[82:83], v[82:83], v[192:193] op_sel_hi:[1,0]
    v_pk_mul_f32 v[84:85], v[84:85], v[196:197] op_sel_hi:[1,0]
    v_pk_mul_f32 v[86:87], v[86:87], v[196:197] op_sel_hi:[1,0]
    v_cvt_pk_bf16_f32 v120, v72, v73
    v_cvt_pk_bf16_f32 v121, v74, v75
    v_cvt_pk_bf16_f32 v124, v76, v77
    v_cvt_pk_bf16_f32 v125, v78, v79
    v_cvt_pk_bf16_f32 v128, v80, v81
    v_cvt_pk_bf16_f32 v129, v82, v83
    v_cvt_pk_bf16_f32 v132, v84, v85
    v_cvt_pk_bf16_f32 v133, v86, v87
    s_waitcnt lgkmcnt(0)
    v_mfma_f32_16x16x16_bf16 v[200:203], v[150:151], v[248:249], 0
    v_mfma_f32_16x16x16_bf16 v[88:91], v[148:149], v[248:249], 0
    v_mfma_f32_16x16x16_bf16 v[204:207], v[150:151], v[250:251], 0
    v_mfma_f32_16x16x16_bf16 v[92:95], v[148:149], v[250:251], 0
    v_mfma_f32_16x16x16_bf16 v[208:211], v[150:151], v[252:253], 0
    v_mfma_f32_16x16x16_bf16 v[96:99], v[148:149], v[252:253], 0
    v_mfma_f32_16x16x16_bf16 v[212:215], v[150:151], v[254:255], 0
    v_mfma_f32_16x16x16_bf16 v[100:103], v[148:149], v[254:255], 0
    s_or_b32 s60, s49, s53
    s_cmp_lg_u32 s60, 0
    s_cbranch_scc1 L_nobk_10
    s_add_u32 s60, s38, 1
    v_mov_b32 v4, s60
    v_mov_b32 v5, 0
    s_mov_b64 exec, 1
    buffer_store_dword v4, v5, s[32:35], s14 offen sc1
    s_mov_b64 exec, -1
L_nobk_10:
    v_add_f32 v200, s64, v200
    v_add_f32 v204, s64, v204
    v_add_f32 v208, s64, v208
    v_add_f32 v212, s64, v212
    v_rcp_f32 v200, v200
    v_rcp_f32 v204, v204
    v_rcp_f32 v208, v208
    v_rcp_f32 v212, v212
    v_pk_mul_f32 v[88:89], v[88:89], v[200:201] op_sel_hi:[1,0]
    v_pk_mul_f32 v[90:91], v[90:91], v[200:201] op_sel_hi:[1,0]
    v_pk_mul_f32 v[92:93], v[92:93], v[204:205] op_sel_hi:[1,0]
    v_pk_mul_f32 v[94:95], v[94:95], v[204:205] op_sel_hi:[1,0]
    v_pk_mul_f32 v[96:97], v[96:97], v[208:209] op_sel_hi:[1,0]
    v_pk_mul_f32 v[98:99], v[98:99], v[208:209] op_sel_hi:[1,0]
    v_pk_mul_f32 v[100:101], v[100:101], v[212:213] op_sel_hi:[1,0]
    v_pk_mul_f32 v[102:103], v[102:103], v[212:213] op_sel_hi:[1,0]
    v_cvt_pk_bf16_f32 v122, v88, v89
    v_cvt_pk_bf16_f32 v123, v90, v91
    v_cvt_pk_bf16_f32 v126, v92, v93
    v_cvt_pk_bf16_f32 v127, v94, v95
    v_cvt_pk_bf16_f32 v130, v96, v97
    v_cvt_pk_bf16_f32 v131, v98, v99
    v_cvt_pk_bf16_f32 v134, v100, v101
    v_cvt_pk_bf16_f32 v135, v102, v103
    s_add_u32 s60, s4, 0
    buffer_store_dwordx4 v[120:123], v46, s[32:35], s60 offen sc1
    s_add_u32 s60, s4, 16384
    buffer_store_dwordx4 v[124:127], v46, s[32:35], s60 offen sc1
    s_add_u32 s60, s4, 32768
    buffer_store_dwordx4 v[128:131], v46, s[32:35], s60 offen sc1
    s_add_u32 s60, s4, 49152
    buffer_store_dwordx4 v[132:135], v46, s[32:35], s60 offen sc1
    s_branch L_phase2
L_path3:
    s_lshl_b32 s58, s48, 4
    s_add_u32 s58, s58, s49
    s_lshl_b32 s13, s58, 7
    s_add_u32 s13, s13, 5242880
    s_lshl_b32 s11, s58, 8
    s_add_u32 s11, s11, 5251072
    s_lshl_b32 s14, s50, 7
    s_add_u32 s14, s14, 5246976
    s_load_dwordx2 s[36:37], s[20:21], s13
    s_load_dwordx2 s[38:39], s[20:21], s14
    s_lshl_b32 s59, s50, 1
    s_add_u32 s59, s59, s53
    s_lshl_b32 s12, s59, 3
    s_add_u32 s12, s12, s11
    s_add_u32 s12, s12, 128
    s_lshr_b32 s60, s50, 2
    s_lshl_b32 s60, s60, 7
    s_add_u32 s11, s11, s60
    v_lshrrev_b32 v2, 4, v1
    v_and_b32 v3, 15, v1
    v_lshlrev_b32 v5, 1, v2
    v_xor_b32 v5, v3, v5
    v_lshlrev_b32 v6, 10, v2
    v_lshl_add_u32 v12, v5, 4, v6
    v_xor_b32 v6, 128, v12
    v_add_u32 v13, 3072, v6
    v_add_u32 v16, 6144, v12
    v_add_u32 v17, 9216, v6
    v_and_b32 v2, 15, v1
    v_lshrrev_b32 v3, 4, v1
    v_lshrrev_b32 v4, 1, v2
    v_xor_b32 v5, v3, v4
    v_lshlrev_b32 v6, 7, v2
    v_lshl_add_u32 v6, v5, 4, v6
    v_lshrrev_b32 v7, 3, v2
    v_lshl_add_u32 v7, v7, 10, v6
    v_add_u32 v20, 8192, v7
    v_xor_b32 v23, 64, v20
    v_add_u32 v21, 65536, v20
    v_add_u32 v22, 131072, v20
    v_add_u32 v24, 65536, v23
    v_add_u32 v25, 131072, v23
    v_lshrrev_b32 v4, 2, v2
    v_and_b32 v5, 3, v2
    v_lshrrev_b32 v8, 3, v2
    v_and_b32 v7, 1, v3
    v_lshl_or_b32 v8, v7, 1, v8
    v_lshrrev_b32 v6, 1, v3
    v_lshlrev_b32 v6, 12, v6
    v_lshl_add_u32 v6, v7, 11, v6
    v_lshl_add_u32 v6, v4, 7, v6
    v_lshl_add_u32 v6, v5, 3, v6
    s_lshl_b32 s58, s53, 1
    v_xor_b32 v7, s58, v8
    v_lshl_add_u32 v32, v7, 5, v6
    v_xor_b32 v35, 32, v32
    v_add_u32 v33, 65536, v32
    v_add_u32 v34, 131072, v32
    v_add_u32 v36, 65536, v35
    v_add_u32 v37, 131072, v35
    v_lshlrev_b32 v46, 4, v1
    v_lshlrev_b32 v47, 3, v1
    s_mov_b32 s61, 0x3eb8aa3b
    s_mov_b32 s62, 0xbeb8aa3b
    s_mov_b32 s63, 0x3fb8aa3b
    s_mov_b32 s64, 0x358637bd
    s_mov_b32 s71, 300000
    s_mov_b32 s18, 0x3fb8aa3b
    s_mov_b32 s19, 0x3fb8aa3b
    s_mov_b32 s96, 0x3eb8aa3b
    s_mov_b32 s97, 0x3eb8aa3b
    v_mov_b32 v66, 0x3f803f80
    v_mov_b32 v67, 0x3f803f80
    v_mov_b32 v68, 0x3f803f80
    v_mov_b32 v69, 0x3f803f80
    s_lshl_b32 s58, s49, 3
    s_add_u32 s8, s58, 128
    s_add_u32 s4, s8, 4
    s_lshl_b32 s4, s4, 4
    s_add_u32 s4, s4, s59
    s_lshl_b32 s4, s4, 10
    s_lshr_b32 s59, s50, 2
    s_lshl_b32 s59, s59, 2
    s_add_u32 s8, s8, s59
    s_add_u32 s8, s8, s51
    s_lshl_b32 s8, s8, 14
    s_lshl_b32 s7, s51, 13
    s_lshl_b32 s58, s53, 13
    v_add_u32 v9, s58, v46
    v_add_u32 v9, 139264, v9
    s_lshl_b32 s58, s50, 2
    s_lshl_b32 s59, s53, 1
    s_add_u32 s58, s58, s59
    s_add_u32 s70, s58, 1
    s_lshl_b32 s58, s70, 4
    s_add_u32 s58, s58, s49
    s_lshl_b32 s5, s58, 10
    s_add_u32 s5, s5, 4194304
    s_lshl_b32 s6, s58, 6
    s_add_u32 s6, s6, 4718592
    s_add_u32 s17, s16, 2
    s_and_b32 s17, s17, 7
    s_add_u32 m0, s57, 69632
    s_lshl_b32 s60, s17, 7
    s_add_u32 s60, s60, s54
    buffer_load_dwordx4 v10, s[24:27], s60 offen offset:0 lds
    buffer_load_dwordx4 v10, s[24:27], s60 offen offset:1024 lds
    buffer_load_dwordx4 v11, s[24:27], s60 offen offset:2048 lds
    buffer_load_dwordx4 v11, s[24:27], s60 offen offset:3072 lds
    s_add_u32 m0, s57, 88064
    s_mul_i32 s60, s17, 196608
    s_add_u32 s60, s60, s66
    buffer_load_dwordx4 v14, s[28:31], s60 offen offset:0 lds
    buffer_load_dwordx4 v14, s[28:31], s60 offen offset:1024 lds
    buffer_load_dwordx4 v15, s[28:31], s60 offen offset:2048 lds
    buffer_load_dwordx4 v15, s[28:31], s60 offen offset:3072 lds
    s_waitcnt vmcnt(18)
    s_barrier
    ds_read_b128 a[0:3], v20 offset:0
    ds_read_b64_tr_b16 v[144:145], v32 offset:18432
    ds_read_b64_tr_b16 v[146:147], v32 offset:18944
    ds_read_b64_tr_b16 v[148:149], v32 offset:19456
    ds_read_b64_tr_b16 v[150:151], v32 offset:19968
    ds_read_b64_tr_b16 v[152:153], v35 offset:18432
    ds_read_b64_tr_b16 v[154:155], v35 offset:18944
    ds_read_b64_tr_b16 v[156:157], v35 offset:19456
    ds_read_b64_tr_b16 v[158:159], v35 offset:19968
    ds_read_b128 a[64:67], v20 offset:1024
    ds_read_b128 a[128:131], v20 offset:4096
    ds_read_b128 a[192:195], v20 offset:5120
    s_waitcnt lgkmcnt(11)
    s_waitcnt lgkmcnt(9)
    v_mfma_f32_16x16x32_bf16 v[72:75], a[0:3], v[144:147], 0
    ds_read_b128 a[4:7], v23 offset:0
    s_waitcnt lgkmcnt(8)
    v_mfma_f32_16x16x32_bf16 v[76:79], a[0:3], v[148:151], 0
    ds_read_b64_tr_b16 v[160:161], v32 offset:26624
    s_waitcnt lgkmcnt(7)
    v_mfma_f32_16x16x32_bf16 v[80:83], a[0:3], v[152:155], 0
    ds_read_b64_tr_b16 v[162:163], v32 offset:27136
    s_waitcnt lgkmcnt(6)
    v_mfma_f32_16x16x32_bf16 v[84:87], a[0:3], v[156:159], 0
    s_add_u32 s17, s16, 3
    s_and_b32 s17, s17, 7
    s_add_u32 m0, s57, 104448
    s_lshl_b32 s60, s17, 7
    s_add_u32 s60, s60, s54
    buffer_load_dwordx4 v10, s[24:27], s60 offen offset:0 lds
    s_waitcnt lgkmcnt(5)
    v_mfma_f32_16x16x32_bf16 v[88:91], a[64:67], v[144:147], 0
    ds_read_b64_tr_b16 v[164:165], v32 offset:27648
    v_mfma_f32_16x16x32_bf16 v[92:95], a[64:67], v[148:151], 0
    ds_read_b64_tr_b16 v[166:167], v32 offset:28160
    v_mfma_f32_16x16x32_bf16 v[96:99], a[64:67], v[152:155], 0
    ds_read_b64_tr_b16 v[168:169], v35 offset:26624
    v_mfma_f32_16x16x32_bf16 v[100:103], a[64:67], v[156:159], 0
    buffer_load_dwordx4 v10, s[24:27], s60 offen offset:1024 lds
    s_waitcnt lgkmcnt(7)
    v_mfma_f32_16x16x32_bf16 v[104:107], a[128:131], v[144:147], 0
    ds_read_b64_tr_b16 v[170:171], v35 offset:27136
    v_mfma_f32_16x16x32_bf16 v[108:111], a[128:131], v[148:151], 0
    ds_read_b64_tr_b16 v[172:173], v35 offset:27648
    v_mfma_f32_16x16x32_bf16 v[112:115], a[128:131], v[152:155], 0
    ds_read_b64_tr_b16 v[174:175], v35 offset:28160
    v_mfma_f32_16x16x32_bf16 v[116:119], a[128:131], v[156:159], 0
    buffer_load_dwordx4 v11, s[24:27], s60 offen offset:2048 lds
    s_waitcnt lgkmcnt(9)
    v_mfma_f32_16x16x32_bf16 v[120:123], a[192:195], v[144:147], 0
    ds_read_b128 a[68:71], v23 offset:1024
    v_mfma_f32_16x16x32_bf16 v[124:127], a[192:195], v[148:151], 0
    ds_read_b128 a[132:135], v23 offset:4096
    v_mfma_f32_16x16x32_bf16 v[128:131], a[192:195], v[152:155], 0
    ds_read_b128 a[196:199], v23 offset:5120
    v_mfma_f32_16x16x32_bf16 v[132:135], a[192:195], v[156:159], 0
    buffer_load_dwordx4 v11, s[24:27], s60 offen offset:3072 lds
    s_waitcnt lgkmcnt(11)
    s_waitcnt lgkmcnt(9)
    v_mfma_f32_16x16x32_bf16 v[72:75], a[4:7], v[160:163], v[72:75]
    s_waitcnt lgkmcnt(7)
    v_mfma_f32_16x16x32_bf16 v[76:79], a[4:7], v[164:167], v[76:79]
    s_add_u32 m0, s57, 122880
    s_mul_i32 s60, s17, 196608
    s_add_u32 s60, s60, s66
    buffer_load_dwordx4 v14, s[28:31], s60 offen offset:0 lds
    s_waitcnt lgkmcnt(5)
    v_mfma_f32_16x16x32_bf16 v[80:83], a[4:7], v[168:171], v[80:83]
    s_waitcnt lgkmcnt(3)
    v_mfma_f32_16x16x32_bf16 v[84:87], a[4:7], v[172:175], v[84:87]
    s_waitcnt lgkmcnt(0)
    s_waitcnt vmcnt(15)
    s_barrier
    v_mfma_f32_16x16x32_bf16 v[88:91], a[68:71], v[160:163], v[88:91]
    ds_read_b128 a[8:11], v20 offset:34816
    ds_read_b64_tr_b16 v[144:145], v32 offset:53248
    v_mfma_f32_16x16x32_bf16 v[92:95], a[68:71], v[164:167], v[92:95]
    ds_read_b64_tr_b16 v[146:147], v32 offset:53760
    ds_read_b64_tr_b16 v[148:149], v32 offset:54272
    v_mfma_f32_16x16x32_bf16 v[96:99], a[68:71], v[168:171], v[96:99]
    ds_read_b64_tr_b16 v[150:151], v32 offset:54784
    ds_read_b64_tr_b16 v[152:153], v35 offset:53248
    v_mfma_f32_16x16x32_bf16 v[100:103], a[68:71], v[172:175], v[100:103]
    buffer_load_dwordx4 v14, s[28:31], s60 offen offset:1024 lds
    ds_read_b64_tr_b16 v[154:155], v35 offset:53760
    v_mfma_f32_16x16x32_bf16 v[104:107], a[132:135], v[160:163], v[104:107]
    ds_read_b64_tr_b16 v[156:157], v35 offset:54272
    ds_read_b64_tr_b16 v[158:159], v35 offset:54784
    v_mfma_f32_16x16x32_bf16 v[108:111], a[132:135], v[164:167], v[108:111]
    ds_read_b128 a[72:75], v20 offset:35840
    ds_read_b128 a[136:139], v20 offset:38912
    v_mfma_f32_16x16x32_bf16 v[112:115], a[132:135], v[168:171], v[112:115]
    ds_read_b128 a[200:203], v20 offset:39936
    v_mfma_f32_16x16x32_bf16 v[116:119], a[132:135], v[172:175], v[116:119]
    buffer_load_dwordx4 v15, s[28:31], s60 offen offset:2048 lds
    v_mfma_f32_16x16x32_bf16 v[120:123], a[196:199], v[160:163], v[120:123]
    v_mfma_f32_16x16x32_bf16 v[124:127], a[196:199], v[164:167], v[124:127]
    v_mfma_f32_16x16x32_bf16 v[128:131], a[196:199], v[168:171], v[128:131]
    v_mfma_f32_16x16x32_bf16 v[132:135], a[196:199], v[172:175], v[132:135]
    buffer_load_dwordx4 v15, s[28:31], s60 offen offset:3072 lds
    s_waitcnt lgkmcnt(11)
    s_waitcnt lgkmcnt(9)
    v_mfma_f32_16x16x32_bf16 v[72:75], a[8:11], v[144:147], v[72:75]
    ds_read_b128 a[12:15], v23 offset:34816
    s_waitcnt lgkmcnt(8)
    v_mfma_f32_16x16x32_bf16 v[76:79], a[8:11], v[148:151], v[76:79]
    ds_read_b64_tr_b16 v[160:161], v32 offset:61440
    s_waitcnt lgkmcnt(7)
    v_mfma_f32_16x16x32_bf16 v[80:83], a[8:11], v[152:155], v[80:83]
    ds_read_b64_tr_b16 v[162:163], v32 offset:61952
    s_waitcnt lgkmcnt(6)
    v_mfma_f32_16x16x32_bf16 v[84:87], a[8:11], v[156:159], v[84:87]
    s_add_u32 s17, s16, 4
    s_and_b32 s17, s17, 7
    s_add_u32 m0, s57, 0
    s_lshl_b32 s60, s17, 7
    s_add_u32 s60, s60, s54
    buffer_load_dwordx4 v10, s[24:27], s60 offen offset:0 lds
    s_waitcnt lgkmcnt(5)
    v_mfma_f32_16x16x32_bf16 v[88:91], a[72:75], v[144:147], v[88:91]
    ds_read_b64_tr_b16 v[164:165], v32 offset:62464
    v_mfma_f32_16x16x32_bf16 v[92:95], a[72:75], v[148:151], v[92:95]
    ds_read_b64_tr_b16 v[166:167], v32 offset:62976
    v_mfma_f32_16x16x32_bf16 v[96:99], a[72:75], v[152:155], v[96:99]
    ds_read_b64_tr_b16 v[168:169], v35 offset:61440
    v_mfma_f32_16x16x32_bf16 v[100:103], a[72:75], v[156:159], v[100:103]
    buffer_load_dwordx4 v10, s[24:27], s60 offen offset:1024 lds
    s_waitcnt lgkmcnt(7)
    v_mfma_f32_16x16x32_bf16 v[104:107], a[136:139], v[144:147], v[104:107]
    ds_read_b64_tr_b16 v[170:171], v35 offset:61952
    v_mfma_f32_16x16x32_bf16 v[108:111], a[136:139], v[148:151], v[108:111]
    ds_read_b64_tr_b16 v[172:173], v35 offset:62464
    v_mfma_f32_16x16x32_bf16 v[112:115], a[136:139], v[152:155], v[112:115]
    ds_read_b64_tr_b16 v[174:175], v35 offset:62976
    v_mfma_f32_16x16x32_bf16 v[116:119], a[136:139], v[156:159], v[116:119]
    buffer_load_dwordx4 v11, s[24:27], s60 offen offset:2048 lds
    s_waitcnt lgkmcnt(9)
    v_mfma_f32_16x16x32_bf16 v[120:123], a[200:203], v[144:147], v[120:123]
    ds_read_b128 a[76:79], v23 offset:35840
    v_mfma_f32_16x16x32_bf16 v[124:127], a[200:203], v[148:151], v[124:127]
    ds_read_b128 a[140:143], v23 offset:38912
    v_mfma_f32_16x16x32_bf16 v[128:131], a[200:203], v[152:155], v[128:131]
    ds_read_b128 a[204:207], v23 offset:39936
    v_mfma_f32_16x16x32_bf16 v[132:135], a[200:203], v[156:159], v[132:135]
    buffer_load_dwordx4 v11, s[24:27], s60 offen offset:3072 lds
    s_waitcnt lgkmcnt(11)
    s_waitcnt lgkmcnt(9)
    v_mfma_f32_16x16x32_bf16 v[72:75], a[12:15], v[160:163], v[72:75]
    s_waitcnt lgkmcnt(7)
    v_mfma_f32_16x16x32_bf16 v[76:79], a[12:15], v[164:167], v[76:79]
    s_add_u32 m0, s57, 18432
    s_mul_i32 s60, s17, 196608
    s_add_u32 s60, s60, s66
    buffer_load_dwordx4 v14, s[28:31], s60 offen offset:0 lds
    s_waitcnt lgkmcnt(5)
    v_mfma_f32_16x16x32_bf16 v[80:83], a[12:15], v[168:171], v[80:83]
    s_waitcnt lgkmcnt(3)
    v_mfma_f32_16x16x32_bf16 v[84:87], a[12:15], v[172:175], v[84:87]
    s_waitcnt lgkmcnt(0)
    s_waitcnt vmcnt(13)
    s_barrier
    v_mfma_f32_16x16x32_bf16 v[88:91], a[76:79], v[160:163], v[88:91]
    ds_read_b128 a[16:19], v21 offset:4096
    ds_read_b64_tr_b16 v[144:145], v33 offset:22528
    v_mfma_f32_16x16x32_bf16 v[92:95], a[76:79], v[164:167], v[92:95]
    ds_read_b64_tr_b16 v[146:147], v33 offset:23040
    ds_read_b64_tr_b16 v[148:149], v33 offset:23552
    v_mfma_f32_16x16x32_bf16 v[96:99], a[76:79], v[168:171], v[96:99]
    ds_read_b64_tr_b16 v[150:151], v33 offset:24064
    ds_read_b64_tr_b16 v[152:153], v36 offset:22528
    v_mfma_f32_16x16x32_bf16 v[100:103], a[76:79], v[172:175], v[100:103]
    buffer_load_dwordx4 v14, s[28:31], s60 offen offset:1024 lds
    ds_read_b64_tr_b16 v[154:155], v36 offset:23040
    v_mfma_f32_16x16x32_bf16 v[104:107], a[140:143], v[160:163], v[104:107]
    ds_read_b64_tr_b16 v[156:157], v36 offset:23552
    ds_read_b64_tr_b16 v[158:159], v36 offset:24064
    v_mfma_f32_16x16x32_bf16 v[108:111], a[140:143], v[164:167], v[108:111]
    ds_read_b128 a[80:83], v21 offset:5120
    ds_read_b128 a[144:147], v21 offset:8192
    v_mfma_f32_16x16x32_bf16 v[112:115], a[140:143], v[168:171], v[112:115]
    ds_read_b128 a[208:211], v21 offset:9216
    v_mfma_f32_16x16x32_bf16 v[116:119], a[140:143], v[172:175], v[116:119]
    buffer_load_dwordx4 v15, s[28:31], s60 offen offset:2048 lds
    v_mfma_f32_16x16x32_bf16 v[120:123], a[204:207], v[160:163], v[120:123]
    v_mfma_f32_16x16x32_bf16 v[124:127], a[204:207], v[164:167], v[124:127]
    v_mfma_f32_16x16x32_bf16 v[128:131], a[204:207], v[168:171], v[128:131]
    v_mfma_f32_16x16x32_bf16 v[132:135], a[204:207], v[172:175], v[132:135]
    buffer_load_dwordx4 v15, s[28:31], s60 offen offset:3072 lds
    s_waitcnt lgkmcnt(11)
    s_waitcnt lgkmcnt(9)
    v_mfma_f32_16x16x32_bf16 v[72:75], a[16:19], v[144:147], v[72:75]
    ds_read_b128 a[20:23], v24 offset:4096
    s_waitcnt lgkmcnt(8)
    v_mfma_f32_16x16x32_bf16 v[76:79], a[16:19], v[148:151], v[76:79]
    ds_read_b64_tr_b16 v[160:161], v33 offset:30720
    s_waitcnt lgkmcnt(7)
    v_mfma_f32_16x16x32_bf16 v[80:83], a[16:19], v[152:155], v[80:83]
    ds_read_b64_tr_b16 v[162:163], v33 offset:31232
    s_waitcnt lgkmcnt(6)
    v_mfma_f32_16x16x32_bf16 v[84:87], a[16:19], v[156:159], v[84:87]
    s_add_u32 s17, s16, 5
    s_and_b32 s17, s17, 7
    s_add_u32 m0, s57, 34816
    s_lshl_b32 s60, s17, 7
    s_add_u32 s60, s60, s54
    buffer_load_dwordx4 v10, s[24:27], s60 offen offset:0 lds
    s_waitcnt lgkmcnt(5)
    v_mfma_f32_16x16x32_bf16 v[88:91], a[80:83], v[144:147], v[88:91]
    ds_read_b64_tr_b16 v[164:165], v33 offset:31744
    v_mfma_f32_16x16x32_bf16 v[92:95], a[80:83], v[148:151], v[92:95]
    ds_read_b64_tr_b16 v[166:167], v33 offset:32256
    v_mfma_f32_16x16x32_bf16 v[96:99], a[80:83], v[152:155], v[96:99]
    ds_read_b64_tr_b16 v[168:169], v36 offset:30720
    v_mfma_f32_16x16x32_bf16 v[100:103], a[80:83], v[156:159], v[100:103]
    buffer_load_dwordx4 v10, s[24:27], s60 offen offset:1024 lds
    s_waitcnt lgkmcnt(7)
    v_mfma_f32_16x16x32_bf16 v[104:107], a[144:147], v[144:147], v[104:107]
    ds_read_b64_tr_b16 v[170:171], v36 offset:31232
    v_mfma_f32_16x16x32_bf16 v[108:111], a[144:147], v[148:151], v[108:111]
    ds_read_b64_tr_b16 v[172:173], v36 offset:31744
    v_mfma_f32_16x16x32_bf16 v[112:115], a[144:147], v[152:155], v[112:115]
    ds_read_b64_tr_b16 v[174:175], v36 offset:32256
    v_mfma_f32_16x16x32_bf16 v[116:119], a[144:147], v[156:159], v[116:119]
    buffer_load_dwordx4 v11, s[24:27], s60 offen offset:2048 lds
    s_waitcnt lgkmcnt(9)
    v_mfma_f32_16x16x32_bf16 v[120:123], a[208:211], v[144:147], v[120:123]
    ds_read_b128 a[84:87], v24 offset:5120
    v_mfma_f32_16x16x32_bf16 v[124:127], a[208:211], v[148:151], v[124:127]
    ds_read_b128 a[148:151], v24 offset:8192
    v_mfma_f32_16x16x32_bf16 v[128:131], a[208:211], v[152:155], v[128:131]
    ds_read_b128 a[212:215], v24 offset:9216
    v_mfma_f32_16x16x32_bf16 v[132:135], a[208:211], v[156:159], v[132:135]
    buffer_load_dwordx4 v11, s[24:27], s60 offen offset:3072 lds
    s_waitcnt lgkmcnt(11)
    s_waitcnt lgkmcnt(9)
    v_mfma_f32_16x16x32_bf16 v[72:75], a[20:23], v[160:163], v[72:75]
    s_waitcnt lgkmcnt(7)
    v_mfma_f32_16x16x32_bf16 v[76:79], a[20:23], v[164:167], v[76:79]
    s_add_u32 m0, s57, 53248
    s_mul_i32 s60, s17, 196608
    s_add_u32 s60, s60, s66
    buffer_load_dwordx4 v14, s[28:31], s60 offen offset:0 lds
    s_waitcnt lgkmcnt(5)
    v_mfma_f32_16x16x32_bf16 v[80:83], a[20:23], v[168:171], v[80:83]
    s_waitcnt lgkmcnt(3)
    v_mfma_f32_16x16x32_bf16 v[84:87], a[20:23], v[172:175], v[84:87]
    s_waitcnt lgkmcnt(0)
    s_waitcnt vmcnt(13)
    s_barrier
    v_mfma_f32_16x16x32_bf16 v[88:91], a[84:87], v[160:163], v[88:91]
    ds_read_b128 a[24:27], v21 offset:38912
    ds_read_b64_tr_b16 v[144:145], v33 offset:57344
    v_mfma_f32_16x16x32_bf16 v[92:95], a[84:87], v[164:167], v[92:95]
    ds_read_b64_tr_b16 v[146:147], v33 offset:57856
    ds_read_b64_tr_b16 v[148:149], v33 offset:58368
    v_mfma_f32_16x16x32_bf16 v[96:99], a[84:87], v[168:171], v[96:99]
    ds_read_b64_tr_b16 v[150:151], v33 offset:58880
    ds_read_b64_tr_b16 v[152:153], v36 offset:57344
    v_mfma_f32_16x16x32_bf16 v[100:103], a[84:87], v[172:175], v[100:103]
    buffer_load_dwordx4 v14, s[28:31], s60 offen offset:1024 lds
    ds_read_b64_tr_b16 v[154:155], v36 offset:57856
    v_mfma_f32_16x16x32_bf16 v[104:107], a[148:151], v[160:163], v[104:107]
    ds_read_b64_tr_b16 v[156:157], v36 offset:58368
    ds_read_b64_tr_b16 v[158:159], v36 offset:58880
    v_mfma_f32_16x16x32_bf16 v[108:111], a[148:151], v[164:167], v[108:111]
    ds_read_b128 a[88:91], v21 offset:39936
    ds_read_b128 a[152:155], v21 offset:43008
    v_mfma_f32_16x16x32_bf16 v[112:115], a[148:151], v[168:171], v[112:115]
    ds_read_b128 a[216:219], v21 offset:44032
    v_mfma_f32_16x16x32_bf16 v[116:119], a[148:151], v[172:175], v[116:119]
    buffer_load_dwordx4 v15, s[28:31], s60 offen offset:2048 lds
    v_mfma_f32_16x16x32_bf16 v[120:123], a[212:215], v[160:163], v[120:123]
    v_mfma_f32_16x16x32_bf16 v[124:127], a[212:215], v[164:167], v[124:127]
    v_mfma_f32_16x16x32_bf16 v[128:131], a[212:215], v[168:171], v[128:131]
    v_mfma_f32_16x16x32_bf16 v[132:135], a[212:215], v[172:175], v[132:135]
    buffer_load_dwordx4 v15, s[28:31], s60 offen offset:3072 lds
    s_waitcnt lgkmcnt(11)
    s_waitcnt lgkmcnt(9)
    v_mfma_f32_16x16x32_bf16 v[72:75], a[24:27], v[144:147], v[72:75]
    ds_read_b128 a[28:31], v24 offset:38912
    s_waitcnt lgkmcnt(8)
    v_mfma_f32_16x16x32_bf16 v[76:79], a[24:27], v[148:151], v[76:79]
    ds_read_b64_tr_b16 v[160:161], v34 offset:0
    s_waitcnt lgkmcnt(7)
    v_mfma_f32_16x16x32_bf16 v[80:83], a[24:27], v[152:155], v[80:83]
    ds_read_b64_tr_b16 v[162:163], v34 offset:512
    s_waitcnt lgkmcnt(6)
    v_mfma_f32_16x16x32_bf16 v[84:87], a[24:27], v[156:159], v[84:87]
    s_add_u32 s17, s16, 6
    s_and_b32 s17, s17, 7
    s_add_u32 m0, s57, 69632
    s_lshl_b32 s60, s17, 7
    s_add_u32 s60, s60, s54
    buffer_load_dwordx4 v10, s[24:27], s60 offen offset:0 lds
    s_waitcnt lgkmcnt(5)
    v_mfma_f32_16x16x32_bf16 v[88:91], a[88:91], v[144:147], v[88:91]
    ds_read_b64_tr_b16 v[164:165], v34 offset:1024
    v_mfma_f32_16x16x32_bf16 v[92:95], a[88:91], v[148:151], v[92:95]
    ds_read_b64_tr_b16 v[166:167], v34 offset:1536
    v_mfma_f32_16x16x32_bf16 v[96:99], a[88:91], v[152:155], v[96:99]
    ds_read_b64_tr_b16 v[168:169], v37 offset:0
    v_mfma_f32_16x16x32_bf16 v[100:103], a[88:91], v[156:159], v[100:103]
    buffer_load_dwordx4 v10, s[24:27], s60 offen offset:1024 lds
    s_waitcnt lgkmcnt(7)
    v_mfma_f32_16x16x32_bf16 v[104:107], a[152:155], v[144:147], v[104:107]
    ds_read_b64_tr_b16 v[170:171], v37 offset:512
    v_mfma_f32_16x16x32_bf16 v[108:111], a[152:155], v[148:151], v[108:111]
    ds_read_b64_tr_b16 v[172:173], v37 offset:1024
    v_mfma_f32_16x16x32_bf16 v[112:115], a[152:155], v[152:155], v[112:115]
    ds_read_b64_tr_b16 v[174:175], v37 offset:1536
    v_mfma_f32_16x16x32_bf16 v[116:119], a[152:155], v[156:159], v[116:119]
    buffer_load_dwordx4 v11, s[24:27], s60 offen offset:2048 lds
    s_waitcnt lgkmcnt(9)
    v_mfma_f32_16x16x32_bf16 v[120:123], a[216:219], v[144:147], v[120:123]
    ds_read_b128 a[92:95], v24 offset:39936
    v_mfma_f32_16x16x32_bf16 v[124:127], a[216:219], v[148:151], v[124:127]
    ds_read_b128 a[156:159], v24 offset:43008
    v_mfma_f32_16x16x32_bf16 v[128:131], a[216:219], v[152:155], v[128:131]
    ds_read_b128 a[220:223], v24 offset:44032
    v_mfma_f32_16x16x32_bf16 v[132:135], a[216:219], v[156:159], v[132:135]
    buffer_load_dwordx4 v11, s[24:27], s60 offen offset:3072 lds
    s_waitcnt lgkmcnt(11)
    s_waitcnt lgkmcnt(9)
    v_mfma_f32_16x16x32_bf16 v[72:75], a[28:31], v[160:163], v[72:75]
    s_waitcnt lgkmcnt(7)
    v_mfma_f32_16x16x32_bf16 v[76:79], a[28:31], v[164:167], v[76:79]
    s_add_u32 m0, s57, 88064
    s_mul_i32 s60, s17, 196608
    s_add_u32 s60, s60, s66
    buffer_load_dwordx4 v14, s[28:31], s60 offen offset:0 lds
    s_waitcnt lgkmcnt(5)
    v_mfma_f32_16x16x32_bf16 v[80:83], a[28:31], v[168:171], v[80:83]
    s_waitcnt lgkmcnt(3)
    v_mfma_f32_16x16x32_bf16 v[84:87], a[28:31], v[172:175], v[84:87]
    s_waitcnt lgkmcnt(0)
    s_waitcnt vmcnt(13)
    s_barrier
    v_mfma_f32_16x16x32_bf16 v[88:91], a[92:95], v[160:163], v[88:91]
    ds_read_b128 a[32:35], v20 offset:0
    ds_read_b64_tr_b16 v[144:145], v32 offset:18432
    v_mfma_f32_16x16x32_bf16 v[92:95], a[92:95], v[164:167], v[92:95]
    ds_read_b64_tr_b16 v[146:147], v32 offset:18944
    ds_read_b64_tr_b16 v[148:149], v32 offset:19456
    v_mfma_f32_16x16x32_bf16 v[96:99], a[92:95], v[168:171], v[96:99]
    ds_read_b64_tr_b16 v[150:151], v32 offset:19968
    ds_read_b64_tr_b16 v[152:153], v35 offset:18432
    v_mfma_f32_16x16x32_bf16 v[100:103], a[92:95], v[172:175], v[100:103]
    buffer_load_dwordx4 v14, s[28:31], s60 offen offset:1024 lds
    ds_read_b64_tr_b16 v[154:155], v35 offset:18944
    v_mfma_f32_16x16x32_bf16 v[104:107], a[156:159], v[160:163], v[104:107]
    ds_read_b64_tr_b16 v[156:157], v35 offset:19456
    ds_read_b64_tr_b16 v[158:159], v35 offset:19968
    v_mfma_f32_16x16x32_bf16 v[108:111], a[156:159], v[164:167], v[108:111]
    ds_read_b128 a[96:99], v20 offset:1024
    ds_read_b128 a[160:163], v20 offset:4096
    v_mfma_f32_16x16x32_bf16 v[112:115], a[156:159], v[168:171], v[112:115]
    ds_read_b128 a[224:227], v20 offset:5120
    v_mfma_f32_16x16x32_bf16 v[116:119], a[156:159], v[172:175], v[116:119]
    buffer_load_dwordx4 v15, s[28:31], s60 offen offset:2048 lds
    v_mfma_f32_16x16x32_bf16 v[120:123], a[220:223], v[160:163], v[120:123]
    v_mfma_f32_16x16x32_bf16 v[124:127], a[220:223], v[164:167], v[124:127]
    v_mfma_f32_16x16x32_bf16 v[128:131], a[220:223], v[168:171], v[128:131]
    v_mfma_f32_16x16x32_bf16 v[132:135], a[220:223], v[172:175], v[132:135]
    buffer_load_dwordx4 v15, s[28:31], s60 offen offset:3072 lds
    s_waitcnt lgkmcnt(11)
    s_waitcnt lgkmcnt(9)
    v_mfma_f32_16x16x32_bf16 v[72:75], a[32:35], v[144:147], v[72:75]
    ds_read_b128 a[36:39], v23 offset:0
    s_waitcnt lgkmcnt(8)
    v_mfma_f32_16x16x32_bf16 v[76:79], a[32:35], v[148:151], v[76:79]
    ds_read_b64_tr_b16 v[160:161], v32 offset:26624
    s_waitcnt lgkmcnt(7)
    v_mfma_f32_16x16x32_bf16 v[80:83], a[32:35], v[152:155], v[80:83]
    ds_read_b64_tr_b16 v[162:163], v32 offset:27136
    s_waitcnt lgkmcnt(6)
    v_mfma_f32_16x16x32_bf16 v[84:87], a[32:35], v[156:159], v[84:87]
    s_add_u32 s17, s16, 7
    s_and_b32 s17, s17, 7
    s_add_u32 m0, s57, 104448
    s_lshl_b32 s60, s17, 7
    s_add_u32 s60, s60, s54
    buffer_load_dwordx4 v10, s[24:27], s60 offen offset:0 lds
    s_waitcnt lgkmcnt(5)
    v_mfma_f32_16x16x32_bf16 v[88:91], a[96:99], v[144:147], v[88:91]
    ds_read_b64_tr_b16 v[164:165], v32 offset:27648
    v_mfma_f32_16x16x32_bf16 v[92:95], a[96:99], v[148:151], v[92:95]
    ds_read_b64_tr_b16 v[166:167], v32 offset:28160
    v_mfma_f32_16x16x32_bf16 v[96:99], a[96:99], v[152:155], v[96:99]
    ds_read_b64_tr_b16 v[168:169], v35 offset:26624
    v_mfma_f32_16x16x32_bf16 v[100:103], a[96:99], v[156:159], v[100:103]
    buffer_load_dwordx4 v10, s[24:27], s60 offen offset:1024 lds
    s_waitcnt lgkmcnt(7)
    v_mfma_f32_16x16x32_bf16 v[104:107], a[160:163], v[144:147], v[104:107]
    ds_read_b64_tr_b16 v[170:171], v35 offset:27136
    v_mfma_f32_16x16x32_bf16 v[108:111], a[160:163], v[148:151], v[108:111]
    ds_read_b64_tr_b16 v[172:173], v35 offset:27648
    v_mfma_f32_16x16x32_bf16 v[112:115], a[160:163], v[152:155], v[112:115]
    ds_read_b64_tr_b16 v[174:175], v35 offset:28160
    v_mfma_f32_16x16x32_bf16 v[116:119], a[160:163], v[156:159], v[116:119]
    buffer_load_dwordx4 v11, s[24:27], s60 offen offset:2048 lds
    s_waitcnt lgkmcnt(9)
    v_mfma_f32_16x16x32_bf16 v[120:123], a[224:227], v[144:147], v[120:123]
    ds_read_b128 a[100:103], v23 offset:1024
    v_mfma_f32_16x16x32_bf16 v[124:127], a[224:227], v[148:151], v[124:127]
    ds_read_b128 a[164:167], v23 offset:4096
    v_mfma_f32_16x16x32_bf16 v[128:131], a[224:227], v[152:155], v[128:131]
    ds_read_b128 a[228:231], v23 offset:5120
    v_mfma_f32_16x16x32_bf16 v[132:135], a[224:227], v[156:159], v[132:135]
    buffer_load_dwordx4 v11, s[24:27], s60 offen offset:3072 lds
    s_waitcnt lgkmcnt(11)
    s_waitcnt lgkmcnt(9)
    v_mfma_f32_16x16x32_bf16 v[72:75], a[36:39], v[160:163], v[72:75]
    s_waitcnt lgkmcnt(7)
    v_mfma_f32_16x16x32_bf16 v[76:79], a[36:39], v[164:167], v[76:79]
    s_add_u32 m0, s57, 122880
    s_mul_i32 s60, s17, 196608
    s_add_u32 s60, s60, s66
    buffer_load_dwordx4 v14, s[28:31], s60 offen offset:0 lds
    s_waitcnt lgkmcnt(5)
    v_mfma_f32_16x16x32_bf16 v[80:83], a[36:39], v[168:171], v[80:83]
    s_waitcnt lgkmcnt(3)
    v_mfma_f32_16x16x32_bf16 v[84:87], a[36:39], v[172:175], v[84:87]
    s_waitcnt lgkmcnt(0)
    s_waitcnt vmcnt(13)
    s_barrier
    v_mfma_f32_16x16x32_bf16 v[88:91], a[100:103], v[160:163], v[88:91]
    ds_read_b128 a[40:43], v20 offset:34816
    ds_read_b64_tr_b16 v[144:145], v32 offset:53248
    v_mfma_f32_16x16x32_bf16 v[92:95], a[100:103], v[164:167], v[92:95]
    ds_read_b64_tr_b16 v[146:147], v32 offset:53760
    ds_read_b64_tr_b16 v[148:149], v32 offset:54272
    v_mfma_f32_16x16x32_bf16 v[96:99], a[100:103], v[168:171], v[96:99]
    ds_read_b64_tr_b16 v[150:151], v32 offset:54784
    ds_read_b64_tr_b16 v[152:153], v35 offset:53248
    v_mfma_f32_16x16x32_bf16 v[100:103], a[100:103], v[172:175], v[100:103]
    buffer_load_dwordx4 v14, s[28:31], s60 offen offset:1024 lds
    ds_read_b64_tr_b16 v[154:155], v35 offset:53760
    v_mfma_f32_16x16x32_bf16 v[104:107], a[164:167], v[160:163], v[104:107]
    ds_read_b64_tr_b16 v[156:157], v35 offset:54272
    ds_read_b64_tr_b16 v[158:159], v35 offset:54784
    v_mfma_f32_16x16x32_bf16 v[108:111], a[164:167], v[164:167], v[108:111]
    ds_read_b128 a[104:107], v20 offset:35840
    ds_read_b128 a[168:171], v20 offset:38912
    v_mfma_f32_16x16x32_bf16 v[112:115], a[164:167], v[168:171], v[112:115]
    ds_read_b128 a[232:235], v20 offset:39936
    v_mfma_f32_16x16x32_bf16 v[116:119], a[164:167], v[172:175], v[116:119]
    buffer_load_dwordx4 v15, s[28:31], s60 offen offset:2048 lds
    v_mfma_f32_16x16x32_bf16 v[120:123], a[228:231], v[160:163], v[120:123]
    v_mfma_f32_16x16x32_bf16 v[124:127], a[228:231], v[164:167], v[124:127]
    v_mfma_f32_16x16x32_bf16 v[128:131], a[228:231], v[168:171], v[128:131]
    v_mfma_f32_16x16x32_bf16 v[132:135], a[228:231], v[172:175], v[132:135]
    buffer_load_dwordx4 v15, s[28:31], s60 offen offset:3072 lds
    s_waitcnt lgkmcnt(11)
    s_waitcnt lgkmcnt(9)
    v_mfma_f32_16x16x32_bf16 v[72:75], a[40:43], v[144:147], v[72:75]
    ds_read_b128 a[44:47], v23 offset:34816
    s_waitcnt lgkmcnt(8)
    v_mfma_f32_16x16x32_bf16 v[76:79], a[40:43], v[148:151], v[76:79]
    ds_read_b64_tr_b16 v[160:161], v32 offset:61440
    s_waitcnt lgkmcnt(7)
    v_mfma_f32_16x16x32_bf16 v[80:83], a[40:43], v[152:155], v[80:83]
    ds_read_b64_tr_b16 v[162:163], v32 offset:61952
    s_waitcnt lgkmcnt(6)
    v_mfma_f32_16x16x32_bf16 v[84:87], a[40:43], v[156:159], v[84:87]
    s_add_u32 s17, s16, 0
    s_and_b32 s17, s17, 7
    s_add_u32 m0, s57, 0
    s_mul_i32 s60, s17, 196608
    s_add_u32 s60, s60, s56
    buffer_load_dwordx4 v14, s[28:31], s60 offen offset:0 lds
    s_waitcnt lgkmcnt(5)
    v_mfma_f32_16x16x32_bf16 v[88:91], a[104:107], v[144:147], v[88:91]
    ds_read_b64_tr_b16 v[164:165], v32 offset:62464
    v_mfma_f32_16x16x32_bf16 v[92:95], a[104:107], v[148:151], v[92:95]
    ds_read_b64_tr_b16 v[166:167], v32 offset:62976
    v_mfma_f32_16x16x32_bf16 v[96:99], a[104:107], v[152:155], v[96:99]
    ds_read_b64_tr_b16 v[168:169], v35 offset:61440
    v_mfma_f32_16x16x32_bf16 v[100:103], a[104:107], v[156:159], v[100:103]
    buffer_load_dwordx4 v15, s[28:31], s60 offen offset:2048 lds
    s_waitcnt lgkmcnt(7)
    v_mfma_f32_16x16x32_bf16 v[104:107], a[168:171], v[144:147], v[104:107]
    ds_read_b64_tr_b16 v[170:171], v35 offset:61952
    v_mfma_f32_16x16x32_bf16 v[108:111], a[168:171], v[148:151], v[108:111]
    ds_read_b64_tr_b16 v[172:173], v35 offset:62464
    v_mfma_f32_16x16x32_bf16 v[112:115], a[168:171], v[152:155], v[112:115]
    ds_read_b64_tr_b16 v[174:175], v35 offset:62976
    v_mfma_f32_16x16x32_bf16 v[116:119], a[168:171], v[156:159], v[116:119]
    s_add_u32 s17, s16, 1
    s_and_b32 s17, s17, 7
    s_add_u32 m0, s57, 1024
    s_mul_i32 s60, s17, 196608
    s_add_u32 s60, s60, s56
    buffer_load_dwordx4 v14, s[28:31], s60 offen offset:0 lds
    s_waitcnt lgkmcnt(9)
    v_mfma_f32_16x16x32_bf16 v[120:123], a[232:235], v[144:147], v[120:123]
    ds_read_b128 a[108:111], v23 offset:35840
    v_mfma_f32_16x16x32_bf16 v[124:127], a[232:235], v[148:151], v[124:127]
    ds_read_b128 a[172:175], v23 offset:38912
    v_mfma_f32_16x16x32_bf16 v[128:131], a[232:235], v[152:155], v[128:131]
    ds_read_b128 a[236:239], v23 offset:39936
    v_mfma_f32_16x16x32_bf16 v[132:135], a[232:235], v[156:159], v[132:135]
    buffer_load_dwordx4 v15, s[28:31], s60 offen offset:2048 lds
    s_waitcnt lgkmcnt(11)
    s_waitcnt lgkmcnt(9)
    v_mfma_f32_16x16x32_bf16 v[72:75], a[44:47], v[160:163], v[72:75]
    s_waitcnt lgkmcnt(7)
    v_mfma_f32_16x16x32_bf16 v[76:79], a[44:47], v[164:167], v[76:79]
    s_add_u32 s17, s16, 2
    s_and_b32 s17, s17, 7
    s_add_u32 m0, s57, 16384
    s_mul_i32 s60, s17, 196608
    s_add_u32 s60, s60, s56
    buffer_load_dwordx4 v14, s[28:31], s60 offen offset:0 lds
    s_waitcnt lgkmcnt(5)
    v_mfma_f32_16x16x32_bf16 v[80:83], a[44:47], v[168:171], v[80:83]
    s_waitcnt lgkmcnt(3)
    v_mfma_f32_16x16x32_bf16 v[84:87], a[44:47], v[172:175], v[84:87]
    s_waitcnt lgkmcnt(0)
    s_waitcnt vmcnt(13)
    s_barrier
    v_mfma_f32_16x16x32_bf16 v[88:91], a[108:111], v[160:163], v[88:91]
    ds_read_b128 a[48:51], v21 offset:4096
    ds_read_b64_tr_b16 v[144:145], v33 offset:22528
    v_mfma_f32_16x16x32_bf16 v[92:95], a[108:111], v[164:167], v[92:95]
    ds_read_b64_tr_b16 v[146:147], v33 offset:23040
    ds_read_b64_tr_b16 v[148:149], v33 offset:23552
    v_mfma_f32_16x16x32_bf16 v[96:99], a[108:111], v[168:171], v[96:99]
    ds_read_b64_tr_b16 v[150:151], v33 offset:24064
    ds_read_b64_tr_b16 v[152:153], v36 offset:22528
    v_mfma_f32_16x16x32_bf16 v[100:103], a[108:111], v[172:175], v[100:103]
    buffer_load_dwordx4 v15, s[28:31], s60 offen offset:2048 lds
    ds_read_b64_tr_b16 v[154:155], v36 offset:23040
    v_mfma_f32_16x16x32_bf16 v[104:107], a[172:175], v[160:163], v[104:107]
    ds_read_b64_tr_b16 v[156:157], v36 offset:23552
    ds_read_b64_tr_b16 v[158:159], v36 offset:24064
    v_mfma_f32_16x16x32_bf16 v[108:111], a[172:175], v[164:167], v[108:111]
    ds_read_b128 a[112:115], v21 offset:5120
    ds_read_b128 a[176:179], v21 offset:8192
    v_mfma_f32_16x16x32_bf16 v[112:115], a[172:175], v[168:171], v[112:115]
    ds_read_b128 a[240:243], v21 offset:9216
    v_mfma_f32_16x16x32_bf16 v[116:119], a[172:175], v[172:175], v[116:119]
    s_add_u32 s17, s16, 3
    s_and_b32 s17, s17, 7
    s_add_u32 m0, s57, 17408
    s_mul_i32 s60, s17, 196608
    s_add_u32 s60, s60, s56
    buffer_load_dwordx4 v14, s[28:31], s60 offen offset:0 lds
    v_mfma_f32_16x16x32_bf16 v[120:123], a[236:239], v[160:163], v[120:123]
    v_mfma_f32_16x16x32_bf16 v[124:127], a[236:239], v[164:167], v[124:127]
    v_mfma_f32_16x16x32_bf16 v[128:131], a[236:239], v[168:171], v[128:131]
    v_mfma_f32_16x16x32_bf16 v[132:135], a[236:239], v[172:175], v[132:135]
    buffer_load_dwordx4 v15, s[28:31], s60 offen offset:2048 lds
    s_waitcnt lgkmcnt(11)
    s_waitcnt lgkmcnt(9)
    v_mfma_f32_16x16x32_bf16 v[72:75], a[48:51], v[144:147], v[72:75]
    ds_read_b128 a[52:55], v24 offset:4096
    s_waitcnt lgkmcnt(8)
    v_mfma_f32_16x16x32_bf16 v[76:79], a[48:51], v[148:151], v[76:79]
    ds_read_b64_tr_b16 v[160:161], v33 offset:30720
    s_waitcnt lgkmcnt(7)
    v_mfma_f32_16x16x32_bf16 v[80:83], a[48:51], v[152:155], v[80:83]
    ds_read_b64_tr_b16 v[162:163], v33 offset:31232
    s_waitcnt lgkmcnt(6)
    v_mfma_f32_16x16x32_bf16 v[84:87], a[48:51], v[156:159], v[84:87]
    s_add_u32 s17, s16, 4
    s_and_b32 s17, s17, 7
    s_add_u32 m0, s57, 34816
    s_mul_i32 s60, s17, 196608
    s_add_u32 s60, s60, s56
    buffer_load_dwordx4 v14, s[28:31], s60 offen offset:0 lds
    s_waitcnt lgkmcnt(5)
    v_mfma_f32_16x16x32_bf16 v[88:91], a[112:115], v[144:147], v[88:91]
    ds_read_b64_tr_b16 v[164:165], v33 offset:31744
    v_mfma_f32_16x16x32_bf16 v[92:95], a[112:115], v[148:151], v[92:95]
    ds_read_b64_tr_b16 v[166:167], v33 offset:32256
    v_mfma_f32_16x16x32_bf16 v[96:99], a[112:115], v[152:155], v[96:99]
    ds_read_b64_tr_b16 v[168:169], v36 offset:30720
    v_mfma_f32_16x16x32_bf16 v[100:103], a[112:115], v[156:159], v[100:103]
    buffer_load_dwordx4 v15, s[28:31], s60 offen offset:2048 lds
    s_waitcnt lgkmcnt(7)
    v_mfma_f32_16x16x32_bf16 v[104:107], a[176:179], v[144:147], v[104:107]
    ds_read_b64_tr_b16 v[170:171], v36 offset:31232
    v_mfma_f32_16x16x32_bf16 v[108:111], a[176:179], v[148:151], v[108:111]
    ds_read_b64_tr_b16 v[172:173], v36 offset:31744
    v_mfma_f32_16x16x32_bf16 v[112:115], a[176:179], v[152:155], v[112:115]
    ds_read_b64_tr_b16 v[174:175], v36 offset:32256
    v_mfma_f32_16x16x32_bf16 v[116:119], a[176:179], v[156:159], v[116:119]
    s_add_u32 s17, s16, 5
    s_and_b32 s17, s17, 7
    s_add_u32 m0, s57, 35840
    s_mul_i32 s60, s17, 196608
    s_add_u32 s60, s60, s56
    buffer_load_dwordx4 v14, s[28:31], s60 offen offset:0 lds
    s_waitcnt lgkmcnt(9)
    v_mfma_f32_16x16x32_bf16 v[120:123], a[240:243], v[144:147], v[120:123]
    ds_read_b128 a[116:119], v24 offset:5120
    v_mfma_f32_16x16x32_bf16 v[124:127], a[240:243], v[148:151], v[124:127]
    ds_read_b128 a[180:183], v24 offset:8192
    v_mfma_f32_16x16x32_bf16 v[128:131], a[240:243], v[152:155], v[128:131]
    ds_read_b128 a[244:247], v24 offset:9216
    v_mfma_f32_16x16x32_bf16 v[132:135], a[240:243], v[156:159], v[132:135]
    buffer_load_dwordx4 v15, s[28:31], s60 offen offset:2048 lds
    s_waitcnt lgkmcnt(11)
    s_waitcnt lgkmcnt(9)
    v_mfma_f32_16x16x32_bf16 v[72:75], a[52:55], v[160:163], v[72:75]
    s_waitcnt lgkmcnt(7)
    v_mfma_f32_16x16x32_bf16 v[76:79], a[52:55], v[164:167], v[76:79]
    s_add_u32 s17, s16, 6
    s_and_b32 s17, s17, 7
    s_add_u32 m0, s57, 51200
    s_mul_i32 s60, s17, 196608
    s_add_u32 s60, s60, s56
    buffer_load_dwordx4 v14, s[28:31], s60 offen offset:0 lds
    s_waitcnt lgkmcnt(5)
    v_mfma_f32_16x16x32_bf16 v[80:83], a[52:55], v[168:171], v[80:83]
    s_waitcnt lgkmcnt(3)
    v_mfma_f32_16x16x32_bf16 v[84:87], a[52:55], v[172:175], v[84:87]
    s_waitcnt lgkmcnt(0)
    s_waitcnt vmcnt(13)
    s_barrier
    v_mfma_f32_16x16x32_bf16 v[88:91], a[116:119], v[160:163], v[88:91]
    ds_read_b128 a[56:59], v21 offset:38912
    ds_read_b64_tr_b16 v[144:145], v33 offset:57344
    v_mfma_f32_16x16x32_bf16 v[92:95], a[116:119], v[164:167], v[92:95]
    ds_read_b64_tr_b16 v[146:147], v33 offset:57856
    ds_read_b64_tr_b16 v[148:149], v33 offset:58368
    v_mfma_f32_16x16x32_bf16 v[96:99], a[116:119], v[168:171], v[96:99]
    ds_read_b64_tr_b16 v[150:151], v33 offset:58880
    ds_read_b64_tr_b16 v[152:153], v36 offset:57344
    v_mfma_f32_16x16x32_bf16 v[100:103], a[116:119], v[172:175], v[100:103]
    buffer_load_dwordx4 v15, s[28:31], s60 offen offset:2048 lds
    ds_read_b64_tr_b16 v[154:155], v36 offset:57856
    v_mfma_f32_16x16x32_bf16 v[104:107], a[180:183], v[160:163], v[104:107]
    ds_read_b64_tr_b16 v[156:157], v36 offset:58368
    ds_read_b64_tr_b16 v[158:159], v36 offset:58880
    v_mfma_f32_16x16x32_bf16 v[108:111], a[180:183], v[164:167], v[108:111]
    ds_read_b128 a[120:123], v21 offset:39936
    ds_read_b128 a[184:187], v21 offset:43008
    v_mfma_f32_16x16x32_bf16 v[112:115], a[180:183], v[168:171], v[112:115]
    ds_read_b128 a[248:251], v21 offset:44032
    v_mfma_f32_16x16x32_bf16 v[116:119], a[180:183], v[172:175], v[116:119]
    s_add_u32 s17, s16, 7
    s_and_b32 s17, s17, 7
    s_add_u32 m0, s57, 52224
    s_mul_i32 s60, s17, 196608
    s_add_u32 s60, s60, s56
    buffer_load_dwordx4 v14, s[28:31], s60 offen offset:0 lds
    v_mfma_f32_16x16x32_bf16 v[120:123], a[244:247], v[160:163], v[120:123]
    v_mfma_f32_16x16x32_bf16 v[124:127], a[244:247], v[164:167], v[124:127]
    v_mfma_f32_16x16x32_bf16 v[128:131], a[244:247], v[168:171], v[128:131]
    v_mfma_f32_16x16x32_bf16 v[132:135], a[244:247], v[172:175], v[132:135]
    buffer_load_dwordx4 v15, s[28:31], s60 offen offset:2048 lds
    s_waitcnt lgkmcnt(11)
    s_waitcnt lgkmcnt(9)
    v_mfma_f32_16x16x32_bf16 v[72:75], a[56:59], v[144:147], v[72:75]
    ds_read_b128 a[60:63], v24 offset:38912
    s_waitcnt lgkmcnt(8)
    v_mfma_f32_16x16x32_bf16 v[76:79], a[56:59], v[148:151], v[76:79]
    ds_read_b64_tr_b16 v[160:161], v34 offset:0
    s_waitcnt lgkmcnt(7)
    v_mfma_f32_16x16x32_bf16 v[80:83], a[56:59], v[152:155], v[80:83]
    ds_read_b64_tr_b16 v[162:163], v34 offset:512
    s_waitcnt lgkmcnt(6)
    v_mfma_f32_16x16x32_bf16 v[84:87], a[56:59], v[156:159], v[84:87]
    s_add_u32 m0, s7, 67584
    s_add_u32 s60, s65, 0
    buffer_load_dwordx4 v12, s[40:43], s60 offen offset:0 lds
    s_waitcnt lgkmcnt(5)
    v_mfma_f32_16x16x32_bf16 v[88:91], a[120:123], v[144:147], v[88:91]
    ds_read_b64_tr_b16 v[164:165], v34 offset:1024
    v_mfma_f32_16x16x32_bf16 v[92:95], a[120:123], v[148:151], v[92:95]
    ds_read_b64_tr_b16 v[166:167], v34 offset:1536
    v_mfma_f32_16x16x32_bf16 v[96:99], a[120:123], v[152:155], v[96:99]
    ds_read_b64_tr_b16 v[168:169], v37 offset:0
    v_mfma_f32_16x16x32_bf16 v[100:103], a[120:123], v[156:159], v[100:103]
    buffer_load_dwordx4 v13, s[40:43], s60 offen offset:1024 lds
    s_waitcnt lgkmcnt(7)
    v_mfma_f32_16x16x32_bf16 v[104:107], a[184:187], v[144:147], v[104:107]
    ds_read_b64_tr_b16 v[170:171], v37 offset:512
    v_mfma_f32_16x16x32_bf16 v[108:111], a[184:187], v[148:151], v[108:111]
    ds_read_b64_tr_b16 v[172:173], v37 offset:1024
    v_mfma_f32_16x16x32_bf16 v[112:115], a[184:187], v[152:155], v[112:115]
    ds_read_b64_tr_b16 v[174:175], v37 offset:1536
    v_mfma_f32_16x16x32_bf16 v[116:119], a[184:187], v[156:159], v[116:119]
    buffer_load_dwordx4 v16, s[40:43], s60 offen offset:2048 lds
    s_waitcnt lgkmcnt(9)
    v_mfma_f32_16x16x32_bf16 v[120:123], a[248:251], v[144:147], v[120:123]
    ds_read_b128 a[124:127], v24 offset:39936
    v_mfma_f32_16x16x32_bf16 v[124:127], a[248:251], v[148:151], v[124:127]
    ds_read_b128 a[188:191], v24 offset:43008
    v_mfma_f32_16x16x32_bf16 v[128:131], a[248:251], v[152:155], v[128:131]
    ds_read_b128 a[252:255], v24 offset:44032
    v_mfma_f32_16x16x32_bf16 v[132:135], a[248:251], v[156:159], v[132:135]
    buffer_load_dwordx4 v17, s[40:43], s60 offen offset:3072 lds
    s_waitcnt lgkmcnt(11)
    s_waitcnt lgkmcnt(9)
    v_mfma_f32_16x16x32_bf16 v[72:75], a[60:63], v[160:163], v[72:75]
    s_waitcnt lgkmcnt(7)
    v_mfma_f32_16x16x32_bf16 v[76:79], a[60:63], v[164:167], v[76:79]
    s_add_u32 m0, s7, 71680
    s_add_u32 s60, s65, 16384
    buffer_load_dwordx4 v12, s[40:43], s60 offen offset:0 lds
    s_waitcnt lgkmcnt(5)
    v_mfma_f32_16x16x32_bf16 v[80:83], a[60:63], v[168:171], v[80:83]
    s_waitcnt lgkmcnt(3)
    v_mfma_f32_16x16x32_bf16 v[84:87], a[60:63], v[172:175], v[84:87]
    s_waitcnt lgkmcnt(0)
    s_waitcnt vmcnt(13)
    s_barrier
    v_mfma_f32_16x16x32_bf16 v[88:91], a[124:127], v[160:163], v[88:91]
    ds_read_b64_tr_b16 v[144:145], v32 offset:0
    ds_read_b64_tr_b16 v[146:147], v32 offset:512
    v_mfma_f32_16x16x32_bf16 v[92:95], a[124:127], v[164:167], v[92:95]
    ds_read_b64_tr_b16 v[148:149], v32 offset:8192
    ds_read_b64_tr_b16 v[150:151], v32 offset:8704
    v_mfma_f32_16x16x32_bf16 v[96:99], a[124:127], v[168:171], v[96:99]
    ds_read_b64_tr_b16 v[152:153], v32 offset:1024
    ds_read_b64_tr_b16 v[154:155], v32 offset:1536
    v_mfma_f32_16x16x32_bf16 v[100:103], a[124:127], v[172:175], v[100:103]
    buffer_load_dwordx4 v13, s[40:43], s60 offen offset:1024 lds
    v_mfma_f32_16x16x32_bf16 v[104:107], a[188:191], v[160:163], v[104:107]
    v_mfma_f32_16x16x32_bf16 v[108:111], a[188:191], v[164:167], v[108:111]
    v_mfma_f32_16x16x32_bf16 v[112:115], a[188:191], v[168:171], v[112:115]
    v_mfma_f32_16x16x32_bf16 v[116:119], a[188:191], v[172:175], v[116:119]
    buffer_load_dwordx4 v16, s[40:43], s60 offen offset:2048 lds
    v_mfma_f32_16x16x32_bf16 v[120:123], a[252:255], v[160:163], v[120:123]
    v_mfma_f32_16x16x32_bf16 v[124:127], a[252:255], v[164:167], v[124:127]
    v_mfma_f32_16x16x32_bf16 v[128:131], a[252:255], v[168:171], v[128:131]
    v_mfma_f32_16x16x32_bf16 v[132:135], a[252:255], v[172:175], v[132:135]
    buffer_load_dwordx4 v17, s[40:43], s60 offen offset:3072 lds
L_q_11:
    s_waitcnt lgkmcnt(4)
    v_mfma_f32_16x16x32_bf16 v[184:187], v[144:147], a[0:3], 0
    ds_read_b64_tr_b16 v[156:157], v32 offset:9216
    ds_read_b64_tr_b16 v[158:159], v32 offset:9728
    v_pk_mul_f32 v[200:201], v[72:73], s[18:19]
    v_pk_mul_f32 v[202:203], v[74:75], s[18:19]
    v_pk_mul_f32 v[204:205], v[88:89], s[18:19]
    v_pk_mul_f32 v[206:207], v[90:91], s[18:19]
    v_pk_mul_f32 v[208:209], v[104:105], s[18:19]
    v_pk_mul_f32 v[210:211], v[106:107], s[18:19]
    v_pk_mul_f32 v[212:213], v[120:121], s[18:19]
    v_pk_mul_f32 v[214:215], v[122:123], s[18:19]
    v_exp_f32 v200, v200 clamp
    v_max_f32 v72, s64, v72
    v_exp_f32 v201, v201 clamp
    v_max_f32 v73, s64, v73
    v_exp_f32 v202, v202 clamp
    v_max_f32 v74, s64, v74
    v_exp_f32 v203, v203 clamp
    v_max_f32 v75, s64, v75
    v_exp_f32 v204, v204 clamp
    v_max_f32 v88, s64, v88
    v_exp_f32 v205, v205 clamp
    v_max_f32 v89, s64, v89
    v_exp_f32 v206, v206 clamp
    v_max_f32 v90, s64, v90
    v_exp_f32 v207, v207 clamp
    v_max_f32 v91, s64, v91
    v_exp_f32 v208, v208 clamp
    v_max_f32 v104, s64, v104
    v_exp_f32 v209, v209 clamp
    v_max_f32 v105, s64, v105
    v_exp_f32 v210, v210 clamp
    v_max_f32 v106, s64, v106
    v_exp_f32 v211, v211 clamp
    v_max_f32 v107, s64, v107
    v_exp_f32 v212, v212 clamp
    v_max_f32 v120, s64, v120
    v_exp_f32 v213, v213 clamp
    v_max_f32 v121, s64, v121
    v_exp_f32 v214, v214 clamp
    v_max_f32 v122, s64, v122
    v_mfma_f32_16x16x32_bf16 v[188:191], v[144:147], a[64:67], 0
    v_exp_f32 v215, v215 clamp
    v_max_f32 v123, s64, v123
    v_pk_add_f32 v[72:73], v[72:73], v[200:201]
    v_pk_add_f32 v[74:75], v[74:75], v[202:203]
    v_pk_add_f32 v[88:89], v[88:89], v[204:205]
    v_pk_add_f32 v[90:91], v[90:91], v[206:207]
    v_pk_add_f32 v[104:105], v[104:105], v[208:209]
    v_pk_add_f32 v[106:107], v[106:107], v[210:211]
    v_pk_add_f32 v[120:121], v[120:121], v[212:213]
    v_pk_add_f32 v[122:123], v[122:123], v[214:215]
    v_cvt_pk_bf16_f32 v216, v72, v73
    v_cvt_pk_bf16_f32 v217, v74, v75
    v_cvt_pk_bf16_f32 v232, v76, v77
    v_cvt_pk_bf16_f32 v233, v78, v79
    v_cvt_pk_bf16_f32 v218, v88, v89
    v_cvt_pk_bf16_f32 v219, v90, v91
    v_cvt_pk_bf16_f32 v234, v92, v93
    v_cvt_pk_bf16_f32 v235, v94, v95
    v_cvt_pk_bf16_f32 v220, v104, v105
    v_cvt_pk_bf16_f32 v221, v106, v107
    v_cvt_pk_bf16_f32 v236, v108, v109
    v_cvt_pk_bf16_f32 v237, v110, v111
    v_cvt_pk_bf16_f32 v222, v120, v121
    v_cvt_pk_bf16_f32 v223, v122, v123
    v_cvt_pk_bf16_f32 v238, v124, v125
    v_cvt_pk_bf16_f32 v239, v126, v127
    v_mfma_f32_16x16x32_bf16 v[176:179], v[216:219], v[232:235], 0
    v_mfma_f32_16x16x32_bf16 v[180:183], v[216:219], v[66:69], 0
    v_mfma_f32_16x16x32_bf16 v[176:179], v[220:223], v[236:239], v[176:179]
    v_mfma_f32_16x16x32_bf16 v[180:183], v[220:223], v[66:69], v[180:183]
    v_pk_mul_f32 v[200:201], v[80:81], s[18:19]
    v_pk_mul_f32 v[202:203], v[82:83], s[18:19]
    v_pk_mul_f32 v[204:205], v[96:97], s[18:19]
    v_pk_mul_f32 v[206:207], v[98:99], s[18:19]
    v_pk_mul_f32 v[208:209], v[112:113], s[18:19]
    v_pk_mul_f32 v[210:211], v[114:115], s[18:19]
    v_pk_mul_f32 v[212:213], v[128:129], s[18:19]
    v_pk_mul_f32 v[214:215], v[130:131], s[18:19]
    v_exp_f32 v200, v200 clamp
    v_max_f32 v80, s64, v80
    v_mfma_f32_16x16x32_bf16 v[192:195], v[144:147], a[128:131], 0
    v_exp_f32 v201, v201 clamp
    v_max_f32 v81, s64, v81
    ds_write_b128 v9, v[176:179] offset:2048
    ds_write_b128 v9, v[180:183] offset:3072
    v_exp_f32 v202, v202 clamp
    v_max_f32 v82, s64, v82
    v_exp_f32 v203, v203 clamp
    v_max_f32 v83, s64, v83
    v_exp_f32 v204, v204 clamp
    v_max_f32 v96, s64, v96
    v_exp_f32 v205, v205 clamp
    v_max_f32 v97, s64, v97
    v_exp_f32 v206, v206 clamp
    v_max_f32 v98, s64, v98
    v_exp_f32 v207, v207 clamp
    v_max_f32 v99, s64, v99
    v_exp_f32 v208, v208 clamp
    v_max_f32 v112, s64, v112
    v_exp_f32 v209, v209 clamp
    v_max_f32 v113, s64, v113
    v_exp_f32 v210, v210 clamp
    v_max_f32 v114, s64, v114
    v_exp_f32 v211, v211 clamp
    v_max_f32 v115, s64, v115
    v_exp_f32 v212, v212 clamp
    v_max_f32 v128, s64, v128
    v_exp_f32 v213, v213 clamp
    v_max_f32 v129, s64, v129
    v_exp_f32 v214, v214 clamp
    v_max_f32 v130, s64, v130
    v_exp_f32 v215, v215 clamp
    v_max_f32 v131, s64, v131
    v_pk_add_f32 v[80:81], v[80:81], v[200:201]
    v_pk_add_f32 v[82:83], v[82:83], v[202:203]
    v_pk_add_f32 v[96:97], v[96:97], v[204:205]
    v_pk_add_f32 v[98:99], v[98:99], v[206:207]
    v_pk_add_f32 v[112:113], v[112:113], v[208:209]
    v_pk_add_f32 v[114:115], v[114:115], v[210:211]
    v_pk_add_f32 v[128:129], v[128:129], v[212:213]
    v_pk_add_f32 v[130:131], v[130:131], v[214:215]
    v_mfma_f32_16x16x32_bf16 v[196:199], v[144:147], a[192:195], 0
    s_add_u32 m0, s7, 100352
    s_add_u32 s60, s65, 131072
    buffer_load_dwordx4 v12, s[40:43], s60 offen offset:0 lds
    v_cvt_pk_bf16_f32 v224, v80, v81
    v_cvt_pk_bf16_f32 v225, v82, v83
    v_cvt_pk_bf16_f32 v240, v84, v85
    v_cvt_pk_bf16_f32 v241, v86, v87
    v_cvt_pk_bf16_f32 v226, v96, v97
    v_cvt_pk_bf16_f32 v227, v98, v99
    v_cvt_pk_bf16_f32 v242, v100, v101
    v_cvt_pk_bf16_f32 v243, v102, v103
    v_cvt_pk_bf16_f32 v228, v112, v113
    v_cvt_pk_bf16_f32 v229, v114, v115
    v_cvt_pk_bf16_f32 v244, v116, v117
    v_cvt_pk_bf16_f32 v245, v118, v119
    v_cvt_pk_bf16_f32 v230, v128, v129
    v_cvt_pk_bf16_f32 v231, v130, v131
    v_cvt_pk_bf16_f32 v246, v132, v133
    v_cvt_pk_bf16_f32 v247, v134, v135
    v_mfma_f32_16x16x32_bf16 v[136:139], v[224:227], v[240:243], 0
    v_mfma_f32_16x16x32_bf16 v[140:143], v[224:227], v[66:69], 0
    v_mfma_f32_16x16x32_bf16 v[136:139], v[228:231], v[244:247], v[136:139]
    v_mfma_f32_16x16x32_bf16 v[140:143], v[228:231], v[66:69], v[140:143]
    s_waitcnt lgkmcnt(0)
    s_barrier
    v_mfma_f32_16x16x32_bf16 v[184:187], v[148:151], a[4:7], v[184:187]
    ds_read_b64_tr_b16 v[160:161], v32 offset:16384
    ds_read_b64_tr_b16 v[162:163], v32 offset:16896
    ds_read_b128 v[72:75], v9 offset:0
    ds_read_b128 v[76:79], v9 offset:1024
    s_add_u32 s15, s38, 1
    s_and_b32 s15, s15, 0x7f
    s_or_b32 s15, s15, 0x80
    v_mov_b32 v4, s15
    v_mov_b32 v5, 0xff
    v_lshrrev_b32 v3, 4, v1
    v_lshlrev_b32 v3, 4, v3
    s_waitcnt lgkmcnt(0)
    v_pk_add_f32 v[136:137], v[136:137], v[72:73]
    v_pk_add_f32 v[138:139], v[138:139], v[74:75]
    v_pk_add_f32 v[140:141], v[140:141], v[76:77]
    v_pk_add_f32 v[142:143], v[142:143], v[78:79]
    v_bfi_b32 v136, v5, v4, v136
    v_bfi_b32 v137, v5, v4, v137
    v_bfi_b32 v138, v5, v4, v138
    v_bfi_b32 v139, v5, v4, v139
    v_bfi_b32 v140, v5, v4, v140
    v_bfi_b32 v141, v5, v4, v141
    v_bfi_b32 v142, v5, v4, v142
    v_bfi_b32 v143, v5, v4, v143
    buffer_store_dwordx4 v[136:139], v46, s[32:35], s5 offen sc1
    s_mov_b32 s68, 0x00010001
    s_mov_b32 s69, 0x00010001
    s_mov_b64 exec, s[68:69]
    buffer_store_dwordx4 v[140:143], v3, s[32:35], s6 offen sc1
    s_mov_b64 exec, -1
    v_mfma_f32_16x16x32_bf16 v[188:191], v[148:151], a[68:71], v[188:191]
    v_mfma_f32_16x16x32_bf16 v[192:195], v[148:151], a[132:135], v[192:195]
    v_mfma_f32_16x16x32_bf16 v[196:199], v[148:151], a[196:199], v[196:199]
    buffer_load_dwordx4 v13, s[40:43], s60 offen offset:1024 lds
    v_mfma_f32_16x16x32_bf16 v[184:187], v[152:155], a[8:11], v[184:187]
    ds_read_b64_tr_b16 v[164:165], v32 offset:24576
    ds_read_b64_tr_b16 v[166:167], v32 offset:25088
    v_mfma_f32_16x16x32_bf16 v[188:191], v[152:155], a[72:75], v[188:191]
    v_mfma_f32_16x16x32_bf16 v[192:195], v[152:155], a[136:139], v[192:195]
    v_mfma_f32_16x16x32_bf16 v[196:199], v[152:155], a[200:203], v[196:199]
    buffer_load_dwordx4 v16, s[40:43], s60 offen offset:2048 lds
    v_mfma_f32_16x16x32_bf16 v[184:187], v[156:159], a[12:15], v[184:187]
    ds_read_b64_tr_b16 v[168:169], v32 offset:17408
    ds_read_b64_tr_b16 v[170:171], v32 offset:17920
    v_mfma_f32_16x16x32_bf16 v[188:191], v[156:159], a[76:79], v[188:191]
    v_mfma_f32_16x16x32_bf16 v[192:195], v[156:159], a[140:143], v[192:195]
    v_mfma_f32_16x16x32_bf16 v[196:199], v[156:159], a[204:207], v[196:199]
    buffer_load_dwordx4 v17, s[40:43], s60 offen offset:3072 lds
    v_mfma_f32_16x16x32_bf16 v[184:187], v[160:163], a[16:19], v[184:187]
    ds_read_b64_tr_b16 v[172:173], v32 offset:25600
    ds_read_b64_tr_b16 v[174:175], v32 offset:26112
    v_mfma_f32_16x16x32_bf16 v[188:191], v[160:163], a[80:83], v[188:191]
    v_mfma_f32_16x16x32_bf16 v[192:195], v[160:163], a[144:147], v[192:195]
    v_mfma_f32_16x16x32_bf16 v[196:199], v[160:163], a[208:211], v[196:199]
    s_add_u32 m0, s7, 104448
    s_add_u32 s60, s65, 147456
    buffer_load_dwordx4 v12, s[40:43], s60 offen offset:0 lds
    s_waitcnt lgkmcnt(0)
    s_waitcnt vmcnt(15)
    s_barrier
    v_mfma_f32_16x16x32_bf16 v[184:187], v[164:167], a[20:23], v[184:187]
    ds_read_b64_tr_b16 v[144:145], v32 offset:34816
    ds_read_b64_tr_b16 v[146:147], v32 offset:35328
    v_mfma_f32_16x16x32_bf16 v[188:191], v[164:167], a[84:87], v[188:191]
    v_mfma_f32_16x16x32_bf16 v[192:195], v[164:167], a[148:151], v[192:195]
    v_mfma_f32_16x16x32_bf16 v[196:199], v[164:167], a[212:215], v[196:199]
    buffer_load_dwordx4 v13, s[40:43], s60 offen offset:1024 lds
    v_mfma_f32_16x16x32_bf16 v[184:187], v[168:171], a[24:27], v[184:187]
    ds_read_b64_tr_b16 v[148:149], v32 offset:43008
    ds_read_b64_tr_b16 v[150:151], v32 offset:43520
    v_mfma_f32_16x16x32_bf16 v[188:191], v[168:171], a[88:91], v[188:191]
    v_mfma_f32_16x16x32_bf16 v[192:195], v[168:171], a[152:155], v[192:195]
    v_mfma_f32_16x16x32_bf16 v[196:199], v[168:171], a[216:219], v[196:199]
    buffer_load_dwordx4 v16, s[40:43], s60 offen offset:2048 lds
    v_mfma_f32_16x16x32_bf16 v[184:187], v[172:175], a[28:31], v[184:187]
    ds_read_b64_tr_b16 v[152:153], v32 offset:35840
    ds_read_b64_tr_b16 v[154:155], v32 offset:36352
    v_mfma_f32_16x16x32_bf16 v[188:191], v[172:175], a[92:95], v[188:191]
    v_mfma_f32_16x16x32_bf16 v[192:195], v[172:175], a[156:159], v[192:195]
    v_mfma_f32_16x16x32_bf16 v[196:199], v[172:175], a[220:223], v[196:199]
    buffer_load_dwordx4 v17, s[40:43], s60 offen offset:3072 lds
    s_waitcnt lgkmcnt(4)
    v_mfma_f32_16x16x32_bf16 v[184:187], v[144:147], a[32:35], v[184:187]
    ds_read_b64_tr_b16 v[156:157], v32 offset:44032
    ds_read_b64_tr_b16 v[158:159], v32 offset:44544
    v_mfma_f32_16x16x32_bf16 v[188:191], v[144:147], a[96:99], v[188:191]
    v_mfma_f32_16x16x32_bf16 v[192:195], v[144:147], a[160:163], v[192:195]
    v_mfma_f32_16x16x32_bf16 v[196:199], v[144:147], a[224:227], v[196:199]
    s_waitcnt lgkmcnt(4)
    v_mfma_f32_16x16x32_bf16 v[184:187], v[148:151], a[36:39], v[184:187]
    ds_read_b64_tr_b16 v[160:161], v32 offset:51200
    ds_read_b64_tr_b16 v[162:163], v32 offset:51712
    v_mfma_f32_16x16x32_bf16 v[188:191], v[148:151], a[100:103], v[188:191]
    v_mfma_f32_16x16x32_bf16 v[192:195], v[148:151], a[164:167], v[192:195]
    v_mfma_f32_16x16x32_bf16 v[196:199], v[148:151], a[228:231], v[196:199]
    s_waitcnt lgkmcnt(4)
    v_mfma_f32_16x16x32_bf16 v[184:187], v[152:155], a[40:43], v[184:187]
    ds_read_b64_tr_b16 v[164:165], v32 offset:59392
    ds_read_b64_tr_b16 v[166:167], v32 offset:59904
    v_mfma_f32_16x16x32_bf16 v[188:191], v[152:155], a[104:107], v[188:191]
    v_mfma_f32_16x16x32_bf16 v[192:195], v[152:155], a[168:171], v[192:195]
    v_mfma_f32_16x16x32_bf16 v[196:199], v[152:155], a[232:235], v[196:199]
    s_waitcnt lgkmcnt(4)
    v_mfma_f32_16x16x32_bf16 v[184:187], v[156:159], a[44:47], v[184:187]
    ds_read_b64_tr_b16 v[168:169], v32 offset:52224
    ds_read_b64_tr_b16 v[170:171], v32 offset:52736
    v_mfma_f32_16x16x32_bf16 v[188:191], v[156:159], a[108:111], v[188:191]
    v_mfma_f32_16x16x32_bf16 v[192:195], v[156:159], a[172:175], v[192:195]
    v_mfma_f32_16x16x32_bf16 v[196:199], v[156:159], a[236:239], v[196:199]
    s_waitcnt lgkmcnt(4)
    v_mfma_f32_16x16x32_bf16 v[184:187], v[160:163], a[48:51], v[184:187]
    ds_read_b64_tr_b16 v[172:173], v32 offset:60416
    ds_read_b64_tr_b16 v[174:175], v32 offset:60928
    v_mfma_f32_16x16x32_bf16 v[188:191], v[160:163], a[112:115], v[188:191]
    v_mfma_f32_16x16x32_bf16 v[192:195], v[160:163], a[176:179], v[192:195]
    v_mfma_f32_16x16x32_bf16 v[196:199], v[160:163], a[240:243], v[196:199]
    s_waitcnt lgkmcnt(4)
    v_mfma_f32_16x16x32_bf16 v[184:187], v[164:167], a[52:55], v[184:187]
    ds_read_b64_tr_b16 v[144:145], v35 offset:0
    ds_read_b64_tr_b16 v[146:147], v35 offset:512
    v_mfma_f32_16x16x32_bf16 v[188:191], v[164:167], a[116:119], v[188:191]
    v_mfma_f32_16x16x32_bf16 v[192:195], v[164:167], a[180:183], v[192:195]
    v_mfma_f32_16x16x32_bf16 v[196:199], v[164:167], a[244:247], v[196:199]
    s_waitcnt lgkmcnt(4)
    v_mfma_f32_16x16x32_bf16 v[184:187], v[168:171], a[56:59], v[184:187]
    ds_read_b64_tr_b16 v[148:149], v35 offset:8192
    ds_read_b64_tr_b16 v[150:151], v35 offset:8704
    v_mfma_f32_16x16x32_bf16 v[188:191], v[168:171], a[120:123], v[188:191]
    v_mfma_f32_16x16x32_bf16 v[192:195], v[168:171], a[184:187], v[192:195]
    v_mfma_f32_16x16x32_bf16 v[196:199], v[168:171], a[248:251], v[196:199]
    s_waitcnt lgkmcnt(4)
    v_mfma_f32_16x16x32_bf16 v[184:187], v[172:175], a[60:63], v[184:187]
    ds_read_b64_tr_b16 v[152:153], v35 offset:1024
    ds_read_b64_tr_b16 v[154:155], v35 offset:1536
    v_mfma_f32_16x16x32_bf16 v[188:191], v[172:175], a[124:127], v[188:191]
    v_mfma_f32_16x16x32_bf16 v[192:195], v[172:175], a[188:191], v[192:195]
    v_mfma_f32_16x16x32_bf16 v[196:199], v[172:175], a[252:255], v[196:199]
    s_waitcnt lgkmcnt(4)
    v_mfma_f32_16x16x32_bf16 v[200:203], v[144:147], a[0:3], 0
    ds_read_b64_tr_b16 v[156:157], v35 offset:9216
    ds_read_b64_tr_b16 v[158:159], v35 offset:9728
    v_mfma_f32_16x16x32_bf16 v[204:207], v[144:147], a[64:67], 0
    v_pk_mul_f32 v[216:217], v[184:185], s[18:19]
    v_pk_mul_f32 v[218:219], v[186:187], s[18:19]
    v_mfma_f32_16x16x32_bf16 v[208:211], v[144:147], a[128:131], 0
    v_pk_mul_f32 v[220:221], v[188:189], s[18:19]
    v_pk_mul_f32 v[222:223], v[190:191], s[18:19]
    v_mfma_f32_16x16x32_bf16 v[212:215], v[144:147], a[192:195], 0
    v_pk_mul_f32 v[224:225], v[192:193], s[18:19]
    v_pk_mul_f32 v[226:227], v[194:195], s[18:19]
    s_waitcnt lgkmcnt(4)
    v_mfma_f32_16x16x32_bf16 v[200:203], v[148:151], a[4:7], v[200:203]
    ds_read_b64_tr_b16 v[160:161], v35 offset:16384
    ds_read_b64_tr_b16 v[162:163], v35 offset:16896
    v_mfma_f32_16x16x32_bf16 v[204:207], v[148:151], a[68:71], v[204:207]
    v_pk_mul_f32 v[228:229], v[196:197], s[18:19]
    v_pk_mul_f32 v[230:231], v[198:199], s[18:19]
    v_mfma_f32_16x16x32_bf16 v[208:211], v[148:151], a[132:135], v[208:211]
    v_exp_f32 v216, v216 clamp
    v_max_f32 v184, s64, v184
    v_mfma_f32_16x16x32_bf16 v[212:215], v[148:151], a[196:199], v[212:215]
    v_exp_f32 v217, v217 clamp
    v_max_f32 v185, s64, v185
    s_waitcnt lgkmcnt(4)
    v_mfma_f32_16x16x32_bf16 v[200:203], v[152:155], a[8:11], v[200:203]
    ds_read_b64_tr_b16 v[164:165], v35 offset:24576
    ds_read_b64_tr_b16 v[166:167], v35 offset:25088
    v_mfma_f32_16x16x32_bf16 v[204:207], v[152:155], a[72:75], v[204:207]
    v_exp_f32 v218, v218 clamp
    v_max_f32 v186, s64, v186
    v_mfma_f32_16x16x32_bf16 v[208:211], v[152:155], a[136:139], v[208:211]
    v_exp_f32 v219, v219 clamp
    v_max_f32 v187, s64, v187
    v_mfma_f32_16x16x32_bf16 v[212:215], v[152:155], a[200:203], v[212:215]
    v_exp_f32 v220, v220 clamp
    v_max_f32 v188, s64, v188
    s_waitcnt lgkmcnt(4)
    v_mfma_f32_16x16x32_bf16 v[200:203], v[156:159], a[12:15], v[200:203]
    ds_read_b64_tr_b16 v[168:169], v35 offset:17408
    ds_read_b64_tr_b16 v[170:171], v35 offset:17920
    v_mfma_f32_16x16x32_bf16 v[204:207], v[156:159], a[76:79], v[204:207]
    v_exp_f32 v221, v221 clamp
    v_max_f32 v189, s64, v189
    v_mfma_f32_16x16x32_bf16 v[208:211], v[156:159], a[140:143], v[208:211]
    v_exp_f32 v222, v222 clamp
    v_max_f32 v190, s64, v190
    v_mfma_f32_16x16x32_bf16 v[212:215], v[156:159], a[204:207], v[212:215]
    v_exp_f32 v223, v223 clamp
    v_max_f32 v191, s64, v191
    s_waitcnt lgkmcnt(4)
    v_mfma_f32_16x16x32_bf16 v[200:203], v[160:163], a[16:19], v[200:203]
    ds_read_b64_tr_b16 v[172:173], v35 offset:25600
    ds_read_b64_tr_b16 v[174:175], v35 offset:26112
    v_mfma_f32_16x16x32_bf16 v[204:207], v[160:163], a[80:83], v[204:207]
    v_exp_f32 v224, v224 clamp
    v_max_f32 v192, s64, v192
    v_mfma_f32_16x16x32_bf16 v[208:211], v[160:163], a[144:147], v[208:211]
    v_exp_f32 v225, v225 clamp
    v_max_f32 v193, s64, v193
    v_mfma_f32_16x16x32_bf16 v[212:215], v[160:163], a[208:211], v[212:215]
    v_exp_f32 v226, v226 clamp
    v_max_f32 v194, s64, v194
    s_waitcnt lgkmcnt(4)
    v_mfma_f32_16x16x32_bf16 v[200:203], v[164:167], a[20:23], v[200:203]
    ds_read_b64_tr_b16 v[144:145], v35 offset:34816
    ds_read_b64_tr_b16 v[146:147], v35 offset:35328
    v_mfma_f32_16x16x32_bf16 v[204:207], v[164:167], a[84:87], v[204:207]
    v_exp_f32 v227, v227 clamp
    v_max_f32 v195, s64, v195
    v_mfma_f32_16x16x32_bf16 v[208:211], v[164:167], a[148:151], v[208:211]
    v_exp_f32 v228, v228 clamp
    v_max_f32 v196, s64, v196
    v_mfma_f32_16x16x32_bf16 v[212:215], v[164:167], a[212:215], v[212:215]
    v_exp_f32 v229, v229 clamp
    v_max_f32 v197, s64, v197
    s_waitcnt lgkmcnt(4)
    v_mfma_f32_16x16x32_bf16 v[200:203], v[168:171], a[24:27], v[200:203]
    ds_read_b64_tr_b16 v[148:149], v35 offset:43008
    ds_read_b64_tr_b16 v[150:151], v35 offset:43520
    v_mfma_f32_16x16x32_bf16 v[204:207], v[168:171], a[88:91], v[204:207]
    v_exp_f32 v230, v230 clamp
    v_max_f32 v198, s64, v198
    v_mfma_f32_16x16x32_bf16 v[208:211], v[168:171], a[152:155], v[208:211]
    v_exp_f32 v231, v231 clamp
    v_max_f32 v199, s64, v199
    v_mfma_f32_16x16x32_bf16 v[212:215], v[168:171], a[216:219], v[212:215]
    v_pk_add_f32 v[184:185], v[184:185], v[216:217]
    v_pk_add_f32 v[186:187], v[186:187], v[218:219]
    s_waitcnt lgkmcnt(4)
    v_mfma_f32_16x16x32_bf16 v[200:203], v[172:175], a[28:31], v[200:203]
    ds_read_b64_tr_b16 v[152:153], v35 offset:35840
    ds_read_b64_tr_b16 v[154:155], v35 offset:36352
    v_mfma_f32_16x16x32_bf16 v[204:207], v[172:175], a[92:95], v[204:207]
    v_pk_add_f32 v[188:189], v[188:189], v[220:221]
    v_pk_add_f32 v[190:191], v[190:191], v[222:223]
    v_mfma_f32_16x16x32_bf16 v[208:211], v[172:175], a[156:159], v[208:211]
    v_pk_add_f32 v[192:193], v[192:193], v[224:225]
    v_pk_add_f32 v[194:195], v[194:195], v[226:227]
    v_mfma_f32_16x16x32_bf16 v[212:215], v[172:175], a[220:223], v[212:215]
    v_pk_add_f32 v[196:197], v[196:197], v[228:229]
    v_pk_add_f32 v[198:199], v[198:199], v[230:231]
    v_cvt_pk_bf16_f32 v240, v184, v185
    v_cvt_pk_bf16_f32 v241, v186, v187
    v_cvt_pk_bf16_f32 v242, v188, v189
    v_cvt_pk_bf16_f32 v243, v190, v191
    v_cvt_pk_bf16_f32 v244, v192, v193
    v_cvt_pk_bf16_f32 v245, v194, v195
    v_cvt_pk_bf16_f32 v246, v196, v197
    v_cvt_pk_bf16_f32 v247, v198, v199
    s_lshl_b32 s58, s70, 14
    s_add_u32 s58, s58, 4194304
    s_lshl_b32 s59, s70, 10
    s_add_u32 s59, s59, 4718592
    v_and_b32 v3, 15, v1
    v_lshlrev_b32 v3, 6, v3
    v_lshrrev_b32 v4, 4, v1
    v_lshl_add_u32 v3, v4, 4, v3
    s_waitcnt lgkmcnt(4)
    v_mfma_f32_16x16x32_bf16 v[200:203], v[144:147], a[32:35], v[200:203]
    s_add_u32 s60, s58, 0
    buffer_load_dwordx4 v[72:75], v46, s[32:35], s60 offen offset:0 sc1
    v_mfma_f32_16x16x32_bf16 v[204:207], v[144:147], a[96:99], v[204:207]
    ds_read_b64_tr_b16 v[156:157], v35 offset:44032
    ds_read_b64_tr_b16 v[158:159], v35 offset:44544
    v_mfma_f32_16x16x32_bf16 v[208:211], v[144:147], a[160:163], v[208:211]
    buffer_load_dwordx4 v[76:79], v46, s[32:35], s60 offen offset:1024 sc1
    v_mfma_f32_16x16x32_bf16 v[212:215], v[144:147], a[224:227], v[212:215]
    s_waitcnt lgkmcnt(4)
    v_mfma_f32_16x16x32_bf16 v[200:203], v[148:151], a[36:39], v[200:203]
    buffer_load_dwordx4 v[80:83], v46, s[32:35], s60 offen offset:2048 sc1
    ds_read_b64_tr_b16 v[160:161], v35 offset:51200
    v_mfma_f32_16x16x32_bf16 v[204:207], v[148:151], a[100:103], v[204:207]
    ds_read_b64_tr_b16 v[162:163], v35 offset:51712
    v_mfma_f32_16x16x32_bf16 v[208:211], v[148:151], a[164:167], v[208:211]
    buffer_load_dwordx4 v[84:87], v46, s[32:35], s60 offen offset:3072 sc1
    v_mfma_f32_16x16x32_bf16 v[212:215], v[148:151], a[228:231], v[212:215]
    s_waitcnt lgkmcnt(4)
    v_mfma_f32_16x16x32_bf16 v[200:203], v[152:155], a[40:43], v[200:203]
    s_add_u32 s60, s58, 4096
    buffer_load_dwordx4 v[88:91], v46, s[32:35], s60 offen offset:0 sc1
    v_mfma_f32_16x16x32_bf16 v[204:207], v[152:155], a[104:107], v[204:207]
    ds_read_b64_tr_b16 v[164:165], v35 offset:59392
    ds_read_b64_tr_b16 v[166:167], v35 offset:59904
    v_mfma_f32_16x16x32_bf16 v[208:211], v[152:155], a[168:171], v[208:211]
    buffer_load_dwordx4 v[92:95], v46, s[32:35], s60 offen offset:1024 sc1
    v_mfma_f32_16x16x32_bf16 v[212:215], v[152:155], a[232:235], v[212:215]
    s_waitcnt lgkmcnt(4)
    v_mfma_f32_16x16x32_bf16 v[200:203], v[156:159], a[44:47], v[200:203]
    buffer_load_dwordx4 v[96:99], v46, s[32:35], s60 offen offset:2048 sc1
    ds_read_b64_tr_b16 v[168:169], v35 offset:52224
    v_mfma_f32_16x16x32_bf16 v[204:207], v[156:159], a[108:111], v[204:207]
    ds_read_b64_tr_b16 v[170:171], v35 offset:52736
    v_mfma_f32_16x16x32_bf16 v[208:211], v[156:159], a[172:175], v[208:211]
    buffer_load_dwordx4 v[100:103], v46, s[32:35], s60 offen offset:3072 sc1
    v_mfma_f32_16x16x32_bf16 v[212:215], v[156:159], a[236:239], v[212:215]
    s_waitcnt lgkmcnt(4)
    v_mfma_f32_16x16x32_bf16 v[200:203], v[160:163], a[48:51], v[200:203]
    s_add_u32 s60, s58, 8192
    buffer_load_dwordx4 v[104:107], v46, s[32:35], s60 offen offset:0 sc1
    v_mfma_f32_16x16x32_bf16 v[204:207], v[160:163], a[112:115], v[204:207]
    ds_read_b64_tr_b16 v[172:173], v35 offset:60416
    ds_read_b64_tr_b16 v[174:175], v35 offset:60928
    v_mfma_f32_16x16x32_bf16 v[208:211], v[160:163], a[176:179], v[208:211]
    buffer_load_dwordx4 v[108:111], v46, s[32:35], s60 offen offset:1024 sc1
    v_mfma_f32_16x16x32_bf16 v[212:215], v[160:163], a[240:243], v[212:215]
    s_waitcnt lgkmcnt(4)
    v_mfma_f32_16x16x32_bf16 v[200:203], v[164:167], a[52:55], v[200:203]
    buffer_load_dwordx4 v[112:115], v46, s[32:35], s60 offen offset:2048 sc1
    v_mfma_f32_16x16x32_bf16 v[204:207], v[164:167], a[116:119], v[204:207]
    v_mfma_f32_16x16x32_bf16 v[208:211], v[164:167], a[180:183], v[208:211]
    buffer_load_dwordx4 v[116:119], v46, s[32:35], s60 offen offset:3072 sc1
    v_mfma_f32_16x16x32_bf16 v[212:215], v[164:167], a[244:247], v[212:215]
    s_waitcnt lgkmcnt(2)
    v_mfma_f32_16x16x32_bf16 v[200:203], v[168:171], a[56:59], v[200:203]
    s_add_u32 s60, s58, 12288
    buffer_load_dwordx4 v[120:123], v46, s[32:35], s60 offen offset:0 sc1
    v_mfma_f32_16x16x32_bf16 v[204:207], v[168:171], a[120:123], v[204:207]
    v_mfma_f32_16x16x32_bf16 v[208:211], v[168:171], a[184:187], v[208:211]
    buffer_load_dwordx4 v[124:127], v46, s[32:35], s60 offen offset:1024 sc1
    v_mfma_f32_16x16x32_bf16 v[212:215], v[168:171], a[248:251], v[212:215]
    s_waitcnt lgkmcnt(0)
    v_mfma_f32_16x16x32_bf16 v[200:203], v[172:175], a[60:63], v[200:203]
    buffer_load_dwordx4 v[128:131], v46, s[32:35], s60 offen offset:2048 sc1
    v_mfma_f32_16x16x32_bf16 v[204:207], v[172:175], a[124:127], v[204:207]
    v_mfma_f32_16x16x32_bf16 v[208:211], v[172:175], a[188:191], v[208:211]
    buffer_load_dwordx4 v[132:135], v46, s[32:35], s60 offen offset:3072 sc1
    v_mfma_f32_16x16x32_bf16 v[212:215], v[172:175], a[252:255], v[212:215]
    buffer_load_dwordx4 v[136:139], v3, s[32:35], s59 offen sc1
    s_waitcnt lgkmcnt(0)
    s_waitcnt vmcnt(17)
    s_barrier
    v_mov_b32 v6, s15
    v_pk_mul_f32 v[144:145], v[200:201], s[18:19]
    v_pk_mul_f32 v[146:147], v[202:203], s[18:19]
    v_pk_mul_f32 v[148:149], v[204:205], s[18:19]
    v_pk_mul_f32 v[150:151], v[206:207], s[18:19]
    v_pk_mul_f32 v[152:153], v[208:209], s[18:19]
    v_pk_mul_f32 v[154:155], v[210:211], s[18:19]
    v_pk_mul_f32 v[156:157], v[212:213], s[18:19]
    v_pk_mul_f32 v[158:159], v[214:215], s[18:19]
    v_exp_f32 v144, v144 clamp
    s_add_u32 m0, s7, 0
    s_add_u32 s60, s65, 262144
    buffer_load_dwordx4 v12, s[40:43], s60 offen offset:0 lds
    v_max_f32 v200, s64, v200
    v_exp_f32 v145, v145 clamp
    v_max_f32 v201, s64, v201
    v_exp_f32 v146, v146 clamp
    v_max_f32 v202, s64, v202
    v_exp_f32 v147, v147 clamp
    v_max_f32 v203, s64, v203
    v_exp_f32 v148, v148 clamp
    v_max_f32 v204, s64, v204
    buffer_load_dwordx4 v13, s[40:43], s60 offen offset:1024 lds
    v_exp_f32 v149, v149 clamp
    v_max_f32 v205, s64, v205
    v_exp_f32 v150, v150 clamp
    v_max_f32 v206, s64, v206
    v_exp_f32 v151, v151 clamp
    v_max_f32 v207, s64, v207
    v_exp_f32 v152, v152 clamp
    v_max_f32 v208, s64, v208
    v_exp_f32 v153, v153 clamp
    buffer_load_dwordx4 v16, s[40:43], s60 offen offset:2048 lds
    v_max_f32 v209, s64, v209
    v_exp_f32 v154, v154 clamp
    v_max_f32 v210, s64, v210
    v_exp_f32 v155, v155 clamp
    v_max_f32 v211, s64, v211
    v_exp_f32 v156, v156 clamp
    v_max_f32 v212, s64, v212
    v_exp_f32 v157, v157 clamp
    v_max_f32 v213, s64, v213
    buffer_load_dwordx4 v17, s[40:43], s60 offen offset:3072 lds
    v_exp_f32 v158, v158 clamp
    v_max_f32 v214, s64, v214
    v_exp_f32 v159, v159 clamp
    v_max_f32 v215, s64, v215
    v_pk_add_f32 v[200:201], v[200:201], v[144:145]
    v_pk_add_f32 v[202:203], v[202:203], v[146:147]
    v_pk_add_f32 v[204:205], v[204:205], v[148:149]
    v_pk_add_f32 v[206:207], v[206:207], v[150:151]
    v_pk_add_f32 v[208:209], v[208:209], v[152:153]
    s_add_u32 m0, s7, 4096
    s_add_u32 s60, s65, 278528
    buffer_load_dwordx4 v12, s[40:43], s60 offen offset:0 lds
    v_pk_add_f32 v[210:211], v[210:211], v[154:155]
    v_pk_add_f32 v[212:213], v[212:213], v[156:157]
    v_pk_add_f32 v[214:215], v[214:215], v[158:159]
    v_cvt_pk_bf16_f32 v248, v200, v201
    v_cvt_pk_bf16_f32 v249, v202, v203
    v_cvt_pk_bf16_f32 v250, v204, v205
    v_cvt_pk_bf16_f32 v251, v206, v207
    v_cvt_pk_bf16_f32 v252, v208, v209
    v_cvt_pk_bf16_f32 v253, v210, v211
    buffer_load_dwordx4 v13, s[40:43], s60 offen offset:1024 lds
    v_cvt_pk_bf16_f32 v254, v212, v213
    v_cvt_pk_bf16_f32 v255, v214, v215
    s_waitcnt vmcnt(22)
    v_msad_u8 v4, v72, v6, 0
    v_msad_u8 v5, v73, v6, 0
    v_msad_u8 v4, v74, v6, v4
    v_msad_u8 v5, v75, v6, v5
    s_waitcnt vmcnt(21)
    v_msad_u8 v4, v76, v6, v4
    v_msad_u8 v5, v77, v6, v5
    v_msad_u8 v4, v78, v6, v4
    v_msad_u8 v5, v79, v6, v5
    v_pk_add_f32 v[160:161], v[72:73], v[76:77]
    v_pk_add_f32 v[162:163], v[74:75], v[78:79]
    buffer_load_dwordx4 v16, s[40:43], s60 offen offset:2048 lds
    s_waitcnt vmcnt(21)
    v_msad_u8 v4, v80, v6, v4
    v_msad_u8 v5, v81, v6, v5
    v_msad_u8 v4, v82, v6, v4
    v_msad_u8 v5, v83, v6, v5
    v_pk_add_f32 v[160:161], v[160:161], v[80:81]
    v_pk_add_f32 v[162:163], v[162:163], v[82:83]
    s_waitcnt vmcnt(20)
    v_msad_u8 v4, v84, v6, v4
    v_msad_u8 v5, v85, v6, v5
    v_msad_u8 v4, v86, v6, v4
    v_msad_u8 v5, v87, v6, v5
    v_pk_add_f32 v[160:161], v[160:161], v[84:85]
    v_pk_add_f32 v[162:163], v[162:163], v[86:87]
    buffer_load_dwordx4 v17, s[40:43], s60 offen offset:3072 lds
    s_waitcnt vmcnt(20)
    v_msad_u8 v4, v88, v6, v4
    v_msad_u8 v5, v89, v6, v5
    v_msad_u8 v4, v90, v6, v4
    v_msad_u8 v5, v91, v6, v5
    v_pk_add_f32 v[160:161], v[160:161], v[88:89]
    v_pk_add_f32 v[162:163], v[162:163], v[90:91]
    s_waitcnt vmcnt(19)
    v_msad_u8 v4, v92, v6, v4
    v_msad_u8 v5, v93, v6, v5
    v_msad_u8 v4, v94, v6, v4
    v_msad_u8 v5, v95, v6, v5
    v_pk_add_f32 v[160:161], v[160:161], v[92:93]
    v_pk_add_f32 v[162:163], v[162:163], v[94:95]
    s_add_u32 m0, s7, 32768
    s_add_u32 s60, s65, 393216
    buffer_load_dwordx4 v12, s[40:43], s60 offen offset:0 lds
    s_waitcnt vmcnt(19)
    v_msad_u8 v4, v96, v6, v4
    v_msad_u8 v5, v97, v6, v5
    v_msad_u8 v4, v98, v6, v4
    v_msad_u8 v5, v99, v6, v5
    v_pk_add_f32 v[160:161], v[160:161], v[96:97]
    v_pk_add_f32 v[162:163], v[162:163], v[98:99]
    s_waitcnt vmcnt(18)
    v_msad_u8 v4, v100, v6, v4
    v_msad_u8 v5, v101, v6, v5
    v_msad_u8 v4, v102, v6, v4
    v_msad_u8 v5, v103, v6, v5
    v_pk_add_f32 v[160:161], v[160:161], v[100:101]
    v_pk_add_f32 v[162:163], v[162:163], v[102:103]
    buffer_load_dwordx4 v13, s[40:43], s60 offen offset:1024 lds
    s_waitcnt vmcnt(18)
    v_msad_u8 v4, v104, v6, v4
    v_msad_u8 v5, v105, v6, v5
    v_msad_u8 v4, v106, v6, v4
    v_msad_u8 v5, v107, v6, v5
    v_pk_add_f32 v[160:161], v[160:161], v[104:105]
    v_pk_add_f32 v[162:163], v[162:163], v[106:107]
    s_waitcnt vmcnt(17)
    v_msad_u8 v4, v108, v6, v4
    v_msad_u8 v5, v109, v6, v5
    v_msad_u8 v4, v110, v6, v4
    v_msad_u8 v5, v111, v6, v5
    v_pk_add_f32 v[160:161], v[160:161], v[108:109]
    v_pk_add_f32 v[162:163], v[162:163], v[110:111]
    buffer_load_dwordx4 v16, s[40:43], s60 offen offset:2048 lds
    s_waitcnt vmcnt(17)
    v_msad_u8 v4, v112, v6, v4
    v_msad_u8 v5, v113, v6, v5
    v_msad_u8 v4, v114, v6, v4
    v_msad_u8 v5, v115, v6, v5
    v_pk_add_f32 v[160:161], v[160:161], v[112:113]
    v_pk_add_f32 v[162:163], v[162:163], v[114:115]
    s_waitcnt vmcnt(16)
    v_msad_u8 v4, v116, v6, v4
    v_msad_u8 v5, v117, v6, v5
    v_msad_u8 v4, v118, v6, v4
    v_msad_u8 v5, v119, v6, v5
    v_pk_add_f32 v[160:161], v[160:161], v[116:117]
    v_pk_add_f32 v[162:163], v[162:163], v[118:119]
    buffer_load_dwordx4 v17, s[40:43], s60 offen offset:3072 lds
    s_waitcnt vmcnt(16)
    v_msad_u8 v4, v120, v6, v4
    v_msad_u8 v5, v121, v6, v5
    v_msad_u8 v4, v122, v6, v4
    v_msad_u8 v5, v123, v6, v5
    v_pk_add_f32 v[160:161], v[160:161], v[120:121]
    v_pk_add_f32 v[162:163], v[162:163], v[122:123]
    s_waitcnt vmcnt(15)
    v_msad_u8 v4, v124, v6, v4
    v_msad_u8 v5, v125, v6, v5
    v_msad_u8 v4, v126, v6, v4
    v_msad_u8 v5, v127, v6, v5
    v_pk_add_f32 v[160:161], v[160:161], v[124:125]
    v_pk_add_f32 v[162:163], v[162:163], v[126:127]
    s_add_u32 m0, s7, 36864
    s_add_u32 s60, s65, 409600
    buffer_load_dwordx4 v12, s[40:43], s60 offen offset:0 lds
    s_waitcnt vmcnt(15)
    v_msad_u8 v4, v128, v6, v4
    v_msad_u8 v5, v129, v6, v5
    v_msad_u8 v4, v130, v6, v4
    v_msad_u8 v5, v131, v6, v5
    v_pk_add_f32 v[160:161], v[160:161], v[128:129]
    v_pk_add_f32 v[162:163], v[162:163], v[130:131]
    s_waitcnt vmcnt(14)
    v_msad_u8 v4, v132, v6, v4
    v_msad_u8 v5, v133, v6, v5
    v_msad_u8 v4, v134, v6, v4
    v_msad_u8 v5, v135, v6, v5
    v_pk_add_f32 v[160:161], v[160:161], v[132:133]
    v_pk_add_f32 v[162:163], v[162:163], v[134:135]
    buffer_load_dwordx4 v13, s[40:43], s60 offen offset:1024 lds
    s_waitcnt vmcnt(14)
    v_msad_u8 v4, v136, v6, v4
    v_msad_u8 v5, v137, v6, v5
    v_msad_u8 v4, v138, v6, v4
    v_msad_u8 v5, v139, v6, v5
    v_or_b32 v4, v4, v5
    v_cmp_ne_u32 vcc, 0, v4
    buffer_load_dwordx4 v16, s[40:43], s60 offen offset:2048 lds
    buffer_load_dwordx4 v17, s[40:43], s60 offen offset:3072 lds
    s_cbranch_vccz L_kvok_11
L_kvretry_11:
    s_sub_u32 s71, s71, 1
    s_cbranch_scc1 L_kvok_11
    s_sleep 4
    s_add_u32 s60, s58, 0
    buffer_load_dwordx4 v[72:75], v46, s[32:35], s60 offen offset:0 sc1
    buffer_load_dwordx4 v[76:79], v46, s[32:35], s60 offen offset:1024 sc1
    buffer_load_dwordx4 v[80:83], v46, s[32:35], s60 offen offset:2048 sc1
    buffer_load_dwordx4 v[84:87], v46, s[32:35], s60 offen offset:3072 sc1
    s_add_u32 s60, s58, 4096
    buffer_load_dwordx4 v[88:91], v46, s[32:35], s60 offen offset:0 sc1
    buffer_load_dwordx4 v[92:95], v46, s[32:35], s60 offen offset:1024 sc1
    buffer_load_dwordx4 v[96:99], v46, s[32:35], s60 offen offset:2048 sc1
    buffer_load_dwordx4 v[100:103], v46, s[32:35], s60 offen offset:3072 sc1
    s_add_u32 s60, s58, 8192
    buffer_load_dwordx4 v[104:107], v46, s[32:35], s60 offen offset:0 sc1
    buffer_load_dwordx4 v[108:111], v46, s[32:35], s60 offen offset:1024 sc1
    buffer_load_dwordx4 v[112:115], v46, s[32:35], s60 offen offset:2048 sc1
    buffer_load_dwordx4 v[116:119], v46, s[32:35], s60 offen offset:3072 sc1
    s_add_u32 s60, s58, 12288
    buffer_load_dwordx4 v[120:123], v46, s[32:35], s60 offen offset:0 sc1
    buffer_load_dwordx4 v[124:127], v46, s[32:35], s60 offen offset:1024 sc1
    buffer_load_dwordx4 v[128:131], v46, s[32:35], s60 offen offset:2048 sc1
    buffer_load_dwordx4 v[132:135], v46, s[32:35], s60 offen offset:3072 sc1
    buffer_load_dwordx4 v[136:139], v3, s[32:35], s59 offen sc1
    s_waitcnt vmcnt(0)
    v_msad_u8 v4, v72, v6, 0
    v_msad_u8 v5, v73, v6, 0
    v_msad_u8 v4, v74, v6, v4
    v_msad_u8 v5, v75, v6, v5
    v_msad_u8 v4, v76, v6, v4
    v_msad_u8 v5, v77, v6, v5
    v_msad_u8 v4, v78, v6, v4
    v_msad_u8 v5, v79, v6, v5
    v_pk_add_f32 v[160:161], v[72:73], v[76:77]
    v_pk_add_f32 v[162:163], v[74:75], v[78:79]
    v_msad_u8 v4, v80, v6, v4
    v_msad_u8 v5, v81, v6, v5
    v_msad_u8 v4, v82, v6, v4
    v_msad_u8 v5, v83, v6, v5
    v_pk_add_f32 v[160:161], v[160:161], v[80:81]
    v_pk_add_f32 v[162:163], v[162:163], v[82:83]
    v_msad_u8 v4, v84, v6, v4
    v_msad_u8 v5, v85, v6, v5
    v_msad_u8 v4, v86, v6, v4
    v_msad_u8 v5, v87, v6, v5
    v_pk_add_f32 v[160:161], v[160:161], v[84:85]
    v_pk_add_f32 v[162:163], v[162:163], v[86:87]
    v_msad_u8 v4, v88, v6, v4
    v_msad_u8 v5, v89, v6, v5
    v_msad_u8 v4, v90, v6, v4
    v_msad_u8 v5, v91, v6, v5
    v_pk_add_f32 v[160:161], v[160:161], v[88:89]
    v_pk_add_f32 v[162:163], v[162:163], v[90:91]
    v_msad_u8 v4, v92, v6, v4
    v_msad_u8 v5, v93, v6, v5
    v_msad_u8 v4, v94, v6, v4
    v_msad_u8 v5, v95, v6, v5
    v_pk_add_f32 v[160:161], v[160:161], v[92:93]
    v_pk_add_f32 v[162:163], v[162:163], v[94:95]
    v_msad_u8 v4, v96, v6, v4
    v_msad_u8 v5, v97, v6, v5
    v_msad_u8 v4, v98, v6, v4
    v_msad_u8 v5, v99, v6, v5
    v_pk_add_f32 v[160:161], v[160:161], v[96:97]
    v_pk_add_f32 v[162:163], v[162:163], v[98:99]
    v_msad_u8 v4, v100, v6, v4
    v_msad_u8 v5, v101, v6, v5
    v_msad_u8 v4, v102, v6, v4
    v_msad_u8 v5, v103, v6, v5
    v_pk_add_f32 v[160:161], v[160:161], v[100:101]
    v_pk_add_f32 v[162:163], v[162:163], v[102:103]
    v_msad_u8 v4, v104, v6, v4
    v_msad_u8 v5, v105, v6, v5
    v_msad_u8 v4, v106, v6, v4
    v_msad_u8 v5, v107, v6, v5
    v_pk_add_f32 v[160:161], v[160:161], v[104:105]
    v_pk_add_f32 v[162:163], v[162:163], v[106:107]
    v_msad_u8 v4, v108, v6, v4
    v_msad_u8 v5, v109, v6, v5
    v_msad_u8 v4, v110, v6, v4
    v_msad_u8 v5, v111, v6, v5
    v_pk_add_f32 v[160:161], v[160:161], v[108:109]
    v_pk_add_f32 v[162:163], v[162:163], v[110:111]
    v_msad_u8 v4, v112, v6, v4
    v_msad_u8 v5, v113, v6, v5
    v_msad_u8 v4, v114, v6, v4
    v_msad_u8 v5, v115, v6, v5
    v_pk_add_f32 v[160:161], v[160:161], v[112:113]
    v_pk_add_f32 v[162:163], v[162:163], v[114:115]
    v_msad_u8 v4, v116, v6, v4
    v_msad_u8 v5, v117, v6, v5
    v_msad_u8 v4, v118, v6, v4
    v_msad_u8 v5, v119, v6, v5
    v_pk_add_f32 v[160:161], v[160:161], v[116:117]
    v_pk_add_f32 v[162:163], v[162:163], v[118:119]
    v_msad_u8 v4, v120, v6, v4
    v_msad_u8 v5, v121, v6, v5
    v_msad_u8 v4, v122, v6, v4
    v_msad_u8 v5, v123, v6, v5
    v_pk_add_f32 v[160:161], v[160:161], v[120:121]
    v_pk_add_f32 v[162:163], v[162:163], v[122:123]
    v_msad_u8 v4, v124, v6, v4
    v_msad_u8 v5, v125, v6, v5
    v_msad_u8 v4, v126, v6, v4
    v_msad_u8 v5, v127, v6, v5
    v_pk_add_f32 v[160:161], v[160:161], v[124:125]
    v_pk_add_f32 v[162:163], v[162:163], v[126:127]
    v_msad_u8 v4, v128, v6, v4
    v_msad_u8 v5, v129, v6, v5
    v_msad_u8 v4, v130, v6, v4
    v_msad_u8 v5, v131, v6, v5
    v_pk_add_f32 v[160:161], v[160:161], v[128:129]
    v_pk_add_f32 v[162:163], v[162:163], v[130:131]
    v_msad_u8 v4, v132, v6, v4
    v_msad_u8 v5, v133, v6, v5
    v_msad_u8 v4, v134, v6, v4
    v_msad_u8 v5, v135, v6, v5
    v_pk_add_f32 v[160:161], v[160:161], v[132:133]
    v_pk_add_f32 v[162:163], v[162:163], v[134:135]
    v_msad_u8 v4, v136, v6, v4
    v_msad_u8 v5, v137, v6, v5
    v_msad_u8 v4, v138, v6, v4
    v_msad_u8 v5, v139, v6, v5
    v_or_b32 v4, v4, v5
    v_cmp_ne_u32 vcc, 0, v4
    s_cbranch_vccnz L_kvretry_11
L_kvok_11:
    v_add_f32_dpp v136, v136, v136 row_ror:8 row_mask:0xf bank_mask:0xf
    v_add_f32_dpp v137, v137, v137 row_ror:8 row_mask:0xf bank_mask:0xf
    v_add_f32_dpp v138, v138, v138 row_ror:8 row_mask:0xf bank_mask:0xf
    v_add_f32_dpp v139, v139, v139 row_ror:8 row_mask:0xf bank_mask:0xf
    v_add_f32_dpp v136, v136, v136 row_ror:4 row_mask:0xf bank_mask:0xf
    v_add_f32_dpp v137, v137, v137 row_ror:4 row_mask:0xf bank_mask:0xf
    v_add_f32_dpp v138, v138, v138 row_ror:4 row_mask:0xf bank_mask:0xf
    v_add_f32_dpp v139, v139, v139 row_ror:4 row_mask:0xf bank_mask:0xf
    v_add_f32_dpp v136, v136, v136 row_ror:2 row_mask:0xf bank_mask:0xf
    v_add_f32_dpp v137, v137, v137 row_ror:2 row_mask:0xf bank_mask:0xf
    v_add_f32_dpp v138, v138, v138 row_ror:2 row_mask:0xf bank_mask:0xf
    v_add_f32_dpp v139, v139, v139 row_ror:2 row_mask:0xf bank_mask:0xf
    v_add_f32_dpp v136, v136, v136 row_ror:1 row_mask:0xf bank_mask:0xf
    v_add_f32_dpp v137, v137, v137 row_ror:1 row_mask:0xf bank_mask:0xf
    v_add_f32_dpp v138, v138, v138 row_ror:1 row_mask:0xf bank_mask:0xf
    v_add_f32_dpp v139, v139, v139 row_ror:1 row_mask:0xf bank_mask:0xf
    v_cvt_pk_bf16_f32 v148, v160, v161
    v_cvt_pk_bf16_f32 v149, v162, v163
    v_cvt_pk_bf16_f32 v150, v136, v137
    v_cvt_pk_bf16_f32 v151, v138, v139
    ds_write_b128 v9, v[148:151] offset:5120
    s_nop 0
    v_mfma_f32_16x16x16_bf16 v[200:203], v[150:151], v[248:249], 0
    v_mfma_f32_16x16x16_bf16 v[88:91], v[148:149], v[248:249], 0
    v_mfma_f32_16x16x16_bf16 v[204:207], v[150:151], v[250:251], 0
    v_mfma_f32_16x16x16_bf16 v[92:95], v[148:149], v[250:251], 0
    v_mfma_f32_16x16x16_bf16 v[208:211], v[150:151], v[252:253], 0
    v_mfma_f32_16x16x16_bf16 v[96:99], v[148:149], v[252:253], 0
    v_mfma_f32_16x16x16_bf16 v[212:215], v[150:151], v[254:255], 0
    v_mfma_f32_16x16x16_bf16 v[100:103], v[148:149], v[254:255], 0
    s_waitcnt lgkmcnt(0)
    s_barrier
    ds_read_b128 v[144:147], v9 offset:4096
    v_add_f32 v200, s64, v200
    v_add_f32 v204, s64, v204
    v_add_f32 v208, s64, v208
    s_nop 0
    v_add_f32 v212, s64, v212
    v_rcp_f32 v200, v200
    v_rcp_f32 v204, v204
    v_rcp_f32 v208, v208
    v_rcp_f32 v212, v212
    v_pk_mul_f32 v[88:89], v[88:89], v[200:201] op_sel_hi:[1,0]
    v_pk_mul_f32 v[90:91], v[90:91], v[200:201] op_sel_hi:[1,0]
    v_pk_mul_f32 v[92:93], v[92:93], v[204:205] op_sel_hi:[1,0]
    v_pk_mul_f32 v[94:95], v[94:95], v[204:205] op_sel_hi:[1,0]
    v_pk_mul_f32 v[96:97], v[96:97], v[208:209] op_sel_hi:[1,0]
    v_pk_mul_f32 v[98:99], v[98:99], v[208:209] op_sel_hi:[1,0]
    v_pk_mul_f32 v[100:101], v[100:101], v[212:213] op_sel_hi:[1,0]
    v_pk_mul_f32 v[102:103], v[102:103], v[212:213] op_sel_hi:[1,0]
    v_cvt_pk_bf16_f32 v122, v88, v89
    v_cvt_pk_bf16_f32 v123, v90, v91
    v_cvt_pk_bf16_f32 v126, v92, v93
    v_cvt_pk_bf16_f32 v127, v94, v95
    v_cvt_pk_bf16_f32 v130, v96, v97
    v_cvt_pk_bf16_f32 v131, v98, v99
    v_cvt_pk_bf16_f32 v134, v100, v101
    v_cvt_pk_bf16_f32 v135, v102, v103
    s_waitcnt lgkmcnt(0)
    v_mfma_f32_16x16x16_bf16 v[184:187], v[146:147], v[240:241], 0
    v_mfma_f32_16x16x16_bf16 v[72:75], v[144:145], v[240:241], 0
    v_mfma_f32_16x16x16_bf16 v[188:191], v[146:147], v[242:243], 0
    v_mfma_f32_16x16x16_bf16 v[76:79], v[144:145], v[242:243], 0
    v_mfma_f32_16x16x16_bf16 v[192:195], v[146:147], v[244:245], 0
    v_mfma_f32_16x16x16_bf16 v[80:83], v[144:145], v[244:245], 0
    v_mfma_f32_16x16x16_bf16 v[196:199], v[146:147], v[246:247], 0
    v_mfma_f32_16x16x16_bf16 v[84:87], v[144:145], v[246:247], 0
    s_nop 0
    v_add_f32 v184, s64, v184
    s_nop 0
    v_add_f32 v188, s64, v188
    s_nop 0
    v_add_f32 v192, s64, v192
    s_nop 0
    v_add_f32 v196, s64, v196
    v_rcp_f32 v184, v184
    v_rcp_f32 v188, v188
    v_rcp_f32 v192, v192
    v_rcp_f32 v196, v196
    v_pk_mul_f32 v[72:73], v[72:73], v[184:185] op_sel_hi:[1,0]
    v_pk_mul_f32 v[74:75], v[74:75], v[184:185] op_sel_hi:[1,0]
    v_pk_mul_f32 v[76:77], v[76:77], v[188:189] op_sel_hi:[1,0]
    v_pk_mul_f32 v[78:79], v[78:79], v[188:189] op_sel_hi:[1,0]
    v_pk_mul_f32 v[80:81], v[80:81], v[192:193] op_sel_hi:[1,0]
    v_pk_mul_f32 v[82:83], v[82:83], v[192:193] op_sel_hi:[1,0]
    v_pk_mul_f32 v[84:85], v[84:85], v[196:197] op_sel_hi:[1,0]
    v_pk_mul_f32 v[86:87], v[86:87], v[196:197] op_sel_hi:[1,0]
    v_cvt_pk_bf16_f32 v120, v72, v73
    v_cvt_pk_bf16_f32 v121, v74, v75
    v_cvt_pk_bf16_f32 v124, v76, v77
    v_cvt_pk_bf16_f32 v125, v78, v79
    v_cvt_pk_bf16_f32 v128, v80, v81
    v_cvt_pk_bf16_f32 v129, v82, v83
    v_cvt_pk_bf16_f32 v132, v84, v85
    v_cvt_pk_bf16_f32 v133, v86, v87
    s_add_u32 s60, s4, 0
    buffer_store_dwordx4 v[120:123], v46, s[32:35], s60 offen sc1
    s_add_u32 s60, s4, 16384
    buffer_store_dwordx4 v[124:127], v46, s[32:35], s60 offen sc1
    s_add_u32 s60, s4, 32768
    buffer_store_dwordx4 v[128:131], v46, s[32:35], s60 offen sc1
    s_add_u32 s60, s4, 49152
    buffer_store_dwordx4 v[132:135], v46, s[32:35], s60 offen sc1
    s_branch L_phase2
L_phase2:
    v_and_b32 v2, 15, v1
    v_lshrrev_b32 v3, 4, v1
    v_lshrrev_b32 v4, 2, v2
    v_and_b32 v5, 3, v2
    v_lshl_add_u32 v6, v3, 2, v4
    v_and_b32 v7, 7, v6
    v_lshlrev_b32 v6, 8, v6
    v_lshl_add_u32 v6, v5, 3, v6
    v_lshl_add_u32 v6, v7, 5, v6
    v_xor_b32 v20, 0, v6
    v_add_u32 v21, 65536, v20
    v_xor_b32 v22, 32, v6
    v_add_u32 v23, 65536, v22
    v_xor_b32 v24, 64, v6
    v_add_u32 v25, 65536, v24
    v_xor_b32 v26, 96, v6
    v_add_u32 v27, 65536, v26
    v_xor_b32 v28, 128, v6
    v_add_u32 v29, 65536, v28
    v_xor_b32 v30, 160, v6
    v_add_u32 v31, 65536, v30
    v_xor_b32 v32, 192, v6
    v_add_u32 v33, 65536, v32
    v_xor_b32 v34, 224, v6
    v_add_u32 v35, 65536, v34
    s_add_u32 s58, s36, 1
    v_mov_b32 v6, s58
    v_mov_b32 v7, s37
    v_mov_b32 v5, 0
    v_lshlrev_b32 v8, 3, v2
    v_lshlrev_b32 v2, 12, v2
    v_and_b32 v4, 1, v3
    v_lshl_add_u32 v2, v4, 5, v2
    v_lshrrev_b32 v4, 1, v3
    v_lshl_add_u32 v2, v4, 4, v2
    s_lshl_b32 s54, s49, 18
    s_lshr_b32 s59, s50, 2
    s_lshl_b32 s59, s59, 17
    s_add_u32 s54, s54, s59
    s_lshl_b32 s59, s52, 16
    s_add_u32 s54, s54, s59
    s_lshl_b32 s59, s53, 11
    s_add_u32 s54, s54, s59
    s_lshl_b32 s59, s48, 10
    s_add_u32 s54, s54, s59
    s_and_b32 s59, s50, 3
    s_lshl_b32 s59, s59, 8
    s_add_u32 s54, s54, s59
    ds_read_b64_tr_b16 a[0:1], v21 offset:2048
    ds_read_b64_tr_b16 a[2:3], v21 offset:6144
    ds_read_b64_tr_b16 a[4:5], v23 offset:2048
    ds_read_b64_tr_b16 a[6:7], v23 offset:6144
    ds_read_b64_tr_b16 a[8:9], v25 offset:2048
    ds_read_b64_tr_b16 a[10:11], v25 offset:6144
    ds_read_b64_tr_b16 a[12:13], v27 offset:2048
    ds_read_b64_tr_b16 a[14:15], v27 offset:6144
    ds_read_b64_tr_b16 a[16:17], v29 offset:2048
    ds_read_b64_tr_b16 a[18:19], v29 offset:6144
    ds_read_b64_tr_b16 a[20:21], v31 offset:2048
    ds_read_b64_tr_b16 a[22:23], v31 offset:6144
    s_waitcnt lgkmcnt(8)
    ds_read_b64_tr_b16 a[24:25], v33 offset:2048
    ds_read_b64_tr_b16 a[26:27], v33 offset:6144
    ds_read_b64_tr_b16 a[28:29], v35 offset:2048
    ds_read_b64_tr_b16 a[30:31], v35 offset:6144
    s_waitcnt lgkmcnt(8)
    ds_read_b64_tr_b16 a[32:33], v21 offset:10240
    ds_read_b64_tr_b16 a[34:35], v21 offset:14336
    ds_read_b64_tr_b16 a[36:37], v23 offset:10240
    ds_read_b64_tr_b16 a[38:39], v23 offset:14336
    s_waitcnt lgkmcnt(8)
    ds_read_b64_tr_b16 a[40:41], v25 offset:10240
    ds_read_b64_tr_b16 a[42:43], v25 offset:14336
    ds_read_b64_tr_b16 a[44:45], v27 offset:10240
    ds_read_b64_tr_b16 a[46:47], v27 offset:14336
    s_waitcnt lgkmcnt(8)
    ds_read_b64_tr_b16 a[48:49], v29 offset:10240
    ds_read_b64_tr_b16 a[50:51], v29 offset:14336
    ds_read_b64_tr_b16 a[52:53], v31 offset:10240
    ds_read_b64_tr_b16 a[54:55], v31 offset:14336
    s_waitcnt lgkmcnt(8)
    ds_read_b64_tr_b16 a[56:57], v33 offset:10240
    ds_read_b64_tr_b16 a[58:59], v33 offset:14336
    ds_read_b64_tr_b16 a[60:61], v35 offset:10240
    ds_read_b64_tr_b16 a[62:63], v35 offset:14336
    s_waitcnt lgkmcnt(8)
    ds_read_b64_tr_b16 a[64:65], v21 offset:18432
    ds_read_b64_tr_b16 a[66:67], v21 offset:22528
    ds_read_b64_tr_b16 a[68:69], v23 offset:18432
    ds_read_b64_tr_b16 a[70:71], v23 offset:22528
    s_waitcnt lgkmcnt(8)
    ds_read_b64_tr_b16 a[72:73], v25 offset:18432
    ds_read_b64_tr_b16 a[74:75], v25 offset:22528
    ds_read_b64_tr_b16 a[76:77], v27 offset:18432
    ds_read_b64_tr_b16 a[78:79], v27 offset:22528
    s_waitcnt lgkmcnt(8)
    ds_read_b64_tr_b16 a[80:81], v29 offset:18432
    ds_read_b64_tr_b16 a[82:83], v29 offset:22528
    ds_read_b64_tr_b16 a[84:85], v31 offset:18432
    ds_read_b64_tr_b16 a[86:87], v31 offset:22528
    s_waitcnt lgkmcnt(8)
    ds_read_b64_tr_b16 a[88:89], v33 offset:18432
    ds_read_b64_tr_b16 a[90:91], v33 offset:22528
    ds_read_b64_tr_b16 a[92:93], v35 offset:18432
    ds_read_b64_tr_b16 a[94:95], v35 offset:22528
    s_waitcnt lgkmcnt(8)
    ds_read_b64_tr_b16 a[96:97], v21 offset:26624
    ds_read_b64_tr_b16 a[98:99], v21 offset:30720
    ds_read_b64_tr_b16 a[100:101], v23 offset:26624
    ds_read_b64_tr_b16 a[102:103], v23 offset:30720
    s_waitcnt lgkmcnt(8)
    ds_read_b64_tr_b16 a[104:105], v25 offset:26624
    ds_read_b64_tr_b16 a[106:107], v25 offset:30720
    ds_read_b64_tr_b16 a[108:109], v27 offset:26624
    ds_read_b64_tr_b16 a[110:111], v27 offset:30720
    s_waitcnt lgkmcnt(8)
    ds_read_b64_tr_b16 a[112:113], v29 offset:26624
    ds_read_b64_tr_b16 a[114:115], v29 offset:30720
    ds_read_b64_tr_b16 a[116:117], v31 offset:26624
    ds_read_b64_tr_b16 a[118:119], v31 offset:30720
    s_waitcnt lgkmcnt(8)
    ds_read_b64_tr_b16 a[120:121], v33 offset:26624
    ds_read_b64_tr_b16 a[122:123], v33 offset:30720
    ds_read_b64_tr_b16 a[124:125], v35 offset:26624
    ds_read_b64_tr_b16 a[126:127], v35 offset:30720
    s_waitcnt lgkmcnt(8)
    ds_read_b64_tr_b16 a[128:129], v21 offset:34816
    ds_read_b64_tr_b16 a[130:131], v21 offset:38912
    ds_read_b64_tr_b16 a[132:133], v23 offset:34816
    ds_read_b64_tr_b16 a[134:135], v23 offset:38912
    s_waitcnt lgkmcnt(8)
    ds_read_b64_tr_b16 a[136:137], v25 offset:34816
    ds_read_b64_tr_b16 a[138:139], v25 offset:38912
    ds_read_b64_tr_b16 a[140:141], v27 offset:34816
    ds_read_b64_tr_b16 a[142:143], v27 offset:38912
    s_waitcnt lgkmcnt(8)
    ds_read_b64_tr_b16 a[144:145], v29 offset:34816
    ds_read_b64_tr_b16 a[146:147], v29 offset:38912
    ds_read_b64_tr_b16 a[148:149], v31 offset:34816
    ds_read_b64_tr_b16 a[150:151], v31 offset:38912
    s_waitcnt lgkmcnt(8)
    ds_read_b64_tr_b16 a[152:153], v33 offset:34816
    ds_read_b64_tr_b16 a[154:155], v33 offset:38912
    ds_read_b64_tr_b16 a[156:157], v35 offset:34816
    ds_read_b64_tr_b16 a[158:159], v35 offset:38912
    s_waitcnt lgkmcnt(8)
    ds_read_b64_tr_b16 a[160:161], v21 offset:43008
    ds_read_b64_tr_b16 a[162:163], v21 offset:47104
    ds_read_b64_tr_b16 a[164:165], v23 offset:43008
    ds_read_b64_tr_b16 a[166:167], v23 offset:47104
    s_waitcnt lgkmcnt(8)
    ds_read_b64_tr_b16 a[168:169], v25 offset:43008
    ds_read_b64_tr_b16 a[170:171], v25 offset:47104
    ds_read_b64_tr_b16 a[172:173], v27 offset:43008
    ds_read_b64_tr_b16 a[174:175], v27 offset:47104
    s_waitcnt lgkmcnt(8)
    ds_read_b64_tr_b16 a[176:177], v29 offset:43008
    ds_read_b64_tr_b16 a[178:179], v29 offset:47104
    ds_read_b64_tr_b16 a[180:181], v31 offset:43008
    ds_read_b64_tr_b16 a[182:183], v31 offset:47104
    s_waitcnt lgkmcnt(8)
    ds_read_b64_tr_b16 a[184:185], v33 offset:43008
    ds_read_b64_tr_b16 a[186:187], v33 offset:47104
    ds_read_b64_tr_b16 a[188:189], v35 offset:43008
    ds_read_b64_tr_b16 a[190:191], v35 offset:47104
    s_waitcnt lgkmcnt(8)
    s_waitcnt vmcnt(0)
    s_mov_b64 exec, 1
    buffer_store_dwordx2 v[6:7], v5, s[32:35], s12 offen sc1
    s_mov_b64 exec, -1
    ds_read_b64_tr_b16 a[192:193], v21 offset:51200
    ds_read_b64_tr_b16 a[194:195], v21 offset:55296
    ds_read_b64_tr_b16 a[196:197], v23 offset:51200
    ds_read_b64_tr_b16 a[198:199], v23 offset:55296
    s_waitcnt lgkmcnt(8)
    ds_read_b64_tr_b16 a[200:201], v25 offset:51200
    ds_read_b64_tr_b16 a[202:203], v25 offset:55296
    ds_read_b64_tr_b16 a[204:205], v27 offset:51200
    ds_read_b64_tr_b16 a[206:207], v27 offset:55296
    s_waitcnt lgkmcnt(8)
    ds_read_b64_tr_b16 a[208:209], v29 offset:51200
    ds_read_b64_tr_b16 a[210:211], v29 offset:55296
    ds_read_b64_tr_b16 a[212:213], v31 offset:51200
    ds_read_b64_tr_b16 a[214:215], v31 offset:55296
    s_waitcnt lgkmcnt(8)
    ds_read_b64_tr_b16 a[216:217], v33 offset:51200
    ds_read_b64_tr_b16 a[218:219], v33 offset:55296
    ds_read_b64_tr_b16 a[220:221], v35 offset:51200
    ds_read_b64_tr_b16 a[222:223], v35 offset:55296
    s_waitcnt lgkmcnt(8)
    ds_read_b64_tr_b16 a[224:225], v21 offset:59392
    ds_read_b64_tr_b16 a[226:227], v21 offset:63488
    ds_read_b64_tr_b16 a[228:229], v23 offset:59392
    ds_read_b64_tr_b16 a[230:231], v23 offset:63488
    s_waitcnt lgkmcnt(8)
    ds_read_b64_tr_b16 a[232:233], v25 offset:59392
    ds_read_b64_tr_b16 a[234:235], v25 offset:63488
    ds_read_b64_tr_b16 a[236:237], v27 offset:59392
    ds_read_b64_tr_b16 a[238:239], v27 offset:63488
    s_waitcnt lgkmcnt(8)
    ds_read_b64_tr_b16 a[240:241], v29 offset:59392
    ds_read_b64_tr_b16 a[242:243], v29 offset:63488
    ds_read_b64_tr_b16 a[244:245], v31 offset:59392
    ds_read_b64_tr_b16 a[246:247], v31 offset:63488
    s_waitcnt lgkmcnt(8)
    ds_read_b64_tr_b16 a[248:249], v33 offset:59392
    ds_read_b64_tr_b16 a[250:251], v33 offset:63488
    ds_read_b64_tr_b16 a[252:253], v35 offset:59392
    ds_read_b64_tr_b16 a[254:255], v35 offset:63488
    s_waitcnt lgkmcnt(8)
    s_waitcnt vmcnt(1)
    s_barrier
    ds_read_b64_tr_b16 v[160:161], v20 offset:0
    ds_read_b64_tr_b16 v[162:163], v20 offset:4096
    ds_read_b64_tr_b16 v[164:165], v22 offset:0
    ds_read_b64_tr_b16 v[166:167], v22 offset:4096
    s_waitcnt lgkmcnt(8)
    ds_read_b64_tr_b16 v[168:169], v24 offset:0
    ds_read_b64_tr_b16 v[170:171], v24 offset:4096
    ds_read_b64_tr_b16 v[172:173], v26 offset:0
    ds_read_b64_tr_b16 v[174:175], v26 offset:4096
    s_waitcnt lgkmcnt(8)
    ds_read_b64_tr_b16 v[176:177], v28 offset:0
    ds_read_b64_tr_b16 v[178:179], v28 offset:4096
    ds_read_b64_tr_b16 v[180:181], v30 offset:0
    ds_read_b64_tr_b16 v[182:183], v30 offset:4096
    s_waitcnt lgkmcnt(8)
    ds_read_b64_tr_b16 v[184:185], v32 offset:0
    ds_read_b64_tr_b16 v[186:187], v32 offset:4096
    ds_read_b64_tr_b16 v[188:189], v34 offset:0
    ds_read_b64_tr_b16 v[190:191], v34 offset:4096
    s_waitcnt lgkmcnt(8)
    ds_read_b64_tr_b16 v[192:193], v20 offset:8192
    ds_read_b64_tr_b16 v[194:195], v20 offset:12288
    ds_read_b64_tr_b16 v[196:197], v22 offset:8192
    ds_read_b64_tr_b16 v[198:199], v22 offset:12288
    s_waitcnt lgkmcnt(8)
    ds_read_b64_tr_b16 v[200:201], v24 offset:8192
    ds_read_b64_tr_b16 v[202:203], v24 offset:12288
    ds_read_b64_tr_b16 v[204:205], v26 offset:8192
    ds_read_b64_tr_b16 v[206:207], v26 offset:12288
    s_waitcnt lgkmcnt(8)
    ds_read_b64_tr_b16 v[208:209], v28 offset:8192
    ds_read_b64_tr_b16 v[210:211], v28 offset:12288
    ds_read_b64_tr_b16 v[212:213], v30 offset:8192
    ds_read_b64_tr_b16 v[214:215], v30 offset:12288
    s_waitcnt lgkmcnt(8)
    ds_read_b64_tr_b16 v[216:217], v32 offset:8192
    ds_read_b64_tr_b16 v[218:219], v32 offset:12288
    ds_read_b64_tr_b16 v[220:221], v34 offset:8192
    ds_read_b64_tr_b16 v[222:223], v34 offset:12288
    s_waitcnt lgkmcnt(8)
    ds_read_b64_tr_b16 v[224:225], v20 offset:16384
    ds_read_b64_tr_b16 v[226:227], v20 offset:20480
    ds_read_b64_tr_b16 v[228:229], v22 offset:16384
    ds_read_b64_tr_b16 v[230:231], v22 offset:20480
    s_waitcnt lgkmcnt(8)
    ds_read_b64_tr_b16 v[232:233], v24 offset:16384
    ds_read_b64_tr_b16 v[234:235], v24 offset:20480
    ds_read_b64_tr_b16 v[236:237], v26 offset:16384
    ds_read_b64_tr_b16 v[238:239], v26 offset:20480
    s_waitcnt lgkmcnt(8)
    ds_read_b64_tr_b16 v[240:241], v28 offset:16384
    ds_read_b64_tr_b16 v[242:243], v28 offset:20480
    ds_read_b64_tr_b16 v[244:245], v30 offset:16384
    ds_read_b64_tr_b16 v[246:247], v30 offset:20480
    s_waitcnt lgkmcnt(8)
    ds_read_b64_tr_b16 v[248:249], v32 offset:16384
    ds_read_b64_tr_b16 v[250:251], v32 offset:20480
    ds_read_b64_tr_b16 v[252:253], v34 offset:16384
    ds_read_b64_tr_b16 v[254:255], v34 offset:20480
    s_waitcnt lgkmcnt(8)
    s_waitcnt lgkmcnt(0)
    s_cmp_lg_u32 s51, 0
    s_cbranch_scc1 L_ook
    s_branch L_opoll1
L_opoll:
    s_sub_u32 s71, s71, 1
    s_cbranch_scc1 L_ook
    s_sleep 3
L_opoll1:
    buffer_load_dwordx2 v[10:11], v8, s[32:35], s11 offen sc1
    s_waitcnt vmcnt(0)
    v_cmp_ne_u64 vcc, v[10:11], v[6:7]
    s_cbranch_vccnz L_opoll
L_ook:
    s_waitcnt vmcnt(0)
    s_barrier
    s_add_u32 s60, s8, 0
    buffer_load_dwordx4 v[64:67], v46, s[32:35], s60 offen offset:0 sc1
    buffer_load_dwordx4 v[68:71], v46, s[32:35], s60 offen offset:1024 sc1
    buffer_load_dwordx4 v[72:75], v46, s[32:35], s60 offen offset:2048 sc1
    buffer_load_dwordx4 v[76:79], v46, s[32:35], s60 offen offset:3072 sc1
    s_add_u32 s60, s8, 4096
    buffer_load_dwordx4 v[80:83], v46, s[32:35], s60 offen offset:0 sc1
    buffer_load_dwordx4 v[84:87], v46, s[32:35], s60 offen offset:1024 sc1
    buffer_load_dwordx4 v[88:91], v46, s[32:35], s60 offen offset:2048 sc1
    buffer_load_dwordx4 v[92:95], v46, s[32:35], s60 offen offset:3072 sc1
    s_waitcnt vmcnt(7)
    v_mfma_f32_16x16x32_bf16 v[128:131], a[0:3], v[64:67], 0
    s_add_u32 s60, s8, 8192
    buffer_load_dwordx4 v[96:99], v46, s[32:35], s60 offen offset:0 sc1
    v_mfma_f32_16x16x32_bf16 v[132:135], a[4:7], v[64:67], 0
    v_mfma_f32_16x16x32_bf16 v[136:139], a[8:11], v[64:67], 0
    v_mfma_f32_16x16x32_bf16 v[140:143], a[12:15], v[64:67], 0
    buffer_load_dwordx4 v[100:103], v46, s[32:35], s60 offen offset:1024 sc1
    v_mfma_f32_16x16x32_bf16 v[144:147], a[16:19], v[64:67], 0
    v_mfma_f32_16x16x32_bf16 v[148:151], a[20:23], v[64:67], 0
    v_mfma_f32_16x16x32_bf16 v[152:155], a[24:27], v[64:67], 0
    buffer_load_dwordx4 v[104:107], v46, s[32:35], s60 offen offset:2048 sc1
    v_mfma_f32_16x16x32_bf16 v[156:159], a[28:31], v[64:67], 0
    s_waitcnt vmcnt(9)
    v_mfma_f32_16x16x32_bf16 v[128:131], a[32:35], v[68:71], v[128:131]
    buffer_load_dwordx4 v[108:111], v46, s[32:35], s60 offen offset:3072 sc1
    v_mfma_f32_16x16x32_bf16 v[132:135], a[36:39], v[68:71], v[132:135]
    ds_read_b64_tr_b16 a[0:1], v20 offset:24576
    v_mfma_f32_16x16x32_bf16 v[136:139], a[40:43], v[68:71], v[136:139]
    ds_read_b64_tr_b16 a[2:3], v20 offset:28672
    v_mfma_f32_16x16x32_bf16 v[140:143], a[44:47], v[68:71], v[140:143]
    s_add_u32 s60, s8, 12288
    buffer_load_dwordx4 v[112:115], v46, s[32:35], s60 offen offset:0 sc1
    v_mfma_f32_16x16x32_bf16 v[144:147], a[48:51], v[68:71], v[144:147]
    ds_read_b64_tr_b16 a[4:5], v22 offset:24576
    v_mfma_f32_16x16x32_bf16 v[148:151], a[52:55], v[68:71], v[148:151]
    ds_read_b64_tr_b16 a[6:7], v22 offset:28672
    v_mfma_f32_16x16x32_bf16 v[152:155], a[56:59], v[68:71], v[152:155]
    buffer_load_dwordx4 v[116:119], v46, s[32:35], s60 offen offset:1024 sc1
    v_mfma_f32_16x16x32_bf16 v[156:159], a[60:63], v[68:71], v[156:159]
    ds_read_b64_tr_b16 a[8:9], v24 offset:24576
    s_waitcnt vmcnt(11)
    v_mfma_f32_16x16x32_bf16 v[128:131], a[64:67], v[72:75], v[128:131]
    buffer_load_dwordx4 v[120:123], v46, s[32:35], s60 offen offset:2048 sc1
    v_mfma_f32_16x16x32_bf16 v[132:135], a[68:71], v[72:75], v[132:135]
    ds_read_b64_tr_b16 a[10:11], v24 offset:28672
    v_mfma_f32_16x16x32_bf16 v[136:139], a[72:75], v[72:75], v[136:139]
    ds_read_b64_tr_b16 a[12:13], v26 offset:24576
    v_mfma_f32_16x16x32_bf16 v[140:143], a[76:79], v[72:75], v[140:143]
    buffer_load_dwordx4 v[124:127], v46, s[32:35], s60 offen offset:3072 sc1
    v_mfma_f32_16x16x32_bf16 v[144:147], a[80:83], v[72:75], v[144:147]
    ds_read_b64_tr_b16 a[14:15], v26 offset:28672
    v_mfma_f32_16x16x32_bf16 v[148:151], a[84:87], v[72:75], v[148:151]
    ds_read_b64_tr_b16 a[16:17], v28 offset:24576
    v_mfma_f32_16x16x32_bf16 v[152:155], a[88:91], v[72:75], v[152:155]
    ds_read_b64_tr_b16 a[18:19], v28 offset:28672
    v_mfma_f32_16x16x32_bf16 v[156:159], a[92:95], v[72:75], v[156:159]
    ds_read_b64_tr_b16 a[20:21], v30 offset:24576
    s_waitcnt vmcnt(12)
    v_mfma_f32_16x16x32_bf16 v[128:131], a[96:99], v[76:79], v[128:131]
    ds_read_b64_tr_b16 a[22:23], v30 offset:28672
    v_mfma_f32_16x16x32_bf16 v[132:135], a[100:103], v[76:79], v[132:135]
    ds_read_b64_tr_b16 a[24:25], v32 offset:24576
    v_mfma_f32_16x16x32_bf16 v[136:139], a[104:107], v[76:79], v[136:139]
    ds_read_b64_tr_b16 a[26:27], v32 offset:28672
    v_mfma_f32_16x16x32_bf16 v[140:143], a[108:111], v[76:79], v[140:143]
    ds_read_b64_tr_b16 a[28:29], v34 offset:24576
    v_mfma_f32_16x16x32_bf16 v[144:147], a[112:115], v[76:79], v[144:147]
    ds_read_b64_tr_b16 a[30:31], v34 offset:28672
    v_mfma_f32_16x16x32_bf16 v[148:151], a[116:119], v[76:79], v[148:151]
    ds_read_b64_tr_b16 a[32:33], v20 offset:32768
    v_mfma_f32_16x16x32_bf16 v[152:155], a[120:123], v[76:79], v[152:155]
    ds_read_b64_tr_b16 a[34:35], v20 offset:36864
    v_mfma_f32_16x16x32_bf16 v[156:159], a[124:127], v[76:79], v[156:159]
    ds_read_b64_tr_b16 a[36:37], v22 offset:32768
    s_waitcnt vmcnt(11)
    v_mfma_f32_16x16x32_bf16 v[128:131], a[128:131], v[80:83], v[128:131]
    ds_read_b64_tr_b16 a[38:39], v22 offset:36864
    v_mfma_f32_16x16x32_bf16 v[132:135], a[132:135], v[80:83], v[132:135]
    ds_read_b64_tr_b16 a[40:41], v24 offset:32768
    v_mfma_f32_16x16x32_bf16 v[136:139], a[136:139], v[80:83], v[136:139]
    ds_read_b64_tr_b16 a[42:43], v24 offset:36864
    v_mfma_f32_16x16x32_bf16 v[140:143], a[140:143], v[80:83], v[140:143]
    ds_read_b64_tr_b16 a[44:45], v26 offset:32768
    v_mfma_f32_16x16x32_bf16 v[144:147], a[144:147], v[80:83], v[144:147]
    ds_read_b64_tr_b16 a[46:47], v26 offset:36864
    v_mfma_f32_16x16x32_bf16 v[148:151], a[148:151], v[80:83], v[148:151]
    ds_read_b64_tr_b16 a[48:49], v28 offset:32768
    v_mfma_f32_16x16x32_bf16 v[152:155], a[152:155], v[80:83], v[152:155]
    ds_read_b64_tr_b16 a[50:51], v28 offset:36864
    v_mfma_f32_16x16x32_bf16 v[156:159], a[156:159], v[80:83], v[156:159]
    ds_read_b64_tr_b16 a[52:53], v30 offset:32768
    s_waitcnt vmcnt(10)
    v_mfma_f32_16x16x32_bf16 v[128:131], a[160:163], v[84:87], v[128:131]
    ds_read_b64_tr_b16 a[54:55], v30 offset:36864
    v_mfma_f32_16x16x32_bf16 v[132:135], a[164:167], v[84:87], v[132:135]
    ds_read_b64_tr_b16 a[56:57], v32 offset:32768
    v_mfma_f32_16x16x32_bf16 v[136:139], a[168:171], v[84:87], v[136:139]
    ds_read_b64_tr_b16 a[58:59], v32 offset:36864
    v_mfma_f32_16x16x32_bf16 v[140:143], a[172:175], v[84:87], v[140:143]
    ds_read_b64_tr_b16 a[60:61], v34 offset:32768
    v_mfma_f32_16x16x32_bf16 v[144:147], a[176:179], v[84:87], v[144:147]
    ds_read_b64_tr_b16 a[62:63], v34 offset:36864
    v_mfma_f32_16x16x32_bf16 v[148:151], a[180:183], v[84:87], v[148:151]
    ds_read_b64_tr_b16 a[64:65], v20 offset:40960
    v_mfma_f32_16x16x32_bf16 v[152:155], a[184:187], v[84:87], v[152:155]
    ds_read_b64_tr_b16 a[66:67], v20 offset:45056
    v_mfma_f32_16x16x32_bf16 v[156:159], a[188:191], v[84:87], v[156:159]
    ds_read_b64_tr_b16 a[68:69], v22 offset:40960
    s_waitcnt vmcnt(9)
    v_mfma_f32_16x16x32_bf16 v[128:131], a[192:195], v[88:91], v[128:131]
    ds_read_b64_tr_b16 a[70:71], v22 offset:45056
    v_mfma_f32_16x16x32_bf16 v[132:135], a[196:199], v[88:91], v[132:135]
    ds_read_b64_tr_b16 a[72:73], v24 offset:40960
    v_mfma_f32_16x16x32_bf16 v[136:139], a[200:203], v[88:91], v[136:139]
    ds_read_b64_tr_b16 a[74:75], v24 offset:45056
    v_mfma_f32_16x16x32_bf16 v[140:143], a[204:207], v[88:91], v[140:143]
    ds_read_b64_tr_b16 a[76:77], v26 offset:40960
    v_mfma_f32_16x16x32_bf16 v[144:147], a[208:211], v[88:91], v[144:147]
    ds_read_b64_tr_b16 a[78:79], v26 offset:45056
    v_mfma_f32_16x16x32_bf16 v[148:151], a[212:215], v[88:91], v[148:151]
    ds_read_b64_tr_b16 a[80:81], v28 offset:40960
    v_mfma_f32_16x16x32_bf16 v[152:155], a[216:219], v[88:91], v[152:155]
    ds_read_b64_tr_b16 a[82:83], v28 offset:45056
    v_mfma_f32_16x16x32_bf16 v[156:159], a[220:223], v[88:91], v[156:159]
    ds_read_b64_tr_b16 a[84:85], v30 offset:40960
    s_waitcnt vmcnt(8)
    v_mfma_f32_16x16x32_bf16 v[128:131], a[224:227], v[92:95], v[128:131]
    ds_read_b64_tr_b16 a[86:87], v30 offset:45056
    v_mfma_f32_16x16x32_bf16 v[132:135], a[228:231], v[92:95], v[132:135]
    ds_read_b64_tr_b16 a[88:89], v32 offset:40960
    v_mfma_f32_16x16x32_bf16 v[136:139], a[232:235], v[92:95], v[136:139]
    ds_read_b64_tr_b16 a[90:91], v32 offset:45056
    v_mfma_f32_16x16x32_bf16 v[140:143], a[236:239], v[92:95], v[140:143]
    ds_read_b64_tr_b16 a[92:93], v34 offset:40960
    v_mfma_f32_16x16x32_bf16 v[144:147], a[240:243], v[92:95], v[144:147]
    ds_read_b64_tr_b16 a[94:95], v34 offset:45056
    v_mfma_f32_16x16x32_bf16 v[148:151], a[244:247], v[92:95], v[148:151]
    ds_read_b64_tr_b16 a[96:97], v20 offset:49152
    v_mfma_f32_16x16x32_bf16 v[152:155], a[248:251], v[92:95], v[152:155]
    ds_read_b64_tr_b16 a[98:99], v20 offset:53248
    v_mfma_f32_16x16x32_bf16 v[156:159], a[252:255], v[92:95], v[156:159]
    ds_read_b64_tr_b16 a[100:101], v22 offset:49152
    s_waitcnt vmcnt(7)
    v_mfma_f32_16x16x32_bf16 v[128:131], v[160:163], v[96:99], v[128:131]
    ds_read_b64_tr_b16 a[102:103], v22 offset:53248
    v_mfma_f32_16x16x32_bf16 v[132:135], v[164:167], v[96:99], v[132:135]
    ds_read_b64_tr_b16 a[104:105], v24 offset:49152
    v_mfma_f32_16x16x32_bf16 v[136:139], v[168:171], v[96:99], v[136:139]
    ds_read_b64_tr_b16 a[106:107], v24 offset:53248
    v_mfma_f32_16x16x32_bf16 v[140:143], v[172:175], v[96:99], v[140:143]
    ds_read_b64_tr_b16 a[108:109], v26 offset:49152
    v_mfma_f32_16x16x32_bf16 v[144:147], v[176:179], v[96:99], v[144:147]
    ds_read_b64_tr_b16 a[110:111], v26 offset:53248
    v_mfma_f32_16x16x32_bf16 v[148:151], v[180:183], v[96:99], v[148:151]
    ds_read_b64_tr_b16 a[112:113], v28 offset:49152
    v_mfma_f32_16x16x32_bf16 v[152:155], v[184:187], v[96:99], v[152:155]
    ds_read_b64_tr_b16 a[114:115], v28 offset:53248
    v_mfma_f32_16x16x32_bf16 v[156:159], v[188:191], v[96:99], v[156:159]
    ds_read_b64_tr_b16 a[116:117], v30 offset:49152
    s_waitcnt vmcnt(6)
    v_mfma_f32_16x16x32_bf16 v[128:131], v[192:195], v[100:103], v[128:131]
    ds_read_b64_tr_b16 a[118:119], v30 offset:53248
    v_mfma_f32_16x16x32_bf16 v[132:135], v[196:199], v[100:103], v[132:135]
    ds_read_b64_tr_b16 a[120:121], v32 offset:49152
    v_mfma_f32_16x16x32_bf16 v[136:139], v[200:203], v[100:103], v[136:139]
    ds_read_b64_tr_b16 a[122:123], v32 offset:53248
    v_mfma_f32_16x16x32_bf16 v[140:143], v[204:207], v[100:103], v[140:143]
    ds_read_b64_tr_b16 a[124:125], v34 offset:49152
    v_mfma_f32_16x16x32_bf16 v[144:147], v[208:211], v[100:103], v[144:147]
    ds_read_b64_tr_b16 a[126:127], v34 offset:53248
    v_mfma_f32_16x16x32_bf16 v[148:151], v[212:215], v[100:103], v[148:151]
    ds_read_b64_tr_b16 a[128:129], v20 offset:57344
    v_mfma_f32_16x16x32_bf16 v[152:155], v[216:219], v[100:103], v[152:155]
    ds_read_b64_tr_b16 a[130:131], v20 offset:61440
    v_mfma_f32_16x16x32_bf16 v[156:159], v[220:223], v[100:103], v[156:159]
    ds_read_b64_tr_b16 a[132:133], v22 offset:57344
    s_waitcnt vmcnt(5)
    v_mfma_f32_16x16x32_bf16 v[128:131], v[224:227], v[104:107], v[128:131]
    ds_read_b64_tr_b16 a[134:135], v22 offset:61440
    v_mfma_f32_16x16x32_bf16 v[132:135], v[228:231], v[104:107], v[132:135]
    ds_read_b64_tr_b16 a[136:137], v24 offset:57344
    v_mfma_f32_16x16x32_bf16 v[136:139], v[232:235], v[104:107], v[136:139]
    ds_read_b64_tr_b16 a[138:139], v24 offset:61440
    v_mfma_f32_16x16x32_bf16 v[140:143], v[236:239], v[104:107], v[140:143]
    ds_read_b64_tr_b16 a[140:141], v26 offset:57344
    v_mfma_f32_16x16x32_bf16 v[144:147], v[240:243], v[104:107], v[144:147]
    ds_read_b64_tr_b16 a[142:143], v26 offset:61440
    v_mfma_f32_16x16x32_bf16 v[148:151], v[244:247], v[104:107], v[148:151]
    ds_read_b64_tr_b16 a[144:145], v28 offset:57344
    v_mfma_f32_16x16x32_bf16 v[152:155], v[248:251], v[104:107], v[152:155]
    ds_read_b64_tr_b16 a[146:147], v28 offset:61440
    v_mfma_f32_16x16x32_bf16 v[156:159], v[252:255], v[104:107], v[156:159]
    ds_read_b64_tr_b16 a[148:149], v30 offset:57344
    s_waitcnt vmcnt(4)
    s_waitcnt lgkmcnt(15)
    v_mfma_f32_16x16x32_bf16 v[128:131], a[0:3], v[108:111], v[128:131]
    ds_read_b64_tr_b16 a[150:151], v30 offset:61440
    s_waitcnt lgkmcnt(15)
    v_mfma_f32_16x16x32_bf16 v[132:135], a[4:7], v[108:111], v[132:135]
    ds_read_b64_tr_b16 a[152:153], v32 offset:57344
    s_waitcnt lgkmcnt(15)
    v_mfma_f32_16x16x32_bf16 v[136:139], a[8:11], v[108:111], v[136:139]
    ds_read_b64_tr_b16 a[154:155], v32 offset:61440
    s_waitcnt lgkmcnt(15)
    v_mfma_f32_16x16x32_bf16 v[140:143], a[12:15], v[108:111], v[140:143]
    ds_read_b64_tr_b16 a[156:157], v34 offset:57344
    s_waitcnt lgkmcnt(15)
    v_mfma_f32_16x16x32_bf16 v[144:147], a[16:19], v[108:111], v[144:147]
    ds_read_b64_tr_b16 a[158:159], v34 offset:61440
    s_waitcnt lgkmcnt(15)
    v_mfma_f32_16x16x32_bf16 v[148:151], a[20:23], v[108:111], v[148:151]
    s_waitcnt lgkmcnt(15)
    v_mfma_f32_16x16x32_bf16 v[152:155], a[24:27], v[108:111], v[152:155]
    s_waitcnt lgkmcnt(15)
    v_mfma_f32_16x16x32_bf16 v[156:159], a[28:31], v[108:111], v[156:159]
    s_waitcnt vmcnt(3)
    s_waitcnt lgkmcnt(15)
    v_mfma_f32_16x16x32_bf16 v[128:131], a[32:35], v[112:115], v[128:131]
    s_waitcnt lgkmcnt(15)
    v_mfma_f32_16x16x32_bf16 v[132:135], a[36:39], v[112:115], v[132:135]
    s_waitcnt lgkmcnt(15)
    v_mfma_f32_16x16x32_bf16 v[136:139], a[40:43], v[112:115], v[136:139]
    s_waitcnt lgkmcnt(15)
    v_mfma_f32_16x16x32_bf16 v[140:143], a[44:47], v[112:115], v[140:143]
    s_waitcnt lgkmcnt(15)
    v_mfma_f32_16x16x32_bf16 v[144:147], a[48:51], v[112:115], v[144:147]
    s_waitcnt lgkmcnt(15)
    v_mfma_f32_16x16x32_bf16 v[148:151], a[52:55], v[112:115], v[148:151]
    s_waitcnt lgkmcnt(15)
    v_mfma_f32_16x16x32_bf16 v[152:155], a[56:59], v[112:115], v[152:155]
    s_waitcnt lgkmcnt(15)
    v_mfma_f32_16x16x32_bf16 v[156:159], a[60:63], v[112:115], v[156:159]
    s_waitcnt vmcnt(2)
    s_waitcnt lgkmcnt(15)
    v_mfma_f32_16x16x32_bf16 v[128:131], a[64:67], v[116:119], v[128:131]
    s_waitcnt lgkmcnt(15)
    v_mfma_f32_16x16x32_bf16 v[132:135], a[68:71], v[116:119], v[132:135]
    s_waitcnt lgkmcnt(15)
    v_mfma_f32_16x16x32_bf16 v[136:139], a[72:75], v[116:119], v[136:139]
    s_waitcnt lgkmcnt(15)
    v_mfma_f32_16x16x32_bf16 v[140:143], a[76:79], v[116:119], v[140:143]
    s_waitcnt lgkmcnt(15)
    v_mfma_f32_16x16x32_bf16 v[144:147], a[80:83], v[116:119], v[144:147]
    s_waitcnt lgkmcnt(15)
    v_mfma_f32_16x16x32_bf16 v[148:151], a[84:87], v[116:119], v[148:151]
    s_waitcnt lgkmcnt(15)
    v_mfma_f32_16x16x32_bf16 v[152:155], a[88:91], v[116:119], v[152:155]
    s_waitcnt lgkmcnt(15)
    v_mfma_f32_16x16x32_bf16 v[156:159], a[92:95], v[116:119], v[156:159]
    s_waitcnt vmcnt(1)
    s_waitcnt lgkmcnt(15)
    v_mfma_f32_16x16x32_bf16 v[128:131], a[96:99], v[120:123], v[128:131]
    s_waitcnt lgkmcnt(15)
    v_mfma_f32_16x16x32_bf16 v[132:135], a[100:103], v[120:123], v[132:135]
    s_waitcnt lgkmcnt(15)
    v_mfma_f32_16x16x32_bf16 v[136:139], a[104:107], v[120:123], v[136:139]
    s_waitcnt lgkmcnt(15)
    v_mfma_f32_16x16x32_bf16 v[140:143], a[108:111], v[120:123], v[140:143]
    s_waitcnt lgkmcnt(15)
    v_mfma_f32_16x16x32_bf16 v[144:147], a[112:115], v[120:123], v[144:147]
    s_waitcnt lgkmcnt(15)
    v_mfma_f32_16x16x32_bf16 v[148:151], a[116:119], v[120:123], v[148:151]
    s_waitcnt lgkmcnt(15)
    v_mfma_f32_16x16x32_bf16 v[152:155], a[120:123], v[120:123], v[152:155]
    s_waitcnt lgkmcnt(15)
    v_mfma_f32_16x16x32_bf16 v[156:159], a[124:127], v[120:123], v[156:159]
    s_waitcnt vmcnt(0)
    s_waitcnt lgkmcnt(14)
    v_mfma_f32_16x16x32_bf16 v[128:131], a[128:131], v[124:127], v[128:131]
    s_waitcnt lgkmcnt(12)
    v_mfma_f32_16x16x32_bf16 v[132:135], a[132:135], v[124:127], v[132:135]
    s_waitcnt lgkmcnt(10)
    v_mfma_f32_16x16x32_bf16 v[136:139], a[136:139], v[124:127], v[136:139]
    s_waitcnt lgkmcnt(8)
    v_mfma_f32_16x16x32_bf16 v[140:143], a[140:143], v[124:127], v[140:143]
    s_waitcnt lgkmcnt(6)
    v_mfma_f32_16x16x32_bf16 v[144:147], a[144:147], v[124:127], v[144:147]
    s_waitcnt lgkmcnt(4)
    v_mfma_f32_16x16x32_bf16 v[148:151], a[148:151], v[124:127], v[148:151]
    s_waitcnt lgkmcnt(2)
    v_mfma_f32_16x16x32_bf16 v[152:155], a[152:155], v[124:127], v[152:155]
    s_waitcnt lgkmcnt(0)
    v_mfma_f32_16x16x32_bf16 v[156:159], a[156:159], v[124:127], v[156:159]
    s_or_b32 s60, s50, s51
    s_cmp_lg_u32 s60, 0
    s_cbranch_scc1 L_nobo
    s_mov_b64 exec, 1
    buffer_store_dword v6, v5, s[32:35], s13 offen sc1
    s_mov_b64 exec, -1
L_nobo:
    v_cvt_pk_bf16_f32 v64, v128, v129
    v_cvt_pk_bf16_f32 v65, v130, v131
    v_cvt_pk_bf16_f32 v66, v132, v133
    v_cvt_pk_bf16_f32 v67, v134, v135
    v_cvt_pk_bf16_f32 v68, v136, v137
    v_cvt_pk_bf16_f32 v69, v138, v139
    v_cvt_pk_bf16_f32 v70, v140, v141
    v_cvt_pk_bf16_f32 v71, v142, v143
    v_cvt_pk_bf16_f32 v72, v144, v145
    v_cvt_pk_bf16_f32 v73, v146, v147
    v_cvt_pk_bf16_f32 v74, v148, v149
    v_cvt_pk_bf16_f32 v75, v150, v151
    v_cvt_pk_bf16_f32 v76, v152, v153
    v_cvt_pk_bf16_f32 v77, v154, v155
    v_cvt_pk_bf16_f32 v78, v156, v157
    v_cvt_pk_bf16_f32 v79, v158, v159
    v_permlane16_swap_b32 v64, v66
    v_permlane16_swap_b32 v65, v67
    buffer_store_dwordx4 v[64:67], v2, s[44:47], s54 offen offset:0 sc1
    v_permlane16_swap_b32 v68, v70
    v_permlane16_swap_b32 v69, v71
    buffer_store_dwordx4 v[68:71], v2, s[44:47], s54 offen offset:64 sc1
    v_permlane16_swap_b32 v72, v74
    v_permlane16_swap_b32 v73, v75
    buffer_store_dwordx4 v[72:75], v2, s[44:47], s54 offen offset:128 sc1
    v_permlane16_swap_b32 v76, v78
    v_permlane16_swap_b32 v77, v79
    buffer_store_dwordx4 v[76:79], v2, s[44:47], s54 offen offset:192 sc1
L_end:
    s_endpgm
.section .rodata,"a"
.p2align 6
.amdhsa_kernel concat_heads__sliding_local_dilated__linear_attn_block__prompt_kernel
  .amdhsa_next_free_vgpr 512
  .amdhsa_next_free_sgpr 102
  .amdhsa_accum_offset 256
  .amdhsa_group_segment_fixed_size 0
  .amdhsa_kernarg_size 72
  .amdhsa_user_sgpr_count 2
  .amdhsa_user_sgpr_kernarg_segment_ptr 1
  .amdhsa_system_sgpr_workgroup_id_x 1
.end_amdhsa_kernel
```
